```python
import torch

def _softmax(x, axis=-1):
    return torch.softmax(x, dim=axis)
def _gelu(x):
    return torch.nn.functional.gelu(x, approximate="tanh")
def _silu(x):
    return torch.nn.functional.silu(x)
def _sigmoid(x):
    return torch.sigmoid(x)
def _layernorm(x, axis=-1, eps=1e-5):
    m = x.mean(dim=axis, keepdim=True)
    v = x.var(dim=axis, keepdim=True, unbiased=False)
    return (x - m) / torch.sqrt(v + eps)
def _scatter_add(tgt, idx, src, axis=0):
    return tgt.clone().index_add_(axis, idx, src)
def _segment_sum(src, seg, n):
    out = torch.zeros((n,) + src.shape[1:], dtype=src.dtype)
    return out.index_add_(0, seg, src)
def _pad(x, pw):
    flat = tuple(v for pair in reversed(pw) for v in pair)
    return torch.nn.functional.pad(x, flat)

kernel_name = 'concat_heads__gqa_block_cached__gqa_block_cached__near_ridge'

def setup_inputs():

    _w = (lambda a: (lambda t: t.to(torch.bfloat16) if t.is_floating_point() else t)(torch.as_tensor(a)))
    def _A_setup():
        B, Sq, D = 8, 160, 640
        Hq, Hkv, Sk, Dh = 32, 32, 512, 128
        assert Hq % Hkv == 0, (Hq, Hkv)
        return {
            "x": _w((lambda *s: torch.randn(*s, dtype=torch.bfloat16) * 0.8)(B, Sq, D)),
            "k_cache": _w((lambda *s: torch.randn(*s, dtype=torch.bfloat16) * 0.8)(B, Hkv, Sk, Dh)),
            "v_cache": _w((lambda *s: torch.randn(*s, dtype=torch.bfloat16) * 0.05)(B, Hkv, Sk, Dh)),
            "wq": _w((lambda *s: torch.randn(*s, dtype=torch.bfloat16) * 0.8)(D, Hq * Dh) * (D ** -0.5)),
            "wo": _w((lambda *s: torch.randn(*s, dtype=torch.bfloat16) * 0.05)(Hq * Dh, D) * ((Hq * Dh) ** -0.5)),
        }
    _A_in = _A_setup()

    def _B_setup():
        B, Sq, D = 8, 160, 640
        Hq, Hkv, Sk, Dh = 32, 32, 512, 128
        assert Hq % Hkv == 0, (Hq, Hkv)
        return {
            "x": _w((lambda *s: torch.randn(*s, dtype=torch.bfloat16) * 0.8)(B, Sq, D)),
            "k_cache": _w((lambda *s: torch.randn(*s, dtype=torch.bfloat16) * 0.8)(B, Hkv, Sk, Dh)),
            "v_cache": _w((lambda *s: torch.randn(*s, dtype=torch.bfloat16) * 0.05)(B, Hkv, Sk, Dh)),
            "wq": _w((lambda *s: torch.randn(*s, dtype=torch.bfloat16) * 0.8)(D, Hq * Dh) * (D ** -0.5)),
            "wo": _w((lambda *s: torch.randn(*s, dtype=torch.bfloat16) * 0.05)(Hq * Dh, D) * ((Hq * Dh) ** -0.5)),
        }
    _B_in = _B_setup()

    return {
        "A_x": _A_in["x"],
        "A_k_cache": _A_in["k_cache"],
        "A_v_cache": _A_in["v_cache"],
        "A_wq": _A_in["wq"],
        "A_wo": _A_in["wo"],
        "B_x": _B_in["x"],
        "B_k_cache": _B_in["k_cache"],
        "B_v_cache": _B_in["v_cache"],
        "B_wq": _B_in["wq"],
        "B_wo": _B_in["wo"],
    }

def reference(A_x, A_k_cache, A_v_cache, A_wq, A_wo, B_x, B_k_cache, B_v_cache, B_wq, B_wo):
    def _A_ref(x, k_cache, v_cache, wq, wo):
        B, Sq, D = x.shape
        Hq, Dh = 32, 128
        Hkv = k_cache.shape[1]
        rep = Hq // Hkv
        q = (lambda x, *d: x.permute(*d))((x @ wq).reshape(B, Sq, Hq, Dh), 0, 2, 1, 3)
        k = (lambda x, n, axis: torch.repeat_interleave(x, n, dim=axis))(k_cache, rep, axis=1)
        v = (lambda x, n, axis: torch.repeat_interleave(x, n, dim=axis))(v_cache, rep, axis=1)
        scores = torch.einsum("bhqd,bhkd->bhqk", q, k) * (Dh ** -0.5)
        p = _softmax(scores, axis=-1)
        o = torch.einsum("bhqk,bhkd->bhqd", p, v)
        return (lambda x, *d: x.permute(*d))(o, 0, 2, 1, 3).reshape(B, Sq, Hq * Dh) @ wo

    def _B_ref(x, k_cache, v_cache, wq, wo):
        B, Sq, D = x.shape
        Hq, Dh = 32, 128
        Hkv = k_cache.shape[1]
        rep = Hq // Hkv
        q = (lambda x, *d: x.permute(*d))((x @ wq).reshape(B, Sq, Hq, Dh), 0, 2, 1, 3)
        k = (lambda x, n, axis: torch.repeat_interleave(x, n, dim=axis))(k_cache, rep, axis=1)
        v = (lambda x, n, axis: torch.repeat_interleave(x, n, dim=axis))(v_cache, rep, axis=1)
        scores = torch.einsum("bhqd,bhkd->bhqk", q, k) * (Dh ** -0.5)
        p = _softmax(scores, axis=-1)
        o = torch.einsum("bhqk,bhkd->bhqd", p, v)
        return (lambda x, *d: x.permute(*d))(o, 0, 2, 1, 3).reshape(B, Sq, Hq * Dh) @ wo

    a = _A_ref(A_x, A_k_cache, A_v_cache, A_wq, A_wo)
    b = _B_ref(B_x, B_k_cache, B_v_cache, B_wq, B_wo)
    return torch.concatenate([a, b], axis=-1)
```

```asm
; @launch grid=(256,1,1) block=(256,1,1) lds=163840
.amdgcn_target "amdgcn-amd-amdhsa--gfx950"
.text
.globl concat_heads__gqa_block_cached__gqa_block_cached__near_ridge_kernel
.p2align 8
.type concat_heads__gqa_block_cached__gqa_block_cached__near_ridge_kernel,@function
concat_heads__gqa_block_cached__gqa_block_cached__near_ridge_kernel:
s_cmp_ge_u32 s2, 256
s_cbranch_scc1 K1_end
s_and_b32 s3, s2, 7
s_lshr_b32 s4, s3, 2
s_mul_i32 s5, s4, 40
s_add_u32 s6, s0, s5
s_addc_u32 s7, s1, 0
s_load_dwordx8 s[64:71], s[6:7], 0
s_load_dwordx2 s[72:73], s[6:7], 32
s_load_dwordx2 s[74:75], s[0:1], 96
s_load_dwordx4 s[84:87], s[0:1], 80
v_and_b32 v1, 63, v0
v_lshrrev_b32 v24, 6, v0
s_lshr_b32 s5, s2, 3
v_readfirstlane_b32 s36, v24
s_getpc_b64 s[80:81]
s_mul_hi_u32 s78, s5, 390451573
s_mul_i32 s78, s78, 11
s_sub_u32 s78, s5, s78
s_lshl_b32 s78, s78, 12
v_lshlrev_b32 v25, 4, v0
v_add_u32 v25, s78, v25
global_load_dwordx4 a[248:251], v25, s[80:81]
s_and_b32 s76, s3, 1
s_lshl_b32 s76, s76, 3
s_and_b32 s77, s5, 7
s_add_u32 s76, s76, s77
s_bfe_u32 s77, s3, 0x10001
s_lshl_b32 s77, s77, 2
s_lshr_b32 s80, s5, 3
s_add_u32 s77, s77, s80
s_lshl_b32 s76, s76, 1
s_and_b32 s78, s36, 1
s_lshr_b32 s79, s36, 1
s_lshl_b32 s37, s77, 5
s_add_u32 s37, s37, s76
s_add_u32 s37, s37, s79
s_lshl_b32 s37, s37, 17
s_add_u32 s40, s37, 4096
s_lshl_b32 s80, s79, 13
s_lshl_b32 s38, s78, 11
s_add_u32 s38, s38, s80
s_lshl_b32 s39, s78, 10
s_add_u32 s39, s39, s80
s_add_u32 s39, s39, 16384
s_mov_b32 s42, 0xffff0000
s_mov_b32 s43, 0xffff0000
s_mov_b32 s48, 0x3e0293ee
s_mov_b32 s49, 0x3e0293ee
s_mov_b32 s50, 0
s_mov_b32 s51, 0
s_mov_b32 s46, 0
s_lshl_b32 s80, s4, 3
s_add_u32 s80, s80, s77
s_lshl_b32 s80, s80, 5
s_add_u32 s80, s80, s76
s_add_u32 s80, s80, s79
s_mul_i32 s44, s80, 40960
s_mul_i32 s80, s78, 5120
s_add_u32 s44, s44, s80
s_and_b32 s80, s3, 1
s_mul_i32 s45, s80, 2621440
s_mul_i32 s80, s5, 81920
s_add_u32 s45, s45, s80
s_mul_i32 s80, s36, 20480
s_add_u32 s45, s45, s80
s_lshl_b32 s59, s36, 11
s_mul_i32 s60, s36, 5120
s_add_u32 s60, s60, 32768
s_mov_b32 s56, 106496
s_mov_b32 s57, 106496
s_mov_b32 s58, 106496
s_add_u32 s52, s59, 106496
s_add_u32 s53, s60, 106496
v_lshlrev_b32 v7, 4, v1
v_lshlrev_b32 v13, 7, v1
v_lshrrev_b32 v24, 4, v1
v_bfe_u32 v25, v1, 2, 2
v_and_b32 v26, 3, v1
v_and_b32 v27, 15, v1
v_lshrrev_b32 v28, 3, v27
v_lshlrev_b32 v28, 1, v28
v_xor_b32 v28, v28, v24
v_lshlrev_b32 v28, 4, v28
s_lshl_b32 s81, s79, 13
v_lshl_add_u32 v2, v25, 10, v28
v_lshl_add_u32 v2, v26, 6, v2
v_add_u32 v2, s81, v2
v_lshrrev_b32 v29, 3, v27
v_lshl_add_u32 v10, v29, 10, v28
v_and_b32 v29, 7, v27
v_lshl_add_u32 v10, v29, 6, v10
s_mul_i32 s80, s78, 10240
s_add_u32 s80, s80, 32768
v_add_u32 v201, s80, v10
v_add_u32 v10, 106496, v201
v_lshlrev_b32 v28, 10, v24
v_lshl_add_u32 v28, v25, 6, v28
v_lshl_add_u32 v28, v26, 3, v28
v_add_u32 v28, s81, v28
v_and_b32 v29, 1, v24
v_lshl_add_u32 v3, v29, 5, v28
v_xor_b32 v29, 1, v29
v_lshl_add_u32 v4, v29, 5, v28
s_lshl_b32 s80, s78, 1
v_xor_b32 v28, s80, v26
v_lshlrev_b32 v28, 4, v28
v_lshl_add_u32 v28, v24, 6, v28
v_lshl_add_u32 v28, v25, 8, v28
s_lshl_b32 s80, s78, 11
v_add_u32 v5, s80, v28
s_lshl_b32 s80, s78, 10
v_add_u32 v6, s80, v28
v_xor_b32 v28, s78, v26
v_lshlrev_b32 v28, 4, v28
v_lshl_add_u32 v28, v24, 6, v28
v_lshl_add_u32 v28, v25, 13, v28
s_lshl_b32 s80, s36, 16
s_lshl_b32 s62, s76, 8
s_add_u32 s80, s80, s62
v_add_u32 v192, s80, v28
v_add_u32 v193, 31744, v192
v_add_u32 v194, 256, v192
v_add_u32 v195, 32000, v192
v_and_b32 v29, 1, v24
v_xor_b32 v29, v29, v26
v_lshlrev_b32 v29, 4, v29
v_lshl_add_u32 v29, v24, 11, v29
v_lshl_add_u32 v29, v25, 6, v29
v_add_u32 v29, s81, v29
v_and_b32 v30, 1, v26
v_lshl_add_u32 v202, v30, 3, v29
v_xor_b32 v30, 1, v30
v_lshl_add_u32 v203, v30, 3, v29
v_add_u32 v8, 106496, v202
v_add_u32 v9, 106496, v203
v_bfe_u32 v28, v1, 2, 3
v_mul_u32_u24 v28, 1280, v28
v_lshrrev_b32 v29, 5, v1
v_lshl_add_u32 v28, v29, 6, v28
s_mul_i32 s80, s77, 160
s_mul_i32 s62, s36, 40
s_add_u32 s80, s80, s62
s_mul_i32 s80, s80, 1280
v_add_u32 v28, s80, v28
s_lshl_b32 s80, s78, 1
v_xor_b32 v29, s80, v26
v_lshl_add_u32 v30, v29, 4, v28
v_xor_b32 v29, 2, v29
v_lshl_add_u32 v31, v29, 4, v28
v_add_u32 v196, 0, v30
v_add_u32 v197, 9216, v31
v_add_u32 v198, 18432, v30
v_add_u32 v199, 27648, v31
v_add_u32 v200, 40960, v30
v_lshrrev_b32 v30, 2, v1
v_lshlrev_b32 v28, 7, v30
v_lshl_add_u32 v28, v26, 2, v28
v_mov_b32 v206, v28
s_lshl_b32 s80, s5, 1
s_add_u32 s80, s80, s78
s_lshl_b32 s80, s80, 13
s_and_b32 s62, s3, 1
s_lshl_b32 s62, s62, 12
s_add_u32 s80, s80, s62
v_add_u32 v28, s80, v28
s_bfe_u32 s80, s3, 0x10001
s_mul_i32 s80, s80, 640
s_mul_i32 s62, s5, 20
s_add_u32 s80, s80, s62
s_mul_i32 s80, s80, 1280
s_cmp_eq_u32 s79, 0
s_cselect_b64 s[62:63], -1, 0
s_cselect_b32 s33, 524288, 64
s_cselect_b32 s81, 0, 64
s_add_u32 s33, s33, s81
v_add_u32 v29, 0, v30
v_min_u32 v29, 19, v29
v_mul_u32_u24 v29, 1280, v29
v_add_u32 v29, s80, v29
v_add_u32 v31, 0, v28
v_cndmask_b32 v204, v29, v31, s[62:63]
v_add_u32 v29, 16, v30
v_min_u32 v29, 19, v29
v_mul_u32_u24 v29, 1280, v29
v_add_u32 v29, s80, v29
v_add_u32 v31, 2048, v28
v_cndmask_b32 v205, v29, v31, s[62:63]
v_mov_b32 v28, 0x3f803f80
v_accvgpr_write_b32 a252, v28
v_accvgpr_write_b32 a253, v28
v_accvgpr_write_b32 a254, v28
v_accvgpr_write_b32 a255, v28
v_mov_b32 v11, 1
v_mov_b32 v12, 0
s_waitcnt lgkmcnt(0)
s_mov_b32 s8, s64
s_and_b32 s9, s65, 0xffff
s_mov_b32 s10, 1638400
s_mov_b32 s11, 0x20000
s_mov_b32 s12, s66
s_and_b32 s13, s67, 0xffff
s_mov_b32 s14, 33554432
s_mov_b32 s15, 0x20000
s_mov_b32 s16, s68
s_and_b32 s17, s69, 0xffff
s_mov_b32 s18, 33554432
s_mov_b32 s19, 0x20000
s_mov_b32 s20, s70
s_and_b32 s21, s71, 0xffff
s_mov_b32 s22, 5242880
s_mov_b32 s23, 0x20000
s_mov_b32 s24, s72
s_and_b32 s25, s73, 0xffff
s_mov_b32 s26, 5242880
s_mov_b32 s27, 0x20000
s_mov_b32 s28, s74
s_and_b32 s29, s75, 0xffff
s_mov_b32 s30, 268435456
s_mov_b32 s31, 0x20000
s_mov_b32 s92, s84
s_and_b32 s93, s85, 0xffff
s_mov_b32 s94, 3276800
s_mov_b32 s95, 0x20000
s_mov_b32 s88, s86
s_and_b32 s89, s87, 0xffff
s_mov_b32 s90, 256
s_mov_b32 s91, 0x20000
s_cmp_eq_u32 s79, 0
s_cselect_b32 s68, s20, s8
s_cselect_b32 s69, s21, s9
s_cselect_b32 s70, s22, s10
s_mov_b32 s71, 0x20000
s_lshl_b32 s80, s4, 3
s_add_u32 s80, s80, s77
s_lshr_b32 s81, s76, 3
s_bfe_u32 s84, s76, 0x20001
s_lshl_b32 s86, s80, 2
s_add_u32 s86, s86, s81
s_lshl_b32 s86, s86, 7
s_add_u32 s86, s86, 62914560
s_lshl_b32 s96, s84, 2
s_add_u32 s96, s96, s86
s_lshl_b32 s87, s80, 2
s_add_u32 s87, s87, s84
s_lshl_b32 s73, s87, 2
s_lshl_b32 s87, s87, 7
s_add_u32 s87, s87, 62980096
s_lshl_b32 s72, s81, 2
s_add_u32 s72, s72, s87
s_lshl_b32 s85, s80, 4
s_lshl_b32 s6, s81, 2
s_add_u32 s6, s6, s85
s_cmp_eq_u32 s36, 0
s_cselect_b32 s6, s6, 0x7ff00000
s_cselect_b32 s96, s96, 0x7ff00000
s_cselect_b32 s72, s72, 0x7ff00000
s_add_u32 s73, s73, s36
s_mul_i32 s73, s73, 53248
s_add_u32 s73, s73, 100663296
s_mov_b32 s74, s81
s_lshl_b32 s97, s80, 5
s_lshl_b32 s80, s81, 3
s_add_u32 s97, s97, s80
s_mul_i32 s97, s97, 40960
s_mul_i32 s80, s36, 5120
s_add_u32 s97, s97, s80
s_mul_i32 s98, s81, 1310720
s_mul_i32 s80, s84, 320
s_add_u32 s98, s98, s80
s_mul_i32 s80, s36, 20480
s_add_u32 s98, s98, s80
s_lshl_b32 s61, s84, 2
s_lshl_b32 s99, s77, 1
s_add_u32 s99, s99, s78
s_mul_i32 s99, s99, 204800
s_mul_i32 s80, s4, 1280
s_add_u32 s99, s99, s80
s_mul_i32 s80, s84, 320
s_add_u32 s99, s99, s80
s_mul_i32 s80, s79, 160
s_add_u32 s99, s99, s80
s_add_u32 s32, s61, 4
s_and_b32 s32, s32, 15
s_mul_i32 s47, s36, 5120
s_mul_i32 s35, s78, 5120
v_lshrrev_b32 v24, 2, v1
v_mul_u32_u24 v25, 1280, v24
v_bfe_u32 v26, v1, 4, 1
v_lshlrev_b32 v27, 1, v26
v_and_b32 v28, 3, v1
v_xor_b32 v27, v27, v28
v_lshl_add_u32 v25, v27, 4, v25
v_add_u32 v14, 4096, v25
v_add_u32 v15, 3136, v25
v_add_u32 v16, 2176, v25
v_add_u32 v17, 1216, v25
v_add_u32 v18, 4352, v25
v_add_u32 v20, 4096, v7
s_sub_u32 s64, s24, 4096
s_subb_u32 s65, s25, 0
s_add_u32 s66, s26, 4096
s_mov_b32 s67, 0x20000
v_lshlrev_b32 v24, 6, v24
v_lshl_add_u32 v24, v28, 3, v24
v_xor_b32 v26, s79, v26
v_lshl_add_u32 v21, v26, 5, v24
s_lshl_b32 s34, s79, 11
s_add_u32 s34, s34, 20480
s_lshl_b32 s75, s79, 10
s_add_u32 s75, s75, s34
s_mul_i32 s80, s79, 81920
s_add_u32 s80, s80, s35
v_add_u32 v19, s80, v7
s_bitcmp1_b32 s5, 3
s_cbranch_scc0 K1_noX
s_lshr_b32 s80, s5, 4
s_lshl_b32 s80, s80, 3
s_and_b32 s81, s5, 7
s_add_u32 s80, s80, s81
s_lshl_b32 s81, s80, 2
s_lshl_b32 s62, s79, 6
s_add_u32 s81, s81, s62
s_lshl_b32 s62, s78, 1
s_add_u32 s81, s81, s62
s_lshl_b32 s81, s81, 13
s_and_b32 s62, s3, 1
s_lshl_b32 s62, s62, 12
s_add_u32 s81, s81, s62
v_lshrrev_b32 v28, 5, v1
v_lshlrev_b32 v28, 13, v28
v_and_b32 v29, 31, v1
v_lshl_add_u32 v28, v29, 7, v28
s_bfe_u32 s62, s3, 0x10001
s_mul_i32 s62, s62, 640
s_mul_i32 s63, s80, 40
s_add_u32 s62, s62, s63
s_mul_i32 s62, s62, 1280
s_lshl_b32 s63, s36, 7
s_add_u32 s62, s62, s63
v_min_u32 v29, 39, v1
v_mul_u32_u24 v29, 1280, v29
buffer_load_dword a249, v29, s[8:11], s62 offen
s_add_u32 s62, s62, 512
buffer_load_dword a248, v28, s[20:23], s81 offen
s_add_u32 s81, s81, 1048576
buffer_load_dword a249, v29, s[8:11], s62 offen
s_add_u32 s62, s62, 512
buffer_load_dword a248, v28, s[20:23], s81 offen
s_add_u32 s81, s81, 1048576
s_cmp_gt_u32 s36, 1
s_cselect_b32 s62, 0x7ff00000, s62
buffer_load_dword a249, v29, s[8:11], s62 offen
s_add_u32 s62, s62, 512
buffer_load_dword a248, v28, s[20:23], s81 offen
s_add_u32 s81, s81, 1048576
buffer_load_dword a248, v28, s[20:23], s81 offen
s_add_u32 s81, s81, 1048576
buffer_load_dword a248, v28, s[20:23], s81 offen
s_add_u32 s81, s81, 1048576
s_and_b32 s62, s3, 1
s_mul_i32 s62, s62, 2621440
s_mul_i32 s63, s80, 163840
s_add_u32 s62, s62, s63
s_mul_i32 s63, s36, 40960
s_add_u32 s62, s62, s63
K1_noX:
s_bitcmp1_b32 s5, 3
s_cselect_b32 s62, 0x7ff00000, 0
s_cselect_b32 s63, 0x28000, 0
s_cselect_b32 s84, 0x10000, 0
s_cselect_b32 s80, s38, 0x28000
s_cselect_b32 s81, s39, 0x28000
v_add_u32 v22, s80, v7
v_add_u32 v0, s81, v7
s_cmp_eq_u32 s78, 0
s_cselect_b32 s76, s12, s16
s_cselect_b32 s77, s13, s17
s_mov_b32 s78, 33554432
s_mov_b32 s79, 0x20000
s_mov_b32 s7, s37
s_add_u32 m0, s52, 0
s_add_u32 s56, s56, 53248
s_cmp_lt_u32 s56, 159744
s_cselect_b32 s56, s56, 0
buffer_load_dwordx4 v192, s[20:23], s50 offen lds
s_add_u32 s57, s57, 53248
s_cmp_lt_u32 s57, 159744
s_cselect_b32 s57, s57, 0
s_add_u32 s58, s58, 53248
s_cmp_lt_u32 s58, 159744
s_cselect_b32 s58, s58, 0
buffer_load_dwordx4 v193, s[20:23], s50 offen offset:1024 lds
s_add_u32 m0, s52, 8192
s_nop 0
buffer_load_dwordx4 v194, s[20:23], s50 offen lds
buffer_load_dwordx4 v195, s[20:23], s50 offen offset:1024 lds
s_add_u32 m0, s53, 0
s_add_u32 s50, s50, 262144
buffer_load_dwordx4 v196, s[8:11], s51 offen lds
buffer_load_dwordx4 v197, s[8:11], s51 offen offset:1024 lds
buffer_load_dwordx4 v198, s[8:11], s51 offen offset:2048 lds
buffer_load_dwordx4 v199, s[8:11], s51 offen offset:3072 lds
s_add_u32 m0, s53, 4096
s_add_u32 s53, s56, s60
buffer_load_dwordx4 v200, s[8:11], s51 offen lds
s_add_u32 m0, s52, 16384
s_add_u32 s51, s51, 128
buffer_load_dwordx4 v192, s[20:23], s50 offen lds
buffer_load_dwordx4 v193, s[20:23], s50 offen offset:1024 lds
s_add_u32 m0, s52, 24576
s_add_u32 s52, s56, s59
s_add_u32 s56, s56, 53248
s_cmp_lt_u32 s56, 159744
s_cselect_b32 s56, s56, 0
buffer_load_dwordx4 v194, s[20:23], s50 offen lds
buffer_load_dwordx4 v195, s[20:23], s50 offen offset:1024 lds
s_add_u32 m0, s52, 0
s_add_u32 s50, s50, 262144
buffer_load_dwordx4 v192, s[20:23], s50 offen lds
buffer_load_dwordx4 v193, s[20:23], s50 offen offset:1024 lds
s_add_u32 m0, s52, 8192
s_nop 0
buffer_load_dwordx4 v194, s[20:23], s50 offen lds
buffer_load_dwordx4 v195, s[20:23], s50 offen offset:1024 lds
s_add_u32 m0, s53, 0
s_add_u32 s50, s50, 262144
buffer_load_dwordx4 v196, s[8:11], s51 offen lds
buffer_load_dwordx4 v197, s[8:11], s51 offen offset:1024 lds
buffer_load_dwordx4 v198, s[8:11], s51 offen offset:2048 lds
buffer_load_dwordx4 v199, s[8:11], s51 offen offset:3072 lds
s_add_u32 m0, s53, 4096
s_add_u32 s53, s56, s60
buffer_load_dwordx4 v200, s[8:11], s51 offen lds
s_add_u32 m0, s52, 16384
s_add_u32 s51, s51, 128
buffer_load_dwordx4 v192, s[20:23], s50 offen lds
buffer_load_dwordx4 v193, s[20:23], s50 offen offset:1024 lds
s_add_u32 m0, s52, 24576
s_add_u32 s52, s56, s59
s_add_u32 s56, s56, 53248
s_cmp_lt_u32 s56, 159744
s_cselect_b32 s56, s56, 0
buffer_load_dwordx4 v194, s[20:23], s50 offen lds
buffer_load_dwordx4 v195, s[20:23], s50 offen offset:1024 lds
s_add_u32 s50, s50, 262144
s_waitcnt vmcnt(17)
s_barrier
s_add_u32 m0, s52, 0
ds_read_b128 a[0:3], v10 offset:0
buffer_load_dwordx4 v192, s[20:23], s50 offen lds
ds_read_b128 a[4:7], v10 offset:2048
ds_read_b128 a[8:11], v10 offset:4096
buffer_load_dwordx4 v193, s[20:23], s50 offen offset:1024 lds
s_add_u32 m0, s52, 8192
ds_read_b128 a[12:15], v10 offset:6144
ds_read_b128 a[16:19], v10 offset:8192
buffer_load_dwordx4 v194, s[20:23], s50 offen lds
ds_read_b64_tr_b16 a[40:41], v8 offset:0
ds_read_b64_tr_b16 a[42:43], v8 offset:1024
ds_read_b64_tr_b16 a[44:45], v9 offset:0
ds_read_b64_tr_b16 a[46:47], v9 offset:1024
ds_read_b64_tr_b16 a[48:49], v8 offset:256
buffer_load_dwordx4 v195, s[20:23], s50 offen offset:1024 lds
s_add_u32 m0, s53, 0
ds_read_b64_tr_b16 a[50:51], v8 offset:1280
s_add_u32 s50, s50, 262144
ds_read_b64_tr_b16 a[52:53], v9 offset:256
ds_read_b64_tr_b16 a[54:55], v9 offset:1280
s_waitcnt vmcnt(17)
s_barrier
ds_read_b128 a[20:23], v10 offset:512
buffer_load_dwordx4 v196, s[8:11], s51 offen lds
ds_read_b128 a[24:27], v10 offset:2560
ds_read_b128 a[28:31], v10 offset:4608
buffer_load_dwordx4 v197, s[8:11], s51 offen offset:1024 lds
ds_read_b128 a[32:35], v10 offset:6656
ds_read_b128 a[36:39], v10 offset:8704
v_add_u32 v10, s57, v201
s_waitcnt lgkmcnt(11)
v_mfma_f32_16x16x32_bf16 v[32:35], a[40:43], a[0:3], 0
buffer_load_dwordx4 v198, s[8:11], s51 offen offset:2048 lds
ds_read_b64_tr_b16 a[56:57], v8 offset:512
v_mfma_f32_16x16x32_bf16 v[64:67], a[40:43], a[4:7], 0
s_add_u32 s57, s57, 53248
s_cmp_lt_u32 s57, 159744
s_cselect_b32 s57, s57, 0
ds_read_b64_tr_b16 a[58:59], v8 offset:1536
v_mfma_f32_16x16x32_bf16 v[96:99], a[40:43], a[8:11], 0
ds_read_b64_tr_b16 a[60:61], v9 offset:512
v_mfma_f32_16x16x32_bf16 v[128:131], a[40:43], a[12:15], 0
buffer_load_dwordx4 v199, s[8:11], s51 offen offset:3072 lds
s_add_u32 m0, s53, 4096
v_mfma_f32_16x16x32_bf16 v[160:163], a[40:43], a[16:19], 0
ds_read_b64_tr_b16 a[62:63], v9 offset:1536
s_add_u32 s53, s56, s60
s_waitcnt lgkmcnt(13)
v_mfma_f32_16x16x32_bf16 v[36:39], a[44:47], a[0:3], 0
ds_read_b64_tr_b16 a[64:65], v8 offset:768
buffer_load_dwordx4 v200, s[8:11], s51 offen lds
v_mfma_f32_16x16x32_bf16 v[68:71], a[44:47], a[4:7], 0
s_add_u32 m0, s52, 16384
ds_read_b64_tr_b16 a[66:67], v8 offset:1792
v_mfma_f32_16x16x32_bf16 v[100:103], a[44:47], a[8:11], 0
ds_read_b64_tr_b16 a[68:69], v9 offset:768
s_add_u32 s51, s51, 128
v_mfma_f32_16x16x32_bf16 v[132:135], a[44:47], a[12:15], 0
buffer_load_dwordx4 v192, s[20:23], s50 offen lds
ds_read_b64_tr_b16 a[70:71], v9 offset:1792
v_mfma_f32_16x16x32_bf16 v[164:167], a[44:47], a[16:19], 0
ds_read_b64_tr_b16 a[40:41], v8 offset:16384
s_waitcnt lgkmcnt(13)
v_mfma_f32_16x16x32_bf16 v[40:43], a[48:51], a[0:3], 0
ds_read_b64_tr_b16 a[42:43], v8 offset:17408
buffer_load_dwordx4 v193, s[20:23], s50 offen offset:1024 lds
v_mfma_f32_16x16x32_bf16 v[72:75], a[48:51], a[4:7], 0
s_add_u32 m0, s52, 24576
s_add_u32 s52, s56, s59
s_add_u32 s56, s56, 53248
s_cmp_lt_u32 s56, 159744
s_cselect_b32 s56, s56, 0
v_mfma_f32_16x16x32_bf16 v[104:107], a[48:51], a[8:11], 0
ds_read_b64_tr_b16 a[44:45], v9 offset:16384
v_mfma_f32_16x16x32_bf16 v[136:139], a[48:51], a[12:15], 0
buffer_load_dwordx4 v194, s[20:23], s50 offen lds
ds_read_b64_tr_b16 a[46:47], v9 offset:17408
v_mfma_f32_16x16x32_bf16 v[168:171], a[48:51], a[16:19], 0
ds_read_b64_tr_b16 a[48:49], v8 offset:16640
v_mfma_f32_16x16x32_bf16 v[44:47], a[52:55], a[0:3], 0
ds_read_b64_tr_b16 a[50:51], v8 offset:17664
v_mfma_f32_16x16x32_bf16 v[76:79], a[52:55], a[4:7], 0
buffer_load_dwordx4 v195, s[20:23], s50 offen offset:1024 lds
s_add_u32 s50, s50, 262144
v_mfma_f32_16x16x32_bf16 v[108:111], a[52:55], a[8:11], 0
s_waitcnt vmcnt(17) lgkmcnt(6)
s_barrier
v_mfma_f32_16x16x32_bf16 v[140:143], a[52:55], a[12:15], 0
s_add_u32 m0, s52, 0
v_mfma_f32_16x16x32_bf16 v[172:175], a[52:55], a[16:19], 0
buffer_load_dwordx4 v192, s[20:23], s50 offen lds
ds_read_b64_tr_b16 a[52:53], v9 offset:16640
v_mfma_f32_16x16x32_bf16 v[48:51], a[56:59], a[0:3], 0
ds_read_b64_tr_b16 a[54:55], v9 offset:17664
v_mfma_f32_16x16x32_bf16 v[80:83], a[56:59], a[4:7], 0
v_mfma_f32_16x16x32_bf16 v[112:115], a[56:59], a[8:11], 0
buffer_load_dwordx4 v193, s[20:23], s50 offen offset:1024 lds
s_add_u32 m0, s52, 8192
v_mfma_f32_16x16x32_bf16 v[144:147], a[56:59], a[12:15], 0
v_mfma_f32_16x16x32_bf16 v[176:179], a[56:59], a[16:19], 0
v_mfma_f32_16x16x32_bf16 v[52:55], a[60:63], a[0:3], 0
buffer_load_dwordx4 v194, s[20:23], s50 offen lds
v_mfma_f32_16x16x32_bf16 v[84:87], a[60:63], a[4:7], 0
v_mfma_f32_16x16x32_bf16 v[116:119], a[60:63], a[8:11], 0
v_mfma_f32_16x16x32_bf16 v[148:151], a[60:63], a[12:15], 0
buffer_load_dwordx4 v195, s[20:23], s50 offen offset:1024 lds
s_add_u32 m0, s53, 0
v_mfma_f32_16x16x32_bf16 v[180:183], a[60:63], a[16:19], 0
s_add_u32 s50, s50, 262144
v_mfma_f32_16x16x32_bf16 v[56:59], a[64:67], a[0:3], 0
v_mfma_f32_16x16x32_bf16 v[88:91], a[64:67], a[4:7], 0
buffer_load_dwordx4 v196, s[8:11], s51 offen lds
v_mfma_f32_16x16x32_bf16 v[120:123], a[64:67], a[8:11], 0
v_mfma_f32_16x16x32_bf16 v[152:155], a[64:67], a[12:15], 0
v_mfma_f32_16x16x32_bf16 v[184:187], a[64:67], a[16:19], 0
buffer_load_dwordx4 v197, s[8:11], s51 offen offset:1024 lds
v_mfma_f32_16x16x32_bf16 v[60:63], a[68:71], a[0:3], 0
ds_read_b128 a[0:3], v10 offset:0
v_mfma_f32_16x16x32_bf16 v[92:95], a[68:71], a[4:7], 0
ds_read_b128 a[4:7], v10 offset:2048
v_mfma_f32_16x16x32_bf16 v[124:127], a[68:71], a[8:11], 0
ds_read_b128 a[8:11], v10 offset:4096
buffer_load_dwordx4 v198, s[8:11], s51 offen offset:2048 lds
v_mfma_f32_16x16x32_bf16 v[156:159], a[68:71], a[12:15], 0
ds_read_b128 a[12:15], v10 offset:6144
v_mfma_f32_16x16x32_bf16 v[188:191], a[68:71], a[16:19], 0
ds_read_b128 a[16:19], v10 offset:8192
s_waitcnt lgkmcnt(5)
v_mfma_f32_16x16x32_bf16 v[32:35], a[40:43], a[20:23], v[32:35]
ds_read_b64_tr_b16 a[56:57], v8 offset:16896
buffer_load_dwordx4 v199, s[8:11], s51 offen offset:3072 lds
v_mfma_f32_16x16x32_bf16 v[64:67], a[40:43], a[24:27], v[64:67]
ds_read_b64_tr_b16 a[58:59], v8 offset:17920
s_add_u32 m0, s53, 4096
s_add_u32 s53, s56, s60
v_mfma_f32_16x16x32_bf16 v[96:99], a[40:43], a[28:31], v[96:99]
ds_read_b64_tr_b16 a[60:61], v9 offset:16896
v_mfma_f32_16x16x32_bf16 v[128:131], a[40:43], a[32:35], v[128:131]
buffer_load_dwordx4 v200, s[8:11], s51 offen lds
ds_read_b64_tr_b16 a[62:63], v9 offset:17920
v_mfma_f32_16x16x32_bf16 v[160:163], a[40:43], a[36:39], v[160:163]
ds_read_b64_tr_b16 a[64:65], v8 offset:17152
s_add_u32 s51, s51, 128
v_mfma_f32_16x16x32_bf16 v[36:39], a[44:47], a[20:23], v[36:39]
ds_read_b64_tr_b16 a[66:67], v8 offset:18176
v_add_u32 v8, s58, v202
v_mfma_f32_16x16x32_bf16 v[68:71], a[44:47], a[24:27], v[68:71]
ds_read_b64_tr_b16 a[68:69], v9 offset:17152
v_mfma_f32_16x16x32_bf16 v[100:103], a[44:47], a[28:31], v[100:103]
ds_read_b64_tr_b16 a[70:71], v9 offset:18176
v_add_u32 v9, s58, v203
v_mfma_f32_16x16x32_bf16 v[132:135], a[44:47], a[32:35], v[132:135]
ds_read_b64_tr_b16 a[40:41], v8 offset:0
s_add_u32 s58, s58, 53248
s_cmp_lt_u32 s58, 159744
s_cselect_b32 s58, s58, 0
v_mfma_f32_16x16x32_bf16 v[164:167], a[44:47], a[36:39], v[164:167]
ds_read_b64_tr_b16 a[42:43], v8 offset:1024
v_mfma_f32_16x16x32_bf16 v[40:43], a[48:51], a[20:23], v[40:43]
ds_read_b64_tr_b16 a[44:45], v9 offset:0
v_mfma_f32_16x16x32_bf16 v[72:75], a[48:51], a[24:27], v[72:75]
ds_read_b64_tr_b16 a[46:47], v9 offset:1024
v_mfma_f32_16x16x32_bf16 v[104:107], a[48:51], a[28:31], v[104:107]
v_mfma_f32_16x16x32_bf16 v[136:139], a[48:51], a[32:35], v[136:139]
v_mfma_f32_16x16x32_bf16 v[168:171], a[48:51], a[36:39], v[168:171]
ds_read_b64_tr_b16 a[48:49], v8 offset:256
v_mfma_f32_16x16x32_bf16 v[44:47], a[52:55], a[20:23], v[44:47]
ds_read_b64_tr_b16 a[50:51], v8 offset:1280
v_mfma_f32_16x16x32_bf16 v[76:79], a[52:55], a[24:27], v[76:79]
s_waitcnt vmcnt(22) lgkmcnt(6)
s_barrier
v_mfma_f32_16x16x32_bf16 v[108:111], a[52:55], a[28:31], v[108:111]
s_add_u32 m0, s52, 16384
v_mfma_f32_16x16x32_bf16 v[140:143], a[52:55], a[32:35], v[140:143]
buffer_load_dwordx4 v192, s[20:23], s50 offen lds
v_mfma_f32_16x16x32_bf16 v[172:175], a[52:55], a[36:39], v[172:175]
ds_read_b64_tr_b16 a[52:53], v9 offset:256
v_mfma_f32_16x16x32_bf16 v[48:51], a[56:59], a[20:23], v[48:51]
ds_read_b64_tr_b16 a[54:55], v9 offset:1280
v_mfma_f32_16x16x32_bf16 v[80:83], a[56:59], a[24:27], v[80:83]
buffer_load_dwordx4 v193, s[20:23], s50 offen offset:1024 lds
s_add_u32 m0, s52, 24576
v_mfma_f32_16x16x32_bf16 v[112:115], a[56:59], a[28:31], v[112:115]
s_add_u32 s52, s56, s59
s_add_u32 s56, s56, 53248
s_cmp_lt_u32 s56, 159744
s_cselect_b32 s56, s56, 0
v_mfma_f32_16x16x32_bf16 v[144:147], a[56:59], a[32:35], v[144:147]
v_mfma_f32_16x16x32_bf16 v[176:179], a[56:59], a[36:39], v[176:179]
buffer_load_dwordx4 v194, s[20:23], s50 offen lds
v_mfma_f32_16x16x32_bf16 v[52:55], a[60:63], a[20:23], v[52:55]
v_mfma_f32_16x16x32_bf16 v[84:87], a[60:63], a[24:27], v[84:87]
v_mfma_f32_16x16x32_bf16 v[116:119], a[60:63], a[28:31], v[116:119]
buffer_load_dwordx4 v195, s[20:23], s50 offen offset:1024 lds
s_add_u32 s50, s50, 262144
v_mfma_f32_16x16x32_bf16 v[148:151], a[60:63], a[32:35], v[148:151]
v_mfma_f32_16x16x32_bf16 v[180:183], a[60:63], a[36:39], v[180:183]
v_mfma_f32_16x16x32_bf16 v[56:59], a[64:67], a[20:23], v[56:59]
v_mfma_f32_16x16x32_bf16 v[88:91], a[64:67], a[24:27], v[88:91]
v_mfma_f32_16x16x32_bf16 v[120:123], a[64:67], a[28:31], v[120:123]
v_mfma_f32_16x16x32_bf16 v[152:155], a[64:67], a[32:35], v[152:155]
v_mfma_f32_16x16x32_bf16 v[184:187], a[64:67], a[36:39], v[184:187]
v_mfma_f32_16x16x32_bf16 v[60:63], a[68:71], a[20:23], v[60:63]
ds_read_b128 a[20:23], v10 offset:512
v_mfma_f32_16x16x32_bf16 v[92:95], a[68:71], a[24:27], v[92:95]
ds_read_b128 a[24:27], v10 offset:2560
v_mfma_f32_16x16x32_bf16 v[124:127], a[68:71], a[28:31], v[124:127]
ds_read_b128 a[28:31], v10 offset:4608
v_mfma_f32_16x16x32_bf16 v[156:159], a[68:71], a[32:35], v[156:159]
ds_read_b128 a[32:35], v10 offset:6656
v_mfma_f32_16x16x32_bf16 v[188:191], a[68:71], a[36:39], v[188:191]
ds_read_b128 a[36:39], v10 offset:8704
v_add_u32 v10, s57, v201
s_waitcnt lgkmcnt(5)
s_mov_b32 s41, 5
K1_L0:
v_mfma_f32_16x16x32_bf16 v[32:35], a[40:43], a[0:3], v[32:35]
ds_read_b64_tr_b16 a[56:57], v8 offset:512
s_add_u32 s57, s57, 53248
s_cmp_lt_u32 s57, 159744
s_cselect_b32 s57, s57, 0
v_mfma_f32_16x16x32_bf16 v[64:67], a[40:43], a[4:7], v[64:67]
ds_read_b64_tr_b16 a[58:59], v8 offset:1536
v_mfma_f32_16x16x32_bf16 v[96:99], a[40:43], a[8:11], v[96:99]
ds_read_b64_tr_b16 a[60:61], v9 offset:512
v_mfma_f32_16x16x32_bf16 v[128:131], a[40:43], a[12:15], v[128:131]
ds_read_b64_tr_b16 a[62:63], v9 offset:1536
v_mfma_f32_16x16x32_bf16 v[160:163], a[40:43], a[16:19], v[160:163]
ds_read_b64_tr_b16 a[64:65], v8 offset:768
v_mfma_f32_16x16x32_bf16 v[36:39], a[44:47], a[0:3], v[36:39]
ds_read_b64_tr_b16 a[66:67], v8 offset:1792
v_mfma_f32_16x16x32_bf16 v[68:71], a[44:47], a[4:7], v[68:71]
ds_read_b64_tr_b16 a[68:69], v9 offset:768
v_mfma_f32_16x16x32_bf16 v[100:103], a[44:47], a[8:11], v[100:103]
ds_read_b64_tr_b16 a[70:71], v9 offset:1792
v_mfma_f32_16x16x32_bf16 v[132:135], a[44:47], a[12:15], v[132:135]
ds_read_b64_tr_b16 a[40:41], v8 offset:16384
v_mfma_f32_16x16x32_bf16 v[164:167], a[44:47], a[16:19], v[164:167]
ds_read_b64_tr_b16 a[42:43], v8 offset:17408
v_mfma_f32_16x16x32_bf16 v[40:43], a[48:51], a[0:3], v[40:43]
ds_read_b64_tr_b16 a[44:45], v9 offset:16384
v_mfma_f32_16x16x32_bf16 v[72:75], a[48:51], a[4:7], v[72:75]
ds_read_b64_tr_b16 a[46:47], v9 offset:17408
v_mfma_f32_16x16x32_bf16 v[104:107], a[48:51], a[8:11], v[104:107]
v_mfma_f32_16x16x32_bf16 v[136:139], a[48:51], a[12:15], v[136:139]
v_mfma_f32_16x16x32_bf16 v[168:171], a[48:51], a[16:19], v[168:171]
ds_read_b64_tr_b16 a[48:49], v8 offset:16640
v_mfma_f32_16x16x32_bf16 v[44:47], a[52:55], a[0:3], v[44:47]
ds_read_b64_tr_b16 a[50:51], v8 offset:17664
v_mfma_f32_16x16x32_bf16 v[76:79], a[52:55], a[4:7], v[76:79]
s_waitcnt vmcnt(17) lgkmcnt(6)
s_barrier
v_mfma_f32_16x16x32_bf16 v[108:111], a[52:55], a[8:11], v[108:111]
s_add_u32 m0, s52, 0
v_mfma_f32_16x16x32_bf16 v[140:143], a[52:55], a[12:15], v[140:143]
buffer_load_dwordx4 v192, s[20:23], s50 offen lds
v_mfma_f32_16x16x32_bf16 v[172:175], a[52:55], a[16:19], v[172:175]
ds_read_b64_tr_b16 a[52:53], v9 offset:16640
v_mfma_f32_16x16x32_bf16 v[48:51], a[56:59], a[0:3], v[48:51]
ds_read_b64_tr_b16 a[54:55], v9 offset:17664
v_mfma_f32_16x16x32_bf16 v[80:83], a[56:59], a[4:7], v[80:83]
buffer_load_dwordx4 v193, s[20:23], s50 offen offset:1024 lds
s_add_u32 m0, s52, 8192
v_mfma_f32_16x16x32_bf16 v[112:115], a[56:59], a[8:11], v[112:115]
v_mfma_f32_16x16x32_bf16 v[144:147], a[56:59], a[12:15], v[144:147]
v_mfma_f32_16x16x32_bf16 v[176:179], a[56:59], a[16:19], v[176:179]
buffer_load_dwordx4 v194, s[20:23], s50 offen lds
v_mfma_f32_16x16x32_bf16 v[52:55], a[60:63], a[0:3], v[52:55]
v_mfma_f32_16x16x32_bf16 v[84:87], a[60:63], a[4:7], v[84:87]
v_mfma_f32_16x16x32_bf16 v[116:119], a[60:63], a[8:11], v[116:119]
buffer_load_dwordx4 v195, s[20:23], s50 offen offset:1024 lds
s_add_u32 m0, s53, 0
v_mfma_f32_16x16x32_bf16 v[148:151], a[60:63], a[12:15], v[148:151]
s_add_u32 s50, s50, 262144
v_mfma_f32_16x16x32_bf16 v[180:183], a[60:63], a[16:19], v[180:183]
v_mfma_f32_16x16x32_bf16 v[56:59], a[64:67], a[0:3], v[56:59]
buffer_load_dwordx4 v196, s[8:11], s51 offen lds
v_mfma_f32_16x16x32_bf16 v[88:91], a[64:67], a[4:7], v[88:91]
v_mfma_f32_16x16x32_bf16 v[120:123], a[64:67], a[8:11], v[120:123]
v_mfma_f32_16x16x32_bf16 v[152:155], a[64:67], a[12:15], v[152:155]
buffer_load_dwordx4 v197, s[8:11], s51 offen offset:1024 lds
v_mfma_f32_16x16x32_bf16 v[184:187], a[64:67], a[16:19], v[184:187]
v_mfma_f32_16x16x32_bf16 v[60:63], a[68:71], a[0:3], v[60:63]
ds_read_b128 a[0:3], v10 offset:0
v_mfma_f32_16x16x32_bf16 v[92:95], a[68:71], a[4:7], v[92:95]
ds_read_b128 a[4:7], v10 offset:2048
buffer_load_dwordx4 v198, s[8:11], s51 offen offset:2048 lds
v_mfma_f32_16x16x32_bf16 v[124:127], a[68:71], a[8:11], v[124:127]
ds_read_b128 a[8:11], v10 offset:4096
v_mfma_f32_16x16x32_bf16 v[156:159], a[68:71], a[12:15], v[156:159]
ds_read_b128 a[12:15], v10 offset:6144
v_mfma_f32_16x16x32_bf16 v[188:191], a[68:71], a[16:19], v[188:191]
ds_read_b128 a[16:19], v10 offset:8192
buffer_load_dwordx4 v199, s[8:11], s51 offen offset:3072 lds
s_waitcnt lgkmcnt(5)
v_mfma_f32_16x16x32_bf16 v[32:35], a[40:43], a[20:23], v[32:35]
ds_read_b64_tr_b16 a[56:57], v8 offset:16896
s_add_u32 m0, s53, 4096
v_mfma_f32_16x16x32_bf16 v[64:67], a[40:43], a[24:27], v[64:67]
ds_read_b64_tr_b16 a[58:59], v8 offset:17920
s_add_u32 s53, s56, s60
v_mfma_f32_16x16x32_bf16 v[96:99], a[40:43], a[28:31], v[96:99]
buffer_load_dwordx4 v200, s[8:11], s51 offen lds
ds_read_b64_tr_b16 a[60:61], v9 offset:16896
v_mfma_f32_16x16x32_bf16 v[128:131], a[40:43], a[32:35], v[128:131]
ds_read_b64_tr_b16 a[62:63], v9 offset:17920
s_add_u32 s51, s51, 128
v_mfma_f32_16x16x32_bf16 v[160:163], a[40:43], a[36:39], v[160:163]
ds_read_b64_tr_b16 a[64:65], v8 offset:17152
v_mfma_f32_16x16x32_bf16 v[36:39], a[44:47], a[20:23], v[36:39]
ds_read_b64_tr_b16 a[66:67], v8 offset:18176
v_add_u32 v8, s58, v202
v_mfma_f32_16x16x32_bf16 v[68:71], a[44:47], a[24:27], v[68:71]
ds_read_b64_tr_b16 a[68:69], v9 offset:17152
v_mfma_f32_16x16x32_bf16 v[100:103], a[44:47], a[28:31], v[100:103]
ds_read_b64_tr_b16 a[70:71], v9 offset:18176
v_add_u32 v9, s58, v203
v_mfma_f32_16x16x32_bf16 v[132:135], a[44:47], a[32:35], v[132:135]
ds_read_b64_tr_b16 a[40:41], v8 offset:0
s_add_u32 s58, s58, 53248
s_cmp_lt_u32 s58, 159744
s_cselect_b32 s58, s58, 0
v_mfma_f32_16x16x32_bf16 v[164:167], a[44:47], a[36:39], v[164:167]
ds_read_b64_tr_b16 a[42:43], v8 offset:1024
v_mfma_f32_16x16x32_bf16 v[40:43], a[48:51], a[20:23], v[40:43]
ds_read_b64_tr_b16 a[44:45], v9 offset:0
v_mfma_f32_16x16x32_bf16 v[72:75], a[48:51], a[24:27], v[72:75]
ds_read_b64_tr_b16 a[46:47], v9 offset:1024
v_mfma_f32_16x16x32_bf16 v[104:107], a[48:51], a[28:31], v[104:107]
v_mfma_f32_16x16x32_bf16 v[136:139], a[48:51], a[32:35], v[136:139]
v_mfma_f32_16x16x32_bf16 v[168:171], a[48:51], a[36:39], v[168:171]
ds_read_b64_tr_b16 a[48:49], v8 offset:256
v_mfma_f32_16x16x32_bf16 v[44:47], a[52:55], a[20:23], v[44:47]
ds_read_b64_tr_b16 a[50:51], v8 offset:1280
v_mfma_f32_16x16x32_bf16 v[76:79], a[52:55], a[24:27], v[76:79]
s_waitcnt vmcnt(22) lgkmcnt(6)
s_barrier
v_mfma_f32_16x16x32_bf16 v[108:111], a[52:55], a[28:31], v[108:111]
s_add_u32 m0, s52, 16384
v_mfma_f32_16x16x32_bf16 v[140:143], a[52:55], a[32:35], v[140:143]
buffer_load_dwordx4 v192, s[20:23], s50 offen lds
v_mfma_f32_16x16x32_bf16 v[172:175], a[52:55], a[36:39], v[172:175]
ds_read_b64_tr_b16 a[52:53], v9 offset:256
v_mfma_f32_16x16x32_bf16 v[48:51], a[56:59], a[20:23], v[48:51]
ds_read_b64_tr_b16 a[54:55], v9 offset:1280
v_mfma_f32_16x16x32_bf16 v[80:83], a[56:59], a[24:27], v[80:83]
buffer_load_dwordx4 v193, s[20:23], s50 offen offset:1024 lds
s_add_u32 m0, s52, 24576
v_mfma_f32_16x16x32_bf16 v[112:115], a[56:59], a[28:31], v[112:115]
s_add_u32 s52, s56, s59
s_add_u32 s56, s56, 53248
s_cmp_lt_u32 s56, 159744
s_cselect_b32 s56, s56, 0
v_mfma_f32_16x16x32_bf16 v[144:147], a[56:59], a[32:35], v[144:147]
v_mfma_f32_16x16x32_bf16 v[176:179], a[56:59], a[36:39], v[176:179]
buffer_load_dwordx4 v194, s[20:23], s50 offen lds
v_mfma_f32_16x16x32_bf16 v[52:55], a[60:63], a[20:23], v[52:55]
v_mfma_f32_16x16x32_bf16 v[84:87], a[60:63], a[24:27], v[84:87]
v_mfma_f32_16x16x32_bf16 v[116:119], a[60:63], a[28:31], v[116:119]
buffer_load_dwordx4 v195, s[20:23], s50 offen offset:1024 lds
s_add_u32 s50, s50, 262144
v_mfma_f32_16x16x32_bf16 v[148:151], a[60:63], a[32:35], v[148:151]
v_mfma_f32_16x16x32_bf16 v[180:183], a[60:63], a[36:39], v[180:183]
v_mfma_f32_16x16x32_bf16 v[56:59], a[64:67], a[20:23], v[56:59]
v_mfma_f32_16x16x32_bf16 v[88:91], a[64:67], a[24:27], v[88:91]
v_mfma_f32_16x16x32_bf16 v[120:123], a[64:67], a[28:31], v[120:123]
v_mfma_f32_16x16x32_bf16 v[152:155], a[64:67], a[32:35], v[152:155]
v_mfma_f32_16x16x32_bf16 v[184:187], a[64:67], a[36:39], v[184:187]
v_mfma_f32_16x16x32_bf16 v[60:63], a[68:71], a[20:23], v[60:63]
ds_read_b128 a[20:23], v10 offset:512
v_mfma_f32_16x16x32_bf16 v[92:95], a[68:71], a[24:27], v[92:95]
ds_read_b128 a[24:27], v10 offset:2560
v_mfma_f32_16x16x32_bf16 v[124:127], a[68:71], a[28:31], v[124:127]
ds_read_b128 a[28:31], v10 offset:4608
v_mfma_f32_16x16x32_bf16 v[156:159], a[68:71], a[32:35], v[156:159]
ds_read_b128 a[32:35], v10 offset:6656
v_mfma_f32_16x16x32_bf16 v[188:191], a[68:71], a[36:39], v[188:191]
ds_read_b128 a[36:39], v10 offset:8704
v_add_u32 v10, s57, v201
s_waitcnt lgkmcnt(5)
s_sub_u32 s41, s41, 1
s_cmp_lg_u32 s41, 0
s_cbranch_scc1 K1_L0
v_mfma_f32_16x16x32_bf16 v[32:35], a[40:43], a[0:3], v[32:35]
ds_read_b64_tr_b16 a[56:57], v8 offset:512
s_add_u32 s57, s57, 53248
s_cmp_lt_u32 s57, 159744
s_cselect_b32 s57, s57, 0
v_mfma_f32_16x16x32_bf16 v[64:67], a[40:43], a[4:7], v[64:67]
ds_read_b64_tr_b16 a[58:59], v8 offset:1536
v_mfma_f32_16x16x32_bf16 v[96:99], a[40:43], a[8:11], v[96:99]
ds_read_b64_tr_b16 a[60:61], v9 offset:512
v_mfma_f32_16x16x32_bf16 v[128:131], a[40:43], a[12:15], v[128:131]
ds_read_b64_tr_b16 a[62:63], v9 offset:1536
v_mfma_f32_16x16x32_bf16 v[160:163], a[40:43], a[16:19], v[160:163]
ds_read_b64_tr_b16 a[64:65], v8 offset:768
v_mfma_f32_16x16x32_bf16 v[36:39], a[44:47], a[0:3], v[36:39]
ds_read_b64_tr_b16 a[66:67], v8 offset:1792
v_mfma_f32_16x16x32_bf16 v[68:71], a[44:47], a[4:7], v[68:71]
ds_read_b64_tr_b16 a[68:69], v9 offset:768
v_mfma_f32_16x16x32_bf16 v[100:103], a[44:47], a[8:11], v[100:103]
ds_read_b64_tr_b16 a[70:71], v9 offset:1792
v_mfma_f32_16x16x32_bf16 v[132:135], a[44:47], a[12:15], v[132:135]
ds_read_b64_tr_b16 a[40:41], v8 offset:16384
v_mfma_f32_16x16x32_bf16 v[164:167], a[44:47], a[16:19], v[164:167]
ds_read_b64_tr_b16 a[42:43], v8 offset:17408
v_mfma_f32_16x16x32_bf16 v[40:43], a[48:51], a[0:3], v[40:43]
ds_read_b64_tr_b16 a[44:45], v9 offset:16384
v_mfma_f32_16x16x32_bf16 v[72:75], a[48:51], a[4:7], v[72:75]
ds_read_b64_tr_b16 a[46:47], v9 offset:17408
v_mfma_f32_16x16x32_bf16 v[104:107], a[48:51], a[8:11], v[104:107]
v_mfma_f32_16x16x32_bf16 v[136:139], a[48:51], a[12:15], v[136:139]
v_mfma_f32_16x16x32_bf16 v[168:171], a[48:51], a[16:19], v[168:171]
ds_read_b64_tr_b16 a[48:49], v8 offset:16640
v_mfma_f32_16x16x32_bf16 v[44:47], a[52:55], a[0:3], v[44:47]
ds_read_b64_tr_b16 a[50:51], v8 offset:17664
v_mfma_f32_16x16x32_bf16 v[76:79], a[52:55], a[4:7], v[76:79]
s_waitcnt vmcnt(17) lgkmcnt(6)
s_barrier
v_mfma_f32_16x16x32_bf16 v[108:111], a[52:55], a[8:11], v[108:111]
s_add_u32 m0, s52, 0
v_mfma_f32_16x16x32_bf16 v[140:143], a[52:55], a[12:15], v[140:143]
buffer_load_dwordx4 v192, s[20:23], s50 offen lds
v_mfma_f32_16x16x32_bf16 v[172:175], a[52:55], a[16:19], v[172:175]
ds_read_b64_tr_b16 a[52:53], v9 offset:16640
v_mfma_f32_16x16x32_bf16 v[48:51], a[56:59], a[0:3], v[48:51]
ds_read_b64_tr_b16 a[54:55], v9 offset:17664
v_mfma_f32_16x16x32_bf16 v[80:83], a[56:59], a[4:7], v[80:83]
buffer_load_dwordx4 v193, s[20:23], s50 offen offset:1024 lds
s_add_u32 m0, s52, 8192
v_mfma_f32_16x16x32_bf16 v[112:115], a[56:59], a[8:11], v[112:115]
v_mfma_f32_16x16x32_bf16 v[144:147], a[56:59], a[12:15], v[144:147]
v_mfma_f32_16x16x32_bf16 v[176:179], a[56:59], a[16:19], v[176:179]
buffer_load_dwordx4 v194, s[20:23], s50 offen lds
v_mfma_f32_16x16x32_bf16 v[52:55], a[60:63], a[0:3], v[52:55]
v_mfma_f32_16x16x32_bf16 v[84:87], a[60:63], a[4:7], v[84:87]
v_mfma_f32_16x16x32_bf16 v[116:119], a[60:63], a[8:11], v[116:119]
buffer_load_dwordx4 v195, s[20:23], s50 offen offset:1024 lds
s_add_u32 m0, s53, 0
v_mfma_f32_16x16x32_bf16 v[148:151], a[60:63], a[12:15], v[148:151]
s_add_u32 s50, s50, 262144
v_mfma_f32_16x16x32_bf16 v[180:183], a[60:63], a[16:19], v[180:183]
v_mfma_f32_16x16x32_bf16 v[56:59], a[64:67], a[0:3], v[56:59]
buffer_load_dwordx4 v196, s[8:11], s51 offen lds
v_mfma_f32_16x16x32_bf16 v[88:91], a[64:67], a[4:7], v[88:91]
v_mfma_f32_16x16x32_bf16 v[120:123], a[64:67], a[8:11], v[120:123]
v_mfma_f32_16x16x32_bf16 v[152:155], a[64:67], a[12:15], v[152:155]
buffer_load_dwordx4 v197, s[8:11], s51 offen offset:1024 lds
v_mfma_f32_16x16x32_bf16 v[184:187], a[64:67], a[16:19], v[184:187]
v_mfma_f32_16x16x32_bf16 v[60:63], a[68:71], a[0:3], v[60:63]
ds_read_b128 a[0:3], v10 offset:0
v_mfma_f32_16x16x32_bf16 v[92:95], a[68:71], a[4:7], v[92:95]
ds_read_b128 a[4:7], v10 offset:2048
buffer_load_dwordx4 v198, s[8:11], s51 offen offset:2048 lds
v_mfma_f32_16x16x32_bf16 v[124:127], a[68:71], a[8:11], v[124:127]
ds_read_b128 a[8:11], v10 offset:4096
v_mfma_f32_16x16x32_bf16 v[156:159], a[68:71], a[12:15], v[156:159]
ds_read_b128 a[12:15], v10 offset:6144
v_mfma_f32_16x16x32_bf16 v[188:191], a[68:71], a[16:19], v[188:191]
ds_read_b128 a[16:19], v10 offset:8192
buffer_load_dwordx4 v199, s[8:11], s51 offen offset:3072 lds
s_waitcnt lgkmcnt(5)
v_mfma_f32_16x16x32_bf16 v[32:35], a[40:43], a[20:23], v[32:35]
ds_read_b64_tr_b16 a[56:57], v8 offset:16896
s_add_u32 m0, s53, 4096
v_mfma_f32_16x16x32_bf16 v[64:67], a[40:43], a[24:27], v[64:67]
ds_read_b64_tr_b16 a[58:59], v8 offset:17920
s_add_u32 s53, s56, s60
v_mfma_f32_16x16x32_bf16 v[96:99], a[40:43], a[28:31], v[96:99]
buffer_load_dwordx4 v200, s[8:11], s51 offen lds
ds_read_b64_tr_b16 a[60:61], v9 offset:16896
v_mfma_f32_16x16x32_bf16 v[128:131], a[40:43], a[32:35], v[128:131]
ds_read_b64_tr_b16 a[62:63], v9 offset:17920
s_add_u32 s51, s51, 128
v_mfma_f32_16x16x32_bf16 v[160:163], a[40:43], a[36:39], v[160:163]
ds_read_b64_tr_b16 a[64:65], v8 offset:17152
v_mfma_f32_16x16x32_bf16 v[36:39], a[44:47], a[20:23], v[36:39]
ds_read_b64_tr_b16 a[66:67], v8 offset:18176
v_add_u32 v8, s58, v202
v_mfma_f32_16x16x32_bf16 v[68:71], a[44:47], a[24:27], v[68:71]
ds_read_b64_tr_b16 a[68:69], v9 offset:17152
v_mfma_f32_16x16x32_bf16 v[100:103], a[44:47], a[28:31], v[100:103]
ds_read_b64_tr_b16 a[70:71], v9 offset:18176
v_add_u32 v9, s58, v203
v_mfma_f32_16x16x32_bf16 v[132:135], a[44:47], a[32:35], v[132:135]
ds_read_b64_tr_b16 a[40:41], v8 offset:0
s_add_u32 s58, s58, 53248
s_cmp_lt_u32 s58, 159744
s_cselect_b32 s58, s58, 0
v_mfma_f32_16x16x32_bf16 v[164:167], a[44:47], a[36:39], v[164:167]
ds_read_b64_tr_b16 a[42:43], v8 offset:1024
v_mfma_f32_16x16x32_bf16 v[40:43], a[48:51], a[20:23], v[40:43]
ds_read_b64_tr_b16 a[44:45], v9 offset:0
v_mfma_f32_16x16x32_bf16 v[72:75], a[48:51], a[24:27], v[72:75]
ds_read_b64_tr_b16 a[46:47], v9 offset:1024
v_mfma_f32_16x16x32_bf16 v[104:107], a[48:51], a[28:31], v[104:107]
v_mfma_f32_16x16x32_bf16 v[136:139], a[48:51], a[32:35], v[136:139]
v_mfma_f32_16x16x32_bf16 v[168:171], a[48:51], a[36:39], v[168:171]
ds_read_b64_tr_b16 a[48:49], v8 offset:256
v_mfma_f32_16x16x32_bf16 v[44:47], a[52:55], a[20:23], v[44:47]
ds_read_b64_tr_b16 a[50:51], v8 offset:1280
v_mfma_f32_16x16x32_bf16 v[76:79], a[52:55], a[24:27], v[76:79]
s_waitcnt vmcnt(22) lgkmcnt(6)
s_barrier
v_mfma_f32_16x16x32_bf16 v[108:111], a[52:55], a[28:31], v[108:111]
s_add_u32 m0, s52, 16384
v_mfma_f32_16x16x32_bf16 v[140:143], a[52:55], a[32:35], v[140:143]
buffer_load_dwordx4 v192, s[20:23], s50 offen lds
v_mfma_f32_16x16x32_bf16 v[172:175], a[52:55], a[36:39], v[172:175]
ds_read_b64_tr_b16 a[52:53], v9 offset:256
v_mfma_f32_16x16x32_bf16 v[48:51], a[56:59], a[20:23], v[48:51]
ds_read_b64_tr_b16 a[54:55], v9 offset:1280
v_mfma_f32_16x16x32_bf16 v[80:83], a[56:59], a[24:27], v[80:83]
buffer_load_dwordx4 v193, s[20:23], s50 offen offset:1024 lds
s_add_u32 m0, s52, 24576
v_mfma_f32_16x16x32_bf16 v[112:115], a[56:59], a[28:31], v[112:115]
s_add_u32 s52, s56, s59
v_mfma_f32_16x16x32_bf16 v[144:147], a[56:59], a[32:35], v[144:147]
v_mfma_f32_16x16x32_bf16 v[176:179], a[56:59], a[36:39], v[176:179]
buffer_load_dwordx4 v194, s[20:23], s50 offen lds
v_mfma_f32_16x16x32_bf16 v[52:55], a[60:63], a[20:23], v[52:55]
v_mfma_f32_16x16x32_bf16 v[84:87], a[60:63], a[24:27], v[84:87]
v_mfma_f32_16x16x32_bf16 v[116:119], a[60:63], a[28:31], v[116:119]
buffer_load_dwordx4 v195, s[20:23], s50 offen offset:1024 lds
s_add_u32 s50, s50, 262144
v_mfma_f32_16x16x32_bf16 v[148:151], a[60:63], a[32:35], v[148:151]
v_mfma_f32_16x16x32_bf16 v[180:183], a[60:63], a[36:39], v[180:183]
v_mfma_f32_16x16x32_bf16 v[56:59], a[64:67], a[20:23], v[56:59]
v_mfma_f32_16x16x32_bf16 v[88:91], a[64:67], a[24:27], v[88:91]
v_mfma_f32_16x16x32_bf16 v[120:123], a[64:67], a[28:31], v[120:123]
v_mfma_f32_16x16x32_bf16 v[152:155], a[64:67], a[32:35], v[152:155]
v_mfma_f32_16x16x32_bf16 v[184:187], a[64:67], a[36:39], v[184:187]
v_mfma_f32_16x16x32_bf16 v[60:63], a[68:71], a[20:23], v[60:63]
ds_read_b128 a[20:23], v10 offset:512
v_mfma_f32_16x16x32_bf16 v[92:95], a[68:71], a[24:27], v[92:95]
ds_read_b128 a[24:27], v10 offset:2560
v_mfma_f32_16x16x32_bf16 v[124:127], a[68:71], a[28:31], v[124:127]
ds_read_b128 a[28:31], v10 offset:4608
v_mfma_f32_16x16x32_bf16 v[156:159], a[68:71], a[32:35], v[156:159]
ds_read_b128 a[32:35], v10 offset:6656
v_mfma_f32_16x16x32_bf16 v[188:191], a[68:71], a[36:39], v[188:191]
ds_read_b128 a[36:39], v10 offset:8704
v_add_u32 v10, s57, v201
s_waitcnt lgkmcnt(5)
v_mfma_f32_16x16x32_bf16 v[32:35], a[40:43], a[0:3], v[32:35]
ds_read_b64_tr_b16 a[56:57], v8 offset:512
s_add_u32 s57, s57, 53248
s_cmp_lt_u32 s57, 159744
s_cselect_b32 s57, s57, 0
v_mfma_f32_16x16x32_bf16 v[64:67], a[40:43], a[4:7], v[64:67]
ds_read_b64_tr_b16 a[58:59], v8 offset:1536
v_mfma_f32_16x16x32_bf16 v[96:99], a[40:43], a[8:11], v[96:99]
ds_read_b64_tr_b16 a[60:61], v9 offset:512
v_mfma_f32_16x16x32_bf16 v[128:131], a[40:43], a[12:15], v[128:131]
ds_read_b64_tr_b16 a[62:63], v9 offset:1536
v_mfma_f32_16x16x32_bf16 v[160:163], a[40:43], a[16:19], v[160:163]
ds_read_b64_tr_b16 a[64:65], v8 offset:768
v_mfma_f32_16x16x32_bf16 v[36:39], a[44:47], a[0:3], v[36:39]
ds_read_b64_tr_b16 a[66:67], v8 offset:1792
v_mfma_f32_16x16x32_bf16 v[68:71], a[44:47], a[4:7], v[68:71]
ds_read_b64_tr_b16 a[68:69], v9 offset:768
v_mfma_f32_16x16x32_bf16 v[100:103], a[44:47], a[8:11], v[100:103]
ds_read_b64_tr_b16 a[70:71], v9 offset:1792
v_mfma_f32_16x16x32_bf16 v[132:135], a[44:47], a[12:15], v[132:135]
ds_read_b64_tr_b16 a[40:41], v8 offset:16384
v_mfma_f32_16x16x32_bf16 v[164:167], a[44:47], a[16:19], v[164:167]
ds_read_b64_tr_b16 a[42:43], v8 offset:17408
v_mfma_f32_16x16x32_bf16 v[40:43], a[48:51], a[0:3], v[40:43]
ds_read_b64_tr_b16 a[44:45], v9 offset:16384
v_mfma_f32_16x16x32_bf16 v[72:75], a[48:51], a[4:7], v[72:75]
ds_read_b64_tr_b16 a[46:47], v9 offset:17408
v_mfma_f32_16x16x32_bf16 v[104:107], a[48:51], a[8:11], v[104:107]
v_mfma_f32_16x16x32_bf16 v[136:139], a[48:51], a[12:15], v[136:139]
v_mfma_f32_16x16x32_bf16 v[168:171], a[48:51], a[16:19], v[168:171]
ds_read_b64_tr_b16 a[48:49], v8 offset:16640
v_mfma_f32_16x16x32_bf16 v[44:47], a[52:55], a[0:3], v[44:47]
ds_read_b64_tr_b16 a[50:51], v8 offset:17664
v_mfma_f32_16x16x32_bf16 v[76:79], a[52:55], a[4:7], v[76:79]
s_waitcnt vmcnt(17) lgkmcnt(6)
s_barrier
v_mfma_f32_16x16x32_bf16 v[108:111], a[52:55], a[8:11], v[108:111]
v_mfma_f32_16x16x32_bf16 v[140:143], a[52:55], a[12:15], v[140:143]
v_mfma_f32_16x16x32_bf16 v[172:175], a[52:55], a[16:19], v[172:175]
ds_read_b64_tr_b16 a[52:53], v9 offset:16640
v_mfma_f32_16x16x32_bf16 v[48:51], a[56:59], a[0:3], v[48:51]
ds_read_b64_tr_b16 a[54:55], v9 offset:17664
v_mfma_f32_16x16x32_bf16 v[80:83], a[56:59], a[4:7], v[80:83]
v_mfma_f32_16x16x32_bf16 v[112:115], a[56:59], a[8:11], v[112:115]
v_mfma_f32_16x16x32_bf16 v[144:147], a[56:59], a[12:15], v[144:147]
v_mfma_f32_16x16x32_bf16 v[176:179], a[56:59], a[16:19], v[176:179]
v_mfma_f32_16x16x32_bf16 v[52:55], a[60:63], a[0:3], v[52:55]
v_mfma_f32_16x16x32_bf16 v[84:87], a[60:63], a[4:7], v[84:87]
v_mfma_f32_16x16x32_bf16 v[116:119], a[60:63], a[8:11], v[116:119]
v_mfma_f32_16x16x32_bf16 v[148:151], a[60:63], a[12:15], v[148:151]
v_mfma_f32_16x16x32_bf16 v[180:183], a[60:63], a[16:19], v[180:183]
v_mfma_f32_16x16x32_bf16 v[56:59], a[64:67], a[0:3], v[56:59]
v_mfma_f32_16x16x32_bf16 v[88:91], a[64:67], a[4:7], v[88:91]
v_mfma_f32_16x16x32_bf16 v[120:123], a[64:67], a[8:11], v[120:123]
v_mfma_f32_16x16x32_bf16 v[152:155], a[64:67], a[12:15], v[152:155]
v_mfma_f32_16x16x32_bf16 v[184:187], a[64:67], a[16:19], v[184:187]
v_mfma_f32_16x16x32_bf16 v[60:63], a[68:71], a[0:3], v[60:63]
ds_read_b128 a[0:3], v10 offset:0
v_mfma_f32_16x16x32_bf16 v[92:95], a[68:71], a[4:7], v[92:95]
ds_read_b128 a[4:7], v10 offset:2048
v_mfma_f32_16x16x32_bf16 v[124:127], a[68:71], a[8:11], v[124:127]
ds_read_b128 a[8:11], v10 offset:4096
v_mfma_f32_16x16x32_bf16 v[156:159], a[68:71], a[12:15], v[156:159]
ds_read_b128 a[12:15], v10 offset:6144
v_mfma_f32_16x16x32_bf16 v[188:191], a[68:71], a[16:19], v[188:191]
ds_read_b128 a[16:19], v10 offset:8192
s_waitcnt lgkmcnt(5)
v_mfma_f32_16x16x32_bf16 v[32:35], a[40:43], a[20:23], v[32:35]
ds_read_b64_tr_b16 a[56:57], v8 offset:16896
v_mfma_f32_16x16x32_bf16 v[64:67], a[40:43], a[24:27], v[64:67]
ds_read_b64_tr_b16 a[58:59], v8 offset:17920
v_mfma_f32_16x16x32_bf16 v[96:99], a[40:43], a[28:31], v[96:99]
ds_read_b64_tr_b16 a[60:61], v9 offset:16896
v_mfma_f32_16x16x32_bf16 v[128:131], a[40:43], a[32:35], v[128:131]
ds_read_b64_tr_b16 a[62:63], v9 offset:17920
v_mfma_f32_16x16x32_bf16 v[160:163], a[40:43], a[36:39], v[160:163]
ds_read_b64_tr_b16 a[64:65], v8 offset:17152
v_mfma_f32_16x16x32_bf16 v[36:39], a[44:47], a[20:23], v[36:39]
ds_read_b64_tr_b16 a[66:67], v8 offset:18176
v_add_u32 v8, s58, v202
v_mfma_f32_16x16x32_bf16 v[68:71], a[44:47], a[24:27], v[68:71]
ds_read_b64_tr_b16 a[68:69], v9 offset:17152
v_mfma_f32_16x16x32_bf16 v[100:103], a[44:47], a[28:31], v[100:103]
ds_read_b64_tr_b16 a[70:71], v9 offset:18176
v_add_u32 v9, s58, v203
v_mfma_f32_16x16x32_bf16 v[132:135], a[44:47], a[32:35], v[132:135]
ds_read_b64_tr_b16 a[40:41], v8 offset:0
s_add_u32 s58, s58, 53248
s_cmp_lt_u32 s58, 159744
s_cselect_b32 s58, s58, 0
v_mfma_f32_16x16x32_bf16 v[164:167], a[44:47], a[36:39], v[164:167]
ds_read_b64_tr_b16 a[42:43], v8 offset:1024
v_mfma_f32_16x16x32_bf16 v[40:43], a[48:51], a[20:23], v[40:43]
ds_read_b64_tr_b16 a[44:45], v9 offset:0
v_mfma_f32_16x16x32_bf16 v[72:75], a[48:51], a[24:27], v[72:75]
ds_read_b64_tr_b16 a[46:47], v9 offset:1024
v_mfma_f32_16x16x32_bf16 v[104:107], a[48:51], a[28:31], v[104:107]
v_mfma_f32_16x16x32_bf16 v[136:139], a[48:51], a[32:35], v[136:139]
v_mfma_f32_16x16x32_bf16 v[168:171], a[48:51], a[36:39], v[168:171]
ds_read_b64_tr_b16 a[48:49], v8 offset:256
v_mfma_f32_16x16x32_bf16 v[44:47], a[52:55], a[20:23], v[44:47]
ds_read_b64_tr_b16 a[50:51], v8 offset:1280
v_mfma_f32_16x16x32_bf16 v[76:79], a[52:55], a[24:27], v[76:79]
s_waitcnt vmcnt(13) lgkmcnt(6)
s_barrier
v_mfma_f32_16x16x32_bf16 v[108:111], a[52:55], a[28:31], v[108:111]
s_add_u32 m0, s38, 0
v_mfma_f32_16x16x32_bf16 v[140:143], a[52:55], a[32:35], v[140:143]
buffer_load_dwordx4 v5, s[12:15], s37 offen nt lds
v_mfma_f32_16x16x32_bf16 v[172:175], a[52:55], a[36:39], v[172:175]
ds_read_b64_tr_b16 a[52:53], v9 offset:256
v_mfma_f32_16x16x32_bf16 v[48:51], a[56:59], a[20:23], v[48:51]
ds_read_b64_tr_b16 a[54:55], v9 offset:1280
v_mfma_f32_16x16x32_bf16 v[80:83], a[56:59], a[24:27], v[80:83]
buffer_load_dwordx4 v5, s[12:15], s37 offen offset:1024 nt lds
s_add_u32 m0, s38, 4096
v_mfma_f32_16x16x32_bf16 v[112:115], a[56:59], a[28:31], v[112:115]
s_add_u32 s38, s38, 32768
s_and_b32 s38, s38, 0x1ffff
v_mfma_f32_16x16x32_bf16 v[144:147], a[56:59], a[32:35], v[144:147]
v_mfma_f32_16x16x32_bf16 v[176:179], a[56:59], a[36:39], v[176:179]
buffer_load_dwordx4 v5, s[12:15], s40 offen nt lds
v_mfma_f32_16x16x32_bf16 v[52:55], a[60:63], a[20:23], v[52:55]
v_mfma_f32_16x16x32_bf16 v[84:87], a[60:63], a[24:27], v[84:87]
v_mfma_f32_16x16x32_bf16 v[116:119], a[60:63], a[28:31], v[116:119]
buffer_load_dwordx4 v5, s[12:15], s40 offen offset:1024 nt lds
s_add_u32 m0, s39, 0
v_mfma_f32_16x16x32_bf16 v[148:151], a[60:63], a[32:35], v[148:151]
v_mfma_f32_16x16x32_bf16 v[180:183], a[60:63], a[36:39], v[180:183]
v_mfma_f32_16x16x32_bf16 v[56:59], a[64:67], a[20:23], v[56:59]
buffer_load_dwordx4 v6, s[16:19], s37 offen nt lds
v_mfma_f32_16x16x32_bf16 v[88:91], a[64:67], a[24:27], v[88:91]
v_mfma_f32_16x16x32_bf16 v[120:123], a[64:67], a[28:31], v[120:123]
v_mfma_f32_16x16x32_bf16 v[152:155], a[64:67], a[32:35], v[152:155]
buffer_load_dwordx4 v6, s[16:19], s37 offen offset:2048 nt lds
s_add_u32 m0, s39, 4096
v_mfma_f32_16x16x32_bf16 v[184:187], a[64:67], a[36:39], v[184:187]
s_add_u32 s37, s37, 8192
s_add_u32 s39, s39, 32768
s_and_b32 s39, s39, 0x1ffff
v_mfma_f32_16x16x32_bf16 v[60:63], a[68:71], a[20:23], v[60:63]
ds_read_b128 a[20:23], v10 offset:512
v_mfma_f32_16x16x32_bf16 v[92:95], a[68:71], a[24:27], v[92:95]
ds_read_b128 a[24:27], v10 offset:2560
buffer_load_dwordx4 v6, s[16:19], s40 offen nt lds
v_mfma_f32_16x16x32_bf16 v[124:127], a[68:71], a[28:31], v[124:127]
ds_read_b128 a[28:31], v10 offset:4608
v_mfma_f32_16x16x32_bf16 v[156:159], a[68:71], a[32:35], v[156:159]
ds_read_b128 a[32:35], v10 offset:6656
v_mfma_f32_16x16x32_bf16 v[188:191], a[68:71], a[36:39], v[188:191]
ds_read_b128 a[36:39], v10 offset:8704
buffer_load_dwordx4 v6, s[16:19], s40 offen offset:2048 nt lds
s_waitcnt lgkmcnt(5)
v_mfma_f32_16x16x32_bf16 v[32:35], a[40:43], a[0:3], v[32:35]
ds_read_b64_tr_b16 a[56:57], v8 offset:512
s_add_u32 s40, s40, 8192
v_mfma_f32_16x16x32_bf16 v[64:67], a[40:43], a[4:7], v[64:67]
ds_read_b64_tr_b16 a[58:59], v8 offset:1536
v_add_u32 v10, s57, v201
v_mfma_f32_16x16x32_bf16 v[96:99], a[40:43], a[8:11], v[96:99]
ds_read_b64_tr_b16 a[60:61], v9 offset:512
s_add_u32 s57, s57, 53248
s_cmp_lt_u32 s57, 159744
s_cselect_b32 s57, s57, 0
v_mfma_f32_16x16x32_bf16 v[128:131], a[40:43], a[12:15], v[128:131]
ds_read_b64_tr_b16 a[62:63], v9 offset:1536
v_mfma_f32_16x16x32_bf16 v[160:163], a[40:43], a[16:19], v[160:163]
ds_read_b64_tr_b16 a[64:65], v8 offset:768
v_mfma_f32_16x16x32_bf16 v[36:39], a[44:47], a[0:3], v[36:39]
ds_read_b64_tr_b16 a[66:67], v8 offset:1792
v_mfma_f32_16x16x32_bf16 v[68:71], a[44:47], a[4:7], v[68:71]
ds_read_b64_tr_b16 a[68:69], v9 offset:768
v_mfma_f32_16x16x32_bf16 v[100:103], a[44:47], a[8:11], v[100:103]
ds_read_b64_tr_b16 a[70:71], v9 offset:1792
v_mfma_f32_16x16x32_bf16 v[132:135], a[44:47], a[12:15], v[132:135]
ds_read_b64_tr_b16 a[40:41], v8 offset:16384
v_mfma_f32_16x16x32_bf16 v[164:167], a[44:47], a[16:19], v[164:167]
ds_read_b64_tr_b16 a[42:43], v8 offset:17408
v_mfma_f32_16x16x32_bf16 v[40:43], a[48:51], a[0:3], v[40:43]
ds_read_b64_tr_b16 a[44:45], v9 offset:16384
v_mfma_f32_16x16x32_bf16 v[72:75], a[48:51], a[4:7], v[72:75]
ds_read_b64_tr_b16 a[46:47], v9 offset:17408
v_mfma_f32_16x16x32_bf16 v[104:107], a[48:51], a[8:11], v[104:107]
v_mfma_f32_16x16x32_bf16 v[136:139], a[48:51], a[12:15], v[136:139]
v_mfma_f32_16x16x32_bf16 v[168:171], a[48:51], a[16:19], v[168:171]
ds_read_b64_tr_b16 a[48:49], v8 offset:16640
v_mfma_f32_16x16x32_bf16 v[44:47], a[52:55], a[0:3], v[44:47]
ds_read_b64_tr_b16 a[50:51], v8 offset:17664
v_mfma_f32_16x16x32_bf16 v[76:79], a[52:55], a[4:7], v[76:79]
s_waitcnt vmcnt(12) lgkmcnt(6)
s_barrier
v_mfma_f32_16x16x32_bf16 v[108:111], a[52:55], a[8:11], v[108:111]
s_add_u32 m0, s38, 0
v_mfma_f32_16x16x32_bf16 v[140:143], a[52:55], a[12:15], v[140:143]
buffer_load_dwordx4 v5, s[12:15], s37 offen nt lds
v_mfma_f32_16x16x32_bf16 v[172:175], a[52:55], a[16:19], v[172:175]
ds_read_b64_tr_b16 a[52:53], v9 offset:16640
v_mfma_f32_16x16x32_bf16 v[48:51], a[56:59], a[0:3], v[48:51]
ds_read_b64_tr_b16 a[54:55], v9 offset:17664
v_mfma_f32_16x16x32_bf16 v[80:83], a[56:59], a[4:7], v[80:83]
buffer_load_dwordx4 v5, s[12:15], s37 offen offset:1024 nt lds
s_add_u32 m0, s38, 4096
v_mfma_f32_16x16x32_bf16 v[112:115], a[56:59], a[8:11], v[112:115]
s_add_u32 s38, s38, 32768
s_and_b32 s38, s38, 0x1ffff
v_mfma_f32_16x16x32_bf16 v[144:147], a[56:59], a[12:15], v[144:147]
v_mfma_f32_16x16x32_bf16 v[176:179], a[56:59], a[16:19], v[176:179]
buffer_load_dwordx4 v5, s[12:15], s40 offen nt lds
v_mfma_f32_16x16x32_bf16 v[52:55], a[60:63], a[0:3], v[52:55]
v_mfma_f32_16x16x32_bf16 v[84:87], a[60:63], a[4:7], v[84:87]
v_mfma_f32_16x16x32_bf16 v[116:119], a[60:63], a[8:11], v[116:119]
buffer_load_dwordx4 v5, s[12:15], s40 offen offset:1024 nt lds
s_add_u32 m0, s39, 0
v_mfma_f32_16x16x32_bf16 v[148:151], a[60:63], a[12:15], v[148:151]
v_mfma_f32_16x16x32_bf16 v[180:183], a[60:63], a[16:19], v[180:183]
v_mfma_f32_16x16x32_bf16 v[56:59], a[64:67], a[0:3], v[56:59]
buffer_load_dwordx4 v6, s[16:19], s37 offen nt lds
v_mfma_f32_16x16x32_bf16 v[88:91], a[64:67], a[4:7], v[88:91]
v_mfma_f32_16x16x32_bf16 v[120:123], a[64:67], a[8:11], v[120:123]
v_mfma_f32_16x16x32_bf16 v[152:155], a[64:67], a[12:15], v[152:155]
buffer_load_dwordx4 v6, s[16:19], s37 offen offset:2048 nt lds
s_add_u32 m0, s39, 4096
v_mfma_f32_16x16x32_bf16 v[184:187], a[64:67], a[16:19], v[184:187]
s_add_u32 s37, s37, 8192
s_add_u32 s39, s39, 32768
s_and_b32 s39, s39, 0x1ffff
v_mfma_f32_16x16x32_bf16 v[60:63], a[68:71], a[0:3], v[60:63]
ds_read_b128 a[0:3], v10 offset:0
v_mfma_f32_16x16x32_bf16 v[92:95], a[68:71], a[4:7], v[92:95]
ds_read_b128 a[4:7], v10 offset:2048
buffer_load_dwordx4 v6, s[16:19], s40 offen nt lds
v_mfma_f32_16x16x32_bf16 v[124:127], a[68:71], a[8:11], v[124:127]
ds_read_b128 a[8:11], v10 offset:4096
v_mfma_f32_16x16x32_bf16 v[156:159], a[68:71], a[12:15], v[156:159]
ds_read_b128 a[12:15], v10 offset:6144
v_mfma_f32_16x16x32_bf16 v[188:191], a[68:71], a[16:19], v[188:191]
ds_read_b128 a[16:19], v10 offset:8192
buffer_load_dwordx4 v6, s[16:19], s40 offen offset:2048 nt lds
s_waitcnt lgkmcnt(5)
v_mfma_f32_16x16x32_bf16 v[32:35], a[40:43], a[20:23], v[32:35]
ds_read_b64_tr_b16 a[56:57], v8 offset:16896
s_add_u32 s40, s40, 8192
v_mfma_f32_16x16x32_bf16 v[64:67], a[40:43], a[24:27], v[64:67]
ds_read_b64_tr_b16 a[58:59], v8 offset:17920
v_mfma_f32_16x16x32_bf16 v[96:99], a[40:43], a[28:31], v[96:99]
ds_read_b64_tr_b16 a[60:61], v9 offset:16896
v_mfma_f32_16x16x32_bf16 v[128:131], a[40:43], a[32:35], v[128:131]
ds_read_b64_tr_b16 a[62:63], v9 offset:17920
v_mfma_f32_16x16x32_bf16 v[160:163], a[40:43], a[36:39], v[160:163]
ds_read_b64_tr_b16 a[64:65], v8 offset:17152
v_mfma_f32_16x16x32_bf16 v[36:39], a[44:47], a[20:23], v[36:39]
ds_read_b64_tr_b16 a[66:67], v8 offset:18176
v_add_u32 v8, s58, v202
v_mfma_f32_16x16x32_bf16 v[68:71], a[44:47], a[24:27], v[68:71]
ds_read_b64_tr_b16 a[68:69], v9 offset:17152
v_mfma_f32_16x16x32_bf16 v[100:103], a[44:47], a[28:31], v[100:103]
ds_read_b64_tr_b16 a[70:71], v9 offset:18176
v_add_u32 v9, s58, v203
v_mfma_f32_16x16x32_bf16 v[132:135], a[44:47], a[32:35], v[132:135]
ds_read_b64_tr_b16 a[40:41], v8 offset:0
s_add_u32 s58, s58, 53248
s_cmp_lt_u32 s58, 159744
s_cselect_b32 s58, s58, 0
v_mfma_f32_16x16x32_bf16 v[164:167], a[44:47], a[36:39], v[164:167]
ds_read_b64_tr_b16 a[42:43], v8 offset:1024
v_mfma_f32_16x16x32_bf16 v[40:43], a[48:51], a[20:23], v[40:43]
ds_read_b64_tr_b16 a[44:45], v9 offset:0
v_mfma_f32_16x16x32_bf16 v[72:75], a[48:51], a[24:27], v[72:75]
ds_read_b64_tr_b16 a[46:47], v9 offset:1024
v_mfma_f32_16x16x32_bf16 v[104:107], a[48:51], a[28:31], v[104:107]
v_mfma_f32_16x16x32_bf16 v[136:139], a[48:51], a[32:35], v[136:139]
v_mfma_f32_16x16x32_bf16 v[168:171], a[48:51], a[36:39], v[168:171]
ds_read_b64_tr_b16 a[48:49], v8 offset:256
v_mfma_f32_16x16x32_bf16 v[44:47], a[52:55], a[20:23], v[44:47]
ds_read_b64_tr_b16 a[50:51], v8 offset:1280
v_mfma_f32_16x16x32_bf16 v[76:79], a[52:55], a[24:27], v[76:79]
s_waitcnt vmcnt(16) lgkmcnt(6)
s_barrier
v_mfma_f32_16x16x32_bf16 v[108:111], a[52:55], a[28:31], v[108:111]
s_add_u32 m0, s38, 0
v_mfma_f32_16x16x32_bf16 v[140:143], a[52:55], a[32:35], v[140:143]
buffer_load_dwordx4 v5, s[12:15], s37 offen nt lds
v_mfma_f32_16x16x32_bf16 v[172:175], a[52:55], a[36:39], v[172:175]
ds_read_b64_tr_b16 a[52:53], v9 offset:256
v_mfma_f32_16x16x32_bf16 v[48:51], a[56:59], a[20:23], v[48:51]
ds_read_b64_tr_b16 a[54:55], v9 offset:1280
v_mfma_f32_16x16x32_bf16 v[80:83], a[56:59], a[24:27], v[80:83]
buffer_load_dwordx4 v5, s[12:15], s37 offen offset:1024 nt lds
s_add_u32 m0, s38, 4096
v_mfma_f32_16x16x32_bf16 v[112:115], a[56:59], a[28:31], v[112:115]
s_add_u32 s38, s38, 32768
s_and_b32 s38, s38, 0x1ffff
v_mfma_f32_16x16x32_bf16 v[144:147], a[56:59], a[32:35], v[144:147]
v_mfma_f32_16x16x32_bf16 v[176:179], a[56:59], a[36:39], v[176:179]
buffer_load_dwordx4 v5, s[12:15], s40 offen nt lds
v_mfma_f32_16x16x32_bf16 v[52:55], a[60:63], a[20:23], v[52:55]
v_mfma_f32_16x16x32_bf16 v[84:87], a[60:63], a[24:27], v[84:87]
v_mfma_f32_16x16x32_bf16 v[116:119], a[60:63], a[28:31], v[116:119]
buffer_load_dwordx4 v5, s[12:15], s40 offen offset:1024 nt lds
s_add_u32 m0, s39, 0
v_mfma_f32_16x16x32_bf16 v[148:151], a[60:63], a[32:35], v[148:151]
v_mfma_f32_16x16x32_bf16 v[180:183], a[60:63], a[36:39], v[180:183]
v_mfma_f32_16x16x32_bf16 v[56:59], a[64:67], a[20:23], v[56:59]
buffer_load_dwordx4 v6, s[16:19], s37 offen nt lds
v_mfma_f32_16x16x32_bf16 v[88:91], a[64:67], a[24:27], v[88:91]
v_mfma_f32_16x16x32_bf16 v[120:123], a[64:67], a[28:31], v[120:123]
v_mfma_f32_16x16x32_bf16 v[152:155], a[64:67], a[32:35], v[152:155]
buffer_load_dwordx4 v6, s[16:19], s37 offen offset:2048 nt lds
s_add_u32 m0, s39, 4096
v_mfma_f32_16x16x32_bf16 v[184:187], a[64:67], a[36:39], v[184:187]
s_add_u32 s37, s37, 8192
s_add_u32 s39, s39, 32768
s_and_b32 s39, s39, 0x1ffff
v_mfma_f32_16x16x32_bf16 v[60:63], a[68:71], a[20:23], v[60:63]
ds_read_b128 a[20:23], v10 offset:512
v_mfma_f32_16x16x32_bf16 v[92:95], a[68:71], a[24:27], v[92:95]
ds_read_b128 a[24:27], v10 offset:2560
buffer_load_dwordx4 v6, s[16:19], s40 offen nt lds
v_mfma_f32_16x16x32_bf16 v[124:127], a[68:71], a[28:31], v[124:127]
ds_read_b128 a[28:31], v10 offset:4608
v_mfma_f32_16x16x32_bf16 v[156:159], a[68:71], a[32:35], v[156:159]
ds_read_b128 a[32:35], v10 offset:6656
v_mfma_f32_16x16x32_bf16 v[188:191], a[68:71], a[36:39], v[188:191]
ds_read_b128 a[36:39], v10 offset:8704
buffer_load_dwordx4 v6, s[16:19], s40 offen offset:2048 nt lds
s_waitcnt lgkmcnt(5)
v_mfma_f32_16x16x32_bf16 v[32:35], a[40:43], a[0:3], v[32:35]
ds_read_b64_tr_b16 a[56:57], v8 offset:512
s_add_u32 s40, s40, 8192
v_mfma_f32_16x16x32_bf16 v[64:67], a[40:43], a[4:7], v[64:67]
ds_read_b64_tr_b16 a[58:59], v8 offset:1536
v_add_u32 v10, s57, v201
v_mfma_f32_16x16x32_bf16 v[96:99], a[40:43], a[8:11], v[96:99]
ds_read_b64_tr_b16 a[60:61], v9 offset:512
v_mfma_f32_16x16x32_bf16 v[128:131], a[40:43], a[12:15], v[128:131]
ds_read_b64_tr_b16 a[62:63], v9 offset:1536
v_mfma_f32_16x16x32_bf16 v[160:163], a[40:43], a[16:19], v[160:163]
ds_read_b64_tr_b16 a[64:65], v8 offset:768
v_mfma_f32_16x16x32_bf16 v[36:39], a[44:47], a[0:3], v[36:39]
ds_read_b64_tr_b16 a[66:67], v8 offset:1792
v_mfma_f32_16x16x32_bf16 v[68:71], a[44:47], a[4:7], v[68:71]
ds_read_b64_tr_b16 a[68:69], v9 offset:768
v_mfma_f32_16x16x32_bf16 v[100:103], a[44:47], a[8:11], v[100:103]
ds_read_b64_tr_b16 a[70:71], v9 offset:1792
v_mfma_f32_16x16x32_bf16 v[132:135], a[44:47], a[12:15], v[132:135]
ds_read_b64_tr_b16 a[40:41], v8 offset:16384
v_mfma_f32_16x16x32_bf16 v[164:167], a[44:47], a[16:19], v[164:167]
ds_read_b64_tr_b16 a[42:43], v8 offset:17408
v_mfma_f32_16x16x32_bf16 v[40:43], a[48:51], a[0:3], v[40:43]
ds_read_b64_tr_b16 a[44:45], v9 offset:16384
v_mfma_f32_16x16x32_bf16 v[72:75], a[48:51], a[4:7], v[72:75]
ds_read_b64_tr_b16 a[46:47], v9 offset:17408
v_mfma_f32_16x16x32_bf16 v[104:107], a[48:51], a[8:11], v[104:107]
v_mfma_f32_16x16x32_bf16 v[136:139], a[48:51], a[12:15], v[136:139]
v_mfma_f32_16x16x32_bf16 v[168:171], a[48:51], a[16:19], v[168:171]
ds_read_b64_tr_b16 a[48:49], v8 offset:16640
v_mfma_f32_16x16x32_bf16 v[44:47], a[52:55], a[0:3], v[44:47]
ds_read_b64_tr_b16 a[50:51], v8 offset:17664
v_mfma_f32_16x16x32_bf16 v[76:79], a[52:55], a[4:7], v[76:79]
v_mfma_f32_16x16x32_bf16 v[108:111], a[52:55], a[8:11], v[108:111]
v_mfma_f32_16x16x32_bf16 v[140:143], a[52:55], a[12:15], v[140:143]
v_mfma_f32_16x16x32_bf16 v[172:175], a[52:55], a[16:19], v[172:175]
ds_read_b64_tr_b16 a[52:53], v9 offset:16640
s_waitcnt lgkmcnt(7)
v_mfma_f32_16x16x32_bf16 v[48:51], a[56:59], a[0:3], v[48:51]
ds_read_b64_tr_b16 a[54:55], v9 offset:17664
v_mfma_f32_16x16x32_bf16 v[80:83], a[56:59], a[4:7], v[80:83]
v_mfma_f32_16x16x32_bf16 v[112:115], a[56:59], a[8:11], v[112:115]
v_mfma_f32_16x16x32_bf16 v[144:147], a[56:59], a[12:15], v[144:147]
v_mfma_f32_16x16x32_bf16 v[176:179], a[56:59], a[16:19], v[176:179]
ds_read_b64_tr_b16 a[56:57], v8 offset:16896
v_mfma_f32_16x16x32_bf16 v[52:55], a[60:63], a[0:3], v[52:55]
ds_read_b64_tr_b16 a[58:59], v8 offset:17920
v_mfma_f32_16x16x32_bf16 v[84:87], a[60:63], a[4:7], v[84:87]
v_mfma_f32_16x16x32_bf16 v[116:119], a[60:63], a[8:11], v[116:119]
v_mfma_f32_16x16x32_bf16 v[148:151], a[60:63], a[12:15], v[148:151]
v_mfma_f32_16x16x32_bf16 v[180:183], a[60:63], a[16:19], v[180:183]
ds_read_b64_tr_b16 a[60:61], v9 offset:16896
v_mfma_f32_16x16x32_bf16 v[56:59], a[64:67], a[0:3], v[56:59]
ds_read_b64_tr_b16 a[62:63], v9 offset:17920
v_mfma_f32_16x16x32_bf16 v[88:91], a[64:67], a[4:7], v[88:91]
v_mfma_f32_16x16x32_bf16 v[120:123], a[64:67], a[8:11], v[120:123]
v_mfma_f32_16x16x32_bf16 v[152:155], a[64:67], a[12:15], v[152:155]
v_mfma_f32_16x16x32_bf16 v[184:187], a[64:67], a[16:19], v[184:187]
ds_read_b64_tr_b16 a[64:65], v8 offset:17152
v_mfma_f32_16x16x32_bf16 v[60:63], a[68:71], a[0:3], v[60:63]
ds_read_b64_tr_b16 a[66:67], v8 offset:18176
v_add_u32 v8, s58, v202
v_mfma_f32_16x16x32_bf16 v[92:95], a[68:71], a[4:7], v[92:95]
v_mfma_f32_16x16x32_bf16 v[124:127], a[68:71], a[8:11], v[124:127]
v_mfma_f32_16x16x32_bf16 v[156:159], a[68:71], a[12:15], v[156:159]
v_mfma_f32_16x16x32_bf16 v[188:191], a[68:71], a[16:19], v[188:191]
ds_read_b64_tr_b16 a[68:69], v9 offset:17152
s_waitcnt lgkmcnt(5)
v_mfma_f32_16x16x32_bf16 v[32:35], a[40:43], a[20:23], v[32:35]
ds_read_b64_tr_b16 a[70:71], v9 offset:18176
v_add_u32 v9, s58, v203
v_mfma_f32_16x16x32_bf16 v[64:67], a[40:43], a[24:27], v[64:67]
v_mfma_f32_16x16x32_bf16 v[96:99], a[40:43], a[28:31], v[96:99]
s_nop 3
v_pk_mul_f32 v[32:33], v[32:33], s[48:49]
v_mfma_f32_16x16x32_bf16 v[128:131], a[40:43], a[32:35], v[128:131]
v_pk_mul_f32 v[34:35], v[34:35], s[48:49]
v_cvt_pk_bf16_f32 v24, v32, v33
v_mfma_f32_16x16x32_bf16 v[160:163], a[40:43], a[36:39], v[160:163]
v_cvt_pk_bf16_f32 v25, v34, v35
v_pk_mul_f32 v[64:65], v[64:65], s[48:49]
v_mfma_f32_16x16x32_bf16 v[36:39], a[44:47], a[20:23], v[36:39]
v_pk_mul_f32 v[66:67], v[66:67], s[48:49]
v_pk_mul_f32 v[96:97], v[96:97], s[48:49]
v_mfma_f32_16x16x32_bf16 v[68:71], a[44:47], a[24:27], v[68:71]
v_pk_mul_f32 v[98:99], v[98:99], s[48:49]
v_pk_mul_f32 v[128:129], v[128:129], s[48:49]
v_mfma_f32_16x16x32_bf16 v[100:103], a[44:47], a[28:31], v[100:103]
v_pk_mul_f32 v[130:131], v[130:131], s[48:49]
v_pk_mul_f32 v[160:161], v[160:161], s[48:49]
v_mfma_f32_16x16x32_bf16 v[132:135], a[44:47], a[32:35], v[132:135]
s_waitcnt vmcnt(16) lgkmcnt(0)
s_barrier
v_mfma_f32_16x16x32_bf16 v[164:167], a[44:47], a[36:39], v[164:167]
s_add_u32 m0, s38, 0
ds_read_b128 a[0:3], v2 offset:0
v_mfma_f32_16x16x32_bf16 v[40:43], a[48:51], a[20:23], v[40:43]
buffer_load_dwordx4 v5, s[12:15], s37 offen nt lds
ds_read_b128 a[4:7], v2 offset:256
v_mfma_f32_16x16x32_bf16 v[72:75], a[48:51], a[24:27], v[72:75]
v_pk_mul_f32 v[36:37], v[36:37], s[48:49]
ds_read_b128 a[8:11], v2 offset:512
v_mfma_f32_16x16x32_bf16 v[104:107], a[48:51], a[28:31], v[104:107]
v_pk_mul_f32 v[38:39], v[38:39], s[48:49]
ds_read_b128 a[12:15], v2 offset:768
v_mfma_f32_16x16x32_bf16 v[136:139], a[48:51], a[32:35], v[136:139]
buffer_load_dwordx4 v5, s[12:15], s37 offen offset:1024 nt lds
s_add_u32 m0, s38, 4096
v_mfma_f32_16x16x32_bf16 v[168:171], a[48:51], a[36:39], v[168:171]
ds_read_b128 a[16:19], v2 offset:4096
v_cvt_pk_bf16_f32 v26, v36, v37
v_mfma_f32_16x16x32_bf16 v[44:47], a[52:55], a[20:23], v[44:47]
v_cvt_pk_bf16_f32 v27, v38, v39
v_cndmask_b32 v32, v24, v26, s[42:43]
v_mfma_f32_16x16x32_bf16 v[76:79], a[52:55], a[24:27], v[76:79]
buffer_load_dwordx4 v5, s[12:15], s40 offen nt lds
v_cndmask_b32 v33, v25, v27, s[42:43]
v_mfma_f32_16x16x32_bf16 v[108:111], a[52:55], a[28:31], v[108:111]
v_cndmask_b32 v34, v26, v24, s[42:43]
v_cndmask_b32 v35, v27, v25, s[42:43]
v_mfma_f32_16x16x32_bf16 v[140:143], a[52:55], a[32:35], v[140:143]
v_accvgpr_write_b32 a96, v32
v_accvgpr_write_b32 a97, v33
v_mfma_f32_16x16x32_bf16 v[172:175], a[52:55], a[36:39], v[172:175]
buffer_load_dwordx4 v5, s[12:15], s40 offen offset:1024 nt lds
s_add_u32 m0, s39, 0
v_mfma_f32_16x16x32_bf16 v[48:51], a[56:59], a[20:23], v[48:51]
v_accvgpr_write_b32 a98, v34
v_accvgpr_write_b32 a99, v35
v_mfma_f32_16x16x32_bf16 v[80:83], a[56:59], a[24:27], v[80:83]
v_pk_mul_f32 v[40:41], v[40:41], s[48:49]
v_pk_mul_f32 v[42:43], v[42:43], s[48:49]
v_mfma_f32_16x16x32_bf16 v[112:115], a[56:59], a[28:31], v[112:115]
buffer_load_dwordx4 v6, s[16:19], s37 offen nt lds
v_pk_mul_f32 v[44:45], v[44:45], s[48:49]
v_mfma_f32_16x16x32_bf16 v[144:147], a[56:59], a[32:35], v[144:147]
v_pk_mul_f32 v[46:47], v[46:47], s[48:49]
v_cvt_pk_bf16_f32 v28, v40, v41
v_mfma_f32_16x16x32_bf16 v[176:179], a[56:59], a[36:39], v[176:179]
v_cvt_pk_bf16_f32 v29, v42, v43
v_cvt_pk_bf16_f32 v30, v44, v45
v_mfma_f32_16x16x32_bf16 v[52:55], a[60:63], a[20:23], v[52:55]
buffer_load_dwordx4 v6, s[16:19], s37 offen offset:2048 nt lds
s_add_u32 m0, s39, 4096
v_mfma_f32_16x16x32_bf16 v[84:87], a[60:63], a[24:27], v[84:87]
v_cvt_pk_bf16_f32 v31, v46, v47
v_cndmask_b32 v40, v28, v30, s[42:43]
v_mfma_f32_16x16x32_bf16 v[116:119], a[60:63], a[28:31], v[116:119]
v_cndmask_b32 v41, v29, v31, s[42:43]
v_cndmask_b32 v42, v30, v28, s[42:43]
v_mfma_f32_16x16x32_bf16 v[148:151], a[60:63], a[32:35], v[148:151]
buffer_load_dwordx4 v6, s[16:19], s40 offen nt lds
v_cndmask_b32 v43, v31, v29, s[42:43]
v_mfma_f32_16x16x32_bf16 v[180:183], a[60:63], a[36:39], v[180:183]
v_accvgpr_write_b32 a100, v40
v_accvgpr_write_b32 a101, v41
v_mfma_f32_16x16x32_bf16 v[56:59], a[64:67], a[20:23], v[56:59]
v_accvgpr_write_b32 a102, v42
v_accvgpr_write_b32 a103, v43
v_mfma_f32_16x16x32_bf16 v[88:91], a[64:67], a[24:27], v[88:91]
buffer_load_dwordx4 v6, s[16:19], s40 offen offset:2048 nt lds
v_pk_mul_f32 v[48:49], v[48:49], s[48:49]
v_mfma_f32_16x16x32_bf16 v[120:123], a[64:67], a[28:31], v[120:123]
v_pk_mul_f32 v[50:51], v[50:51], s[48:49]
v_pk_mul_f32 v[52:53], v[52:53], s[48:49]
v_mfma_f32_16x16x32_bf16 v[152:155], a[64:67], a[32:35], v[152:155]
v_pk_mul_f32 v[54:55], v[54:55], s[48:49]
v_cvt_pk_bf16_f32 v24, v48, v49
v_mfma_f32_16x16x32_bf16 v[184:187], a[64:67], a[36:39], v[184:187]
v_cvt_pk_bf16_f32 v25, v50, v51
v_cvt_pk_bf16_f32 v26, v52, v53
v_mfma_f32_16x16x32_bf16 v[60:63], a[68:71], a[20:23], v[60:63]
ds_read_b128 a[20:23], v2 offset:4352
v_cvt_pk_bf16_f32 v27, v54, v55
v_mfma_f32_16x16x32_bf16 v[92:95], a[68:71], a[24:27], v[92:95]
ds_read_b128 a[24:27], v2 offset:4608
v_cndmask_b32 v48, v24, v26, s[42:43]
v_mfma_f32_16x16x32_bf16 v[124:127], a[68:71], a[28:31], v[124:127]
ds_read_b128 a[28:31], v2 offset:4864
v_cndmask_b32 v49, v25, v27, s[42:43]
v_mfma_f32_16x16x32_bf16 v[156:159], a[68:71], a[32:35], v[156:159]
v_cndmask_b32 v50, v26, v24, s[42:43]
v_cndmask_b32 v51, v27, v25, s[42:43]
v_mfma_f32_16x16x32_bf16 v[188:191], a[68:71], a[36:39], v[188:191]
v_accvgpr_write_b32 a104, v48
v_accvgpr_write_b32 a105, v49
s_waitcnt lgkmcnt(3)
v_mfma_f32_16x16x32_bf16 v[232:235], a[0:3], a[96:99], 0
v_accvgpr_write_b32 a106, v50
v_accvgpr_write_b32 a107, v51
v_mfma_f32_16x16x32_bf16 v[232:235], a[4:7], a[100:103], v[232:235]
v_pk_mul_f32 v[56:57], v[56:57], s[48:49]
v_pk_mul_f32 v[58:59], v[58:59], s[48:49]
v_mfma_f32_16x16x32_bf16 v[232:235], a[8:11], a[104:107], v[232:235]
v_pk_mul_f32 v[60:61], v[60:61], s[48:49]
v_pk_mul_f32 v[62:63], v[62:63], s[48:49]
buffer_store_dword v12, off, s[28:31], s96 sc1
v_cvt_pk_bf16_f32 v28, v56, v57
v_cvt_pk_bf16_f32 v29, v58, v59
v_cvt_pk_bf16_f32 v30, v60, v61
v_cvt_pk_bf16_f32 v31, v62, v63
v_cndmask_b32 v56, v28, v30, s[42:43]
v_cndmask_b32 v57, v29, v31, s[42:43]
v_cndmask_b32 v58, v30, v28, s[42:43]
v_cndmask_b32 v59, v31, v29, s[42:43]
v_accvgpr_write_b32 a108, v56
v_accvgpr_write_b32 a109, v57
v_accvgpr_write_b32 a110, v58
v_accvgpr_write_b32 a111, v59
buffer_store_dword v12, off, s[28:31], s72 sc1
v_pk_mul_f32 v[68:69], v[68:69], s[48:49]
v_mfma_f32_16x16x32_bf16 v[232:235], a[12:15], a[108:111], v[232:235]
v_pk_mul_f32 v[70:71], v[70:71], s[48:49]
v_cvt_pk_bf16_f32 v24, v64, v65
v_mfma_f32_16x16x32_bf16 v[236:239], a[16:19], a[96:99], 0
v_cvt_pk_bf16_f32 v25, v66, v67
v_cvt_pk_bf16_f32 v26, v68, v69
s_waitcnt lgkmcnt(1)
v_mfma_f32_16x16x32_bf16 v[236:239], a[20:23], a[100:103], v[236:239]
v_cvt_pk_bf16_f32 v27, v70, v71
v_cndmask_b32 v64, v24, v26, s[42:43]
v_mfma_f32_16x16x32_bf16 v[236:239], a[24:27], a[104:107], v[236:239]
v_cndmask_b32 v65, v25, v27, s[42:43]
v_cndmask_b32 v66, v26, v24, s[42:43]
s_waitcnt lgkmcnt(0)
v_mfma_f32_16x16x32_bf16 v[236:239], a[28:31], a[108:111], v[236:239]
v_cndmask_b32 v67, v27, v25, s[42:43]
v_accvgpr_write_b32 a112, v64
v_accvgpr_write_b32 a113, v65
v_accvgpr_write_b32 a114, v66
v_accvgpr_write_b32 a115, v67
v_pk_mul_f32 v[72:73], v[72:73], s[48:49]
v_pk_mul_f32 v[74:75], v[74:75], s[48:49]
v_mfma_f32_16x16x32_bf16 v[240:243], a[0:3], a[112:115], 0
v_pk_mul_f32 v[76:77], v[76:77], s[48:49]
v_pk_mul_f32 v[78:79], v[78:79], s[48:49]
v_cvt_pk_bf16_f32 v28, v72, v73
v_cvt_pk_bf16_f32 v29, v74, v75
v_cvt_pk_bf16_f32 v30, v76, v77
v_cvt_pk_bf16_f32 v31, v78, v79
v_cndmask_b32 v72, v28, v30, s[42:43]
v_cndmask_b32 v73, v29, v31, s[42:43]
v_cndmask_b32 v74, v30, v28, s[42:43]
v_cndmask_b32 v75, v31, v29, s[42:43]
v_accvgpr_write_b32 a116, v72
v_accvgpr_write_b32 a117, v73
v_accvgpr_write_b32 a118, v74
v_accvgpr_write_b32 a119, v75
v_pk_mul_f32 v[80:81], v[80:81], s[48:49]
v_pk_mul_f32 v[82:83], v[82:83], s[48:49]
v_mfma_f32_16x16x32_bf16 v[240:243], a[4:7], a[116:119], v[240:243]
v_pk_mul_f32 v[84:85], v[84:85], s[48:49]
v_pk_mul_f32 v[86:87], v[86:87], s[48:49]
v_cvt_pk_bf16_f32 v24, v80, v81
v_cvt_pk_bf16_f32 v25, v82, v83
v_cvt_pk_bf16_f32 v26, v84, v85
v_cvt_pk_bf16_f32 v27, v86, v87
v_cndmask_b32 v80, v24, v26, s[42:43]
v_cndmask_b32 v81, v25, v27, s[42:43]
v_cndmask_b32 v82, v26, v24, s[42:43]
v_cndmask_b32 v83, v27, v25, s[42:43]
v_accvgpr_write_b32 a120, v80
v_accvgpr_write_b32 a121, v81
v_accvgpr_write_b32 a122, v82
v_accvgpr_write_b32 a123, v83
v_pk_mul_f32 v[88:89], v[88:89], s[48:49]
v_pk_mul_f32 v[90:91], v[90:91], s[48:49]
v_mfma_f32_16x16x32_bf16 v[240:243], a[8:11], a[120:123], v[240:243]
v_pk_mul_f32 v[92:93], v[92:93], s[48:49]
v_pk_mul_f32 v[94:95], v[94:95], s[48:49]
v_cvt_pk_bf16_f32 v28, v88, v89
v_cvt_pk_bf16_f32 v29, v90, v91
v_cvt_pk_bf16_f32 v30, v92, v93
v_cvt_pk_bf16_f32 v31, v94, v95
v_cndmask_b32 v88, v28, v30, s[42:43]
v_cndmask_b32 v89, v29, v31, s[42:43]
v_cndmask_b32 v90, v30, v28, s[42:43]
v_cndmask_b32 v91, v31, v29, s[42:43]
v_accvgpr_write_b32 a124, v88
v_accvgpr_write_b32 a125, v89
v_accvgpr_write_b32 a126, v90
v_accvgpr_write_b32 a127, v91
v_pk_mul_f32 v[100:101], v[100:101], s[48:49]
v_pk_mul_f32 v[102:103], v[102:103], s[48:49]
v_mfma_f32_16x16x32_bf16 v[240:243], a[12:15], a[124:127], v[240:243]
v_cvt_pk_bf16_f32 v24, v96, v97
v_cvt_pk_bf16_f32 v25, v98, v99
v_mfma_f32_16x16x32_bf16 v[244:247], a[16:19], a[112:115], 0
v_cvt_pk_bf16_f32 v26, v100, v101
v_cvt_pk_bf16_f32 v27, v102, v103
v_mfma_f32_16x16x32_bf16 v[244:247], a[20:23], a[116:119], v[244:247]
v_cndmask_b32 v96, v24, v26, s[42:43]
v_cndmask_b32 v97, v25, v27, s[42:43]
v_mfma_f32_16x16x32_bf16 v[244:247], a[24:27], a[120:123], v[244:247]
v_cndmask_b32 v98, v26, v24, s[42:43]
v_cndmask_b32 v99, v27, v25, s[42:43]
v_mfma_f32_16x16x32_bf16 v[244:247], a[28:31], a[124:127], v[244:247]
v_pk_mul_f32 v[112:113], v[112:113], s[48:49]
v_pk_mul_f32 v[114:115], v[114:115], s[48:49]
v_pk_mul_f32 v[116:117], v[116:117], s[48:49]
v_pk_mul_f32 v[118:119], v[118:119], s[48:49]
v_cvt_pk_bf16_f32 v24, v112, v113
v_cvt_pk_bf16_f32 v25, v114, v115
v_cvt_pk_bf16_f32 v26, v116, v117
v_cvt_pk_bf16_f32 v27, v118, v119
v_cndmask_b32 v112, v24, v26, s[42:43]
v_cndmask_b32 v113, v25, v27, s[42:43]
v_cndmask_b32 v114, v26, v24, s[42:43]
v_cndmask_b32 v115, v27, v25, s[42:43]
v_pk_mul_f32 v[132:133], v[132:133], s[48:49]
v_pk_mul_f32 v[134:135], v[134:135], s[48:49]
v_cvt_pk_bf16_f32 v24, v128, v129
v_cvt_pk_bf16_f32 v25, v130, v131
v_cvt_pk_bf16_f32 v26, v132, v133
v_cvt_pk_bf16_f32 v27, v134, v135
v_cndmask_b32 v128, v24, v26, s[42:43]
v_cndmask_b32 v129, v25, v27, s[42:43]
v_cndmask_b32 v130, v26, v24, s[42:43]
v_cndmask_b32 v131, v27, v25, s[42:43]
v_pk_mul_f32 v[144:145], v[144:145], s[48:49]
v_pk_mul_f32 v[146:147], v[146:147], s[48:49]
v_pk_mul_f32 v[148:149], v[148:149], s[48:49]
v_pk_mul_f32 v[150:151], v[150:151], s[48:49]
v_cvt_pk_bf16_f32 v24, v144, v145
v_cvt_pk_bf16_f32 v25, v146, v147
v_cvt_pk_bf16_f32 v26, v148, v149
v_cvt_pk_bf16_f32 v27, v150, v151
v_cndmask_b32 v144, v24, v26, s[42:43]
v_cndmask_b32 v145, v25, v27, s[42:43]
v_cndmask_b32 v146, v26, v24, s[42:43]
v_cndmask_b32 v147, v27, v25, s[42:43]
v_pk_mul_f32 v[162:163], v[162:163], s[48:49]
v_pk_mul_f32 v[164:165], v[164:165], s[48:49]
v_pk_mul_f32 v[166:167], v[166:167], s[48:49]
v_cvt_pk_bf16_f32 v24, v160, v161
v_cvt_pk_bf16_f32 v25, v162, v163
v_cvt_pk_bf16_f32 v26, v164, v165
v_cvt_pk_bf16_f32 v27, v166, v167
v_cndmask_b32 v160, v24, v26, s[42:43]
v_cndmask_b32 v161, v25, v27, s[42:43]
v_cndmask_b32 v162, v26, v24, s[42:43]
v_cndmask_b32 v163, v27, v25, s[42:43]
v_pk_mul_f32 v[176:177], v[176:177], s[48:49]
v_pk_mul_f32 v[178:179], v[178:179], s[48:49]
v_pk_mul_f32 v[180:181], v[180:181], s[48:49]
v_cvt_pk_bf16_f32 v24, v176, v177
v_cvt_pk_bf16_f32 v25, v178, v179
v_cvt_pk_bf16_f32 v26, v180, v181
v_accvgpr_write_b32 a128, v96
v_accvgpr_write_b32 a129, v97
v_accvgpr_write_b32 a130, v98
v_accvgpr_write_b32 a131, v99
v_cndmask_b32 v176, v24, v26, s[42:43]
v_cndmask_b32 v178, v26, v24, s[42:43]
v_pk_mul_f32 v[104:105], v[104:105], s[48:49]
v_pk_mul_f32 v[106:107], v[106:107], s[48:49]
v_pk_mul_f32 v[108:109], v[108:109], s[48:49]
v_pk_mul_f32 v[110:111], v[110:111], s[48:49]
v_max3_f32 v24, v232, v233, v234
v_cvt_pk_bf16_f32 v28, v104, v105
v_cvt_pk_bf16_f32 v29, v106, v107
v_cvt_pk_bf16_f32 v30, v108, v109
v_cvt_pk_bf16_f32 v31, v110, v111
v_max3_f32 v24, v24, v235, v236
v_mfma_f32_16x16x32_bf16 v[232:235], a[0:3], a[128:131], 0
v_cndmask_b32 v104, v28, v30, s[42:43]
v_cndmask_b32 v105, v29, v31, s[42:43]
v_cndmask_b32 v106, v30, v28, s[42:43]
v_cndmask_b32 v107, v31, v29, s[42:43]
v_accvgpr_write_b32 a132, v104
v_accvgpr_write_b32 a133, v105
v_accvgpr_write_b32 a134, v106
v_accvgpr_write_b32 a135, v107
v_accvgpr_write_b32 a136, v112
v_accvgpr_write_b32 a137, v113
v_mfma_f32_16x16x32_bf16 v[232:235], a[4:7], a[132:135], v[232:235]
v_accvgpr_write_b32 a138, v114
v_accvgpr_write_b32 a139, v115
v_pk_mul_f32 v[120:121], v[120:121], s[48:49]
v_pk_mul_f32 v[122:123], v[122:123], s[48:49]
v_mfma_f32_16x16x32_bf16 v[232:235], a[8:11], a[136:139], v[232:235]
v_pk_mul_f32 v[124:125], v[124:125], s[48:49]
v_pk_mul_f32 v[126:127], v[126:127], s[48:49]
v_cvt_pk_bf16_f32 v28, v120, v121
v_cvt_pk_bf16_f32 v29, v122, v123
v_cvt_pk_bf16_f32 v30, v124, v125
v_cvt_pk_bf16_f32 v31, v126, v127
v_cndmask_b32 v120, v28, v30, s[42:43]
v_cndmask_b32 v121, v29, v31, s[42:43]
v_cndmask_b32 v122, v30, v28, s[42:43]
v_cndmask_b32 v123, v31, v29, s[42:43]
v_accvgpr_write_b32 a140, v120
v_accvgpr_write_b32 a141, v121
v_accvgpr_write_b32 a142, v122
v_accvgpr_write_b32 a143, v123
v_max3_f32 v24, v24, v237, v238
v_max_f32 v24, v24, v239
v_mfma_f32_16x16x32_bf16 v[232:235], a[12:15], a[140:143], v[232:235]
v_accvgpr_write_b32 a144, v128
v_accvgpr_write_b32 a145, v129
v_mfma_f32_16x16x32_bf16 v[236:239], a[16:19], a[128:131], 0
v_accvgpr_write_b32 a146, v130
v_accvgpr_write_b32 a147, v131
v_mfma_f32_16x16x32_bf16 v[236:239], a[20:23], a[132:135], v[236:239]
v_pk_mul_f32 v[136:137], v[136:137], s[48:49]
v_pk_mul_f32 v[138:139], v[138:139], s[48:49]
v_mfma_f32_16x16x32_bf16 v[236:239], a[24:27], a[136:139], v[236:239]
v_pk_mul_f32 v[140:141], v[140:141], s[48:49]
v_pk_mul_f32 v[142:143], v[142:143], s[48:49]
v_mfma_f32_16x16x32_bf16 v[236:239], a[28:31], a[140:143], v[236:239]
v_max3_f32 v26, v240, v241, v242
v_cvt_pk_bf16_f32 v28, v136, v137
v_cvt_pk_bf16_f32 v29, v138, v139
v_cvt_pk_bf16_f32 v30, v140, v141
v_cvt_pk_bf16_f32 v31, v142, v143
v_max3_f32 v26, v26, v243, v244
v_mfma_f32_16x16x32_bf16 v[240:243], a[0:3], a[144:147], 0
v_cndmask_b32 v136, v28, v30, s[42:43]
v_cndmask_b32 v137, v29, v31, s[42:43]
v_cndmask_b32 v138, v30, v28, s[42:43]
v_cndmask_b32 v139, v31, v29, s[42:43]
v_accvgpr_write_b32 a148, v136
v_accvgpr_write_b32 a149, v137
v_accvgpr_write_b32 a150, v138
v_accvgpr_write_b32 a151, v139
v_accvgpr_write_b32 a152, v144
v_accvgpr_write_b32 a153, v145
v_mfma_f32_16x16x32_bf16 v[240:243], a[4:7], a[148:151], v[240:243]
v_accvgpr_write_b32 a154, v146
v_accvgpr_write_b32 a155, v147
v_pk_mul_f32 v[152:153], v[152:153], s[48:49]
v_pk_mul_f32 v[154:155], v[154:155], s[48:49]
v_mfma_f32_16x16x32_bf16 v[240:243], a[8:11], a[152:155], v[240:243]
v_pk_mul_f32 v[156:157], v[156:157], s[48:49]
v_pk_mul_f32 v[158:159], v[158:159], s[48:49]
v_cvt_pk_bf16_f32 v28, v152, v153
v_cvt_pk_bf16_f32 v29, v154, v155
v_cvt_pk_bf16_f32 v30, v156, v157
v_cvt_pk_bf16_f32 v31, v158, v159
v_cndmask_b32 v152, v28, v30, s[42:43]
v_cndmask_b32 v153, v29, v31, s[42:43]
v_cndmask_b32 v154, v30, v28, s[42:43]
v_cndmask_b32 v155, v31, v29, s[42:43]
v_accvgpr_write_b32 a156, v152
v_accvgpr_write_b32 a157, v153
v_accvgpr_write_b32 a158, v154
v_accvgpr_write_b32 a159, v155
v_max3_f32 v26, v26, v245, v246
v_max_f32 v26, v26, v247
v_mfma_f32_16x16x32_bf16 v[240:243], a[12:15], a[156:159], v[240:243]
v_pk_mul_f32 v[182:183], v[182:183], s[48:49]
v_cvt_pk_bf16_f32 v27, v182, v183
v_mfma_f32_16x16x32_bf16 v[244:247], a[16:19], a[144:147], 0
v_cndmask_b32 v177, v25, v27, s[42:43]
v_cndmask_b32 v179, v27, v25, s[42:43]
v_mfma_f32_16x16x32_bf16 v[244:247], a[20:23], a[148:151], v[244:247]
v_mov_b32 v25, v24
v_accvgpr_write_b32 a160, v160
v_mfma_f32_16x16x32_bf16 v[244:247], a[24:27], a[152:155], v[244:247]
v_permlane32_swap_b32 v24, v25
v_max_f32 v24, v24, v25
v_mfma_f32_16x16x32_bf16 v[244:247], a[28:31], a[156:159], v[244:247]
v_mov_b32 v25, v24
v_accvgpr_write_b32 a161, v161
v_accvgpr_write_b32 a162, v162
v_permlane16_swap_b32 v24, v25
v_max_f32 v24, v24, v25
v_accvgpr_write_b32 a163, v163
v_sub_f32 v212, 0xc2200000, v24
v_sub_f32 v213, 0xc2200000, v24
v_sub_f32 v214, 0xc2200000, v24
v_sub_f32 v215, 0xc2200000, v24
v_pk_mul_f32 v[168:169], v[168:169], s[48:49]
v_pk_mul_f32 v[170:171], v[170:171], s[48:49]
v_pk_mul_f32 v[172:173], v[172:173], s[48:49]
v_pk_mul_f32 v[174:175], v[174:175], s[48:49]
v_max3_f32 v24, v232, v233, v234
v_cvt_pk_bf16_f32 v28, v168, v169
v_cvt_pk_bf16_f32 v29, v170, v171
v_cvt_pk_bf16_f32 v30, v172, v173
v_cvt_pk_bf16_f32 v31, v174, v175
v_max3_f32 v24, v24, v235, v236
v_mfma_f32_16x16x32_bf16 v[232:235], a[0:3], a[160:163], 0
v_cndmask_b32 v168, v28, v30, s[42:43]
v_cndmask_b32 v169, v29, v31, s[42:43]
v_cndmask_b32 v170, v30, v28, s[42:43]
v_cndmask_b32 v171, v31, v29, s[42:43]
v_accvgpr_write_b32 a164, v168
v_accvgpr_write_b32 a165, v169
v_accvgpr_write_b32 a166, v170
v_accvgpr_write_b32 a167, v171
v_accvgpr_write_b32 a168, v176
v_accvgpr_write_b32 a169, v177
v_mfma_f32_16x16x32_bf16 v[232:235], a[4:7], a[164:167], v[232:235]
v_accvgpr_write_b32 a170, v178
v_accvgpr_write_b32 a171, v179
v_pk_mul_f32 v[184:185], v[184:185], s[48:49]
v_pk_mul_f32 v[186:187], v[186:187], s[48:49]
v_mfma_f32_16x16x32_bf16 v[232:235], a[8:11], a[168:171], v[232:235]
v_pk_mul_f32 v[188:189], v[188:189], s[48:49]
v_pk_mul_f32 v[190:191], v[190:191], s[48:49]
v_cvt_pk_bf16_f32 v28, v184, v185
v_cvt_pk_bf16_f32 v29, v186, v187
v_cvt_pk_bf16_f32 v30, v188, v189
v_cvt_pk_bf16_f32 v31, v190, v191
v_cndmask_b32 v184, v28, v30, s[42:43]
v_cndmask_b32 v185, v29, v31, s[42:43]
v_cndmask_b32 v186, v30, v28, s[42:43]
v_cndmask_b32 v187, v31, v29, s[42:43]
v_accvgpr_write_b32 a172, v184
v_accvgpr_write_b32 a173, v185
v_accvgpr_write_b32 a174, v186
v_accvgpr_write_b32 a175, v187
v_max3_f32 v24, v24, v237, v238
v_max_f32 v24, v24, v239
v_mfma_f32_16x16x32_bf16 v[232:235], a[12:15], a[172:175], v[232:235]
v_mov_b32 v27, v26
v_mov_b32 v25, v24
v_mfma_f32_16x16x32_bf16 v[236:239], a[16:19], a[160:163], 0
v_permlane32_swap_b32 v26, v27
v_max_f32 v26, v26, v27
v_mfma_f32_16x16x32_bf16 v[236:239], a[20:23], a[164:167], v[236:239]
v_mov_b32 v27, v26
v_permlane32_swap_b32 v24, v25
v_mfma_f32_16x16x32_bf16 v[236:239], a[24:27], a[168:171], v[236:239]
v_permlane16_swap_b32 v26, v27
v_max_f32 v26, v26, v27
v_mfma_f32_16x16x32_bf16 v[236:239], a[28:31], a[172:175], v[236:239]
v_sub_f32 v216, 0xc2200000, v26
v_sub_f32 v217, 0xc2200000, v26
v_sub_f32 v218, 0xc2200000, v26
v_sub_f32 v219, 0xc2200000, v26
v_max3_f32 v26, v240, v241, v242
v_max3_f32 v26, v26, v243, v244
v_mfma_f32_16x16x32_bf16 v[240:243], a[0:3], a[96:99], v[212:215]
v_max3_f32 v26, v26, v245, v246
v_max_f32 v26, v26, v247
v_mfma_f32_16x16x32_bf16 v[240:243], a[4:7], a[100:103], v[240:243]
v_max_f32 v24, v24, v25
v_mov_b32 v25, v24
v_mfma_f32_16x16x32_bf16 v[240:243], a[8:11], a[104:107], v[240:243]
ds_read_b64_tr_b16 a[32:33], v3 offset:16384
v_permlane16_swap_b32 v24, v25
v_mfma_f32_16x16x32_bf16 v[240:243], a[12:15], a[108:111], v[240:243]
v_max_f32 v24, v24, v25
ds_read_b64_tr_b16 a[34:35], v3 offset:20480
v_mfma_f32_16x16x32_bf16 v[244:247], a[16:19], a[96:99], v[212:215]
v_sub_f32 v220, 0xc2200000, v24
v_sub_f32 v221, 0xc2200000, v24
v_mfma_f32_16x16x32_bf16 v[244:247], a[20:23], a[100:103], v[244:247]
v_sub_f32 v222, 0xc2200000, v24
v_sub_f32 v223, 0xc2200000, v24
v_mfma_f32_16x16x32_bf16 v[244:247], a[24:27], a[104:107], v[244:247]
v_max3_f32 v24, v232, v233, v234
ds_read_b64_tr_b16 a[36:37], v4 offset:16384
v_mfma_f32_16x16x32_bf16 v[244:247], a[28:31], a[108:111], v[244:247]
v_max3_f32 v24, v24, v235, v236
ds_read_b64_tr_b16 a[38:39], v4 offset:20480
v_mfma_f32_16x16x32_bf16 v[232:235], a[0:3], a[112:115], v[216:219]
ds_read_b64_tr_b16 a[40:41], v3 offset:16640
v_max3_f32 v24, v24, v237, v238
v_mfma_f32_16x16x32_bf16 v[232:235], a[4:7], a[116:119], v[232:235]
ds_read_b64_tr_b16 a[42:43], v3 offset:20736
v_max_f32 v24, v24, v239
v_mfma_f32_16x16x32_bf16 v[232:235], a[8:11], a[120:123], v[232:235]
ds_read_b64_tr_b16 a[44:45], v4 offset:16640
v_mov_b32 v27, v26
v_mfma_f32_16x16x32_bf16 v[232:235], a[12:15], a[124:127], v[232:235]
ds_read_b64_tr_b16 a[46:47], v4 offset:20736
v_permlane32_swap_b32 v26, v27
v_mfma_f32_16x16x32_bf16 v[236:239], a[16:19], a[112:115], v[216:219]
ds_read_b64_tr_b16 a[48:49], v3 offset:16896
v_max_f32 v26, v26, v27
v_mfma_f32_16x16x32_bf16 v[236:239], a[20:23], a[116:119], v[236:239]
ds_read_b64_tr_b16 a[50:51], v3 offset:20992
v_mov_b32 v27, v26
v_mfma_f32_16x16x32_bf16 v[236:239], a[24:27], a[120:123], v[236:239]
ds_read_b64_tr_b16 a[52:53], v4 offset:16896
v_permlane16_swap_b32 v26, v27
v_mfma_f32_16x16x32_bf16 v[236:239], a[28:31], a[124:127], v[236:239]
s_waitcnt vmcnt(18)
s_barrier
ds_read_b64_tr_b16 a[54:55], v4 offset:20992
v_exp_f32 v240, v240
ds_read_b64_tr_b16 a[56:57], v3 offset:17152
v_exp_f32 v241, v241
ds_read_b64_tr_b16 a[58:59], v3 offset:21248
v_exp_f32 v242, v242
ds_read_b64_tr_b16 a[60:61], v4 offset:17152
v_exp_f32 v243, v243
ds_read_b64_tr_b16 a[62:63], v4 offset:21248
v_exp_f32 v244, v244
v_exp_f32 v245, v245
v_exp_f32 v246, v246
v_exp_f32 v247, v247
v_cvt_pk_bf16_f32 v252, v240, v241
v_cvt_pk_bf16_f32 v253, v242, v243
v_cvt_pk_bf16_f32 v254, v244, v245
v_cvt_pk_bf16_f32 v255, v246, v247
v_exp_f32 v232, v232
s_waitcnt lgkmcnt(10)
v_mfma_f32_16x16x32_bf16 v[32:35], a[32:35], v[252:255], 0
v_exp_f32 v233, v233
v_mfma_f32_16x16x32_bf16 v[36:39], a[36:39], v[252:255], 0
v_exp_f32 v234, v234
v_mfma_f32_16x16x32_bf16 v[40:43], a[40:43], v[252:255], 0
v_exp_f32 v235, v235
s_waitcnt lgkmcnt(6)
v_mfma_f32_16x16x32_bf16 v[44:47], a[44:47], v[252:255], 0
v_exp_f32 v236, v236
v_mfma_f32_16x16x32_bf16 v[48:51], a[48:51], v[252:255], 0
v_exp_f32 v237, v237
s_waitcnt lgkmcnt(4)
v_mfma_f32_16x16x32_bf16 v[52:55], a[52:55], v[252:255], 0
v_exp_f32 v238, v238
s_waitcnt lgkmcnt(2)
v_mfma_f32_16x16x32_bf16 v[56:59], a[56:59], v[252:255], 0
v_exp_f32 v239, v239
s_waitcnt lgkmcnt(0)
v_mfma_f32_16x16x32_bf16 v[60:63], a[60:63], v[252:255], 0
v_cvt_pk_bf16_f32 v248, v232, v233
v_cvt_pk_bf16_f32 v249, v234, v235
v_mfma_f32_16x16x32_bf16 v[192:195], a[252:255], v[252:255], 0
v_cvt_pk_bf16_f32 v250, v236, v237
v_cvt_pk_bf16_f32 v251, v238, v239
v_mfma_f32_16x16x32_bf16 v[240:243], a[0:3], a[128:131], v[220:223]
v_max_f32 v26, v26, v27
v_sub_f32 v224, 0xc2200000, v26
v_mfma_f32_16x16x32_bf16 v[240:243], a[4:7], a[132:135], v[240:243]
v_sub_f32 v225, 0xc2200000, v26
v_sub_f32 v226, 0xc2200000, v26
v_mfma_f32_16x16x32_bf16 v[240:243], a[8:11], a[136:139], v[240:243]
v_sub_f32 v227, 0xc2200000, v26
v_mov_b32 v25, v24
v_mfma_f32_16x16x32_bf16 v[240:243], a[12:15], a[140:143], v[240:243]
s_nop 0
v_permlane32_swap_b32 v24, v25
v_mfma_f32_16x16x32_bf16 v[244:247], a[16:19], a[128:131], v[220:223]
v_max_f32 v24, v24, v25
v_mov_b32 v25, v24
v_mfma_f32_16x16x32_bf16 v[244:247], a[20:23], a[132:135], v[244:247]
s_nop 0
v_permlane16_swap_b32 v24, v25
v_mfma_f32_16x16x32_bf16 v[244:247], a[24:27], a[136:139], v[244:247]
v_exp_f32 v240, v240
v_mfma_f32_16x16x32_bf16 v[244:247], a[28:31], a[140:143], v[244:247]
v_exp_f32 v241, v241
v_mfma_f32_16x16x32_bf16 v[64:67], a[32:35], v[248:251], 0
v_exp_f32 v242, v242
v_mfma_f32_16x16x32_bf16 v[68:71], a[36:39], v[248:251], 0
v_exp_f32 v243, v243
v_mfma_f32_16x16x32_bf16 v[72:75], a[40:43], v[248:251], 0
v_cvt_pk_bf16_f32 v252, v240, v241
v_cvt_pk_bf16_f32 v253, v242, v243
v_mfma_f32_16x16x32_bf16 v[76:79], a[44:47], v[248:251], 0
v_exp_f32 v244, v244
v_mfma_f32_16x16x32_bf16 v[80:83], a[48:51], v[248:251], 0
v_exp_f32 v245, v245
v_mfma_f32_16x16x32_bf16 v[84:87], a[52:55], v[248:251], 0
v_exp_f32 v246, v246
v_mfma_f32_16x16x32_bf16 v[88:91], a[56:59], v[248:251], 0
v_exp_f32 v247, v247
v_mfma_f32_16x16x32_bf16 v[92:95], a[60:63], v[248:251], 0
v_cvt_pk_bf16_f32 v254, v244, v245
v_cvt_pk_bf16_f32 v255, v246, v247
v_mfma_f32_16x16x32_bf16 v[196:199], a[252:255], v[248:251], 0
v_max_f32 v24, v24, v25
v_sub_f32 v228, 0xc2200000, v24
v_mfma_f32_16x16x32_bf16 v[232:235], a[0:3], a[144:147], v[224:227]
v_sub_f32 v229, 0xc2200000, v24
v_sub_f32 v230, 0xc2200000, v24
v_mfma_f32_16x16x32_bf16 v[232:235], a[4:7], a[148:151], v[232:235]
v_sub_f32 v231, 0xc2200000, v24
v_add_u32 v3, 0x8000, v3
v_mfma_f32_16x16x32_bf16 v[232:235], a[8:11], a[152:155], v[232:235]
v_and_b32 v3, 0x1ffff, v3
ds_read_b64_tr_b16 a[64:65], v3 offset:16896
v_mfma_f32_16x16x32_bf16 v[232:235], a[12:15], a[156:159], v[232:235]
v_add_u32 v4, 0x8000, v4
ds_read_b64_tr_b16 a[66:67], v3 offset:20992
v_mfma_f32_16x16x32_bf16 v[236:239], a[16:19], a[144:147], v[224:227]
v_and_b32 v4, 0x1ffff, v4
ds_read_b64_tr_b16 a[68:69], v4 offset:16896
v_mfma_f32_16x16x32_bf16 v[236:239], a[20:23], a[148:151], v[236:239]
ds_read_b64_tr_b16 a[70:71], v4 offset:20992
v_add_u32 v2, 0x8000, v2
v_mfma_f32_16x16x32_bf16 v[236:239], a[24:27], a[152:155], v[236:239]
ds_read_b64_tr_b16 a[72:73], v3 offset:17152
v_and_b32 v2, 0x1ffff, v2
v_mfma_f32_16x16x32_bf16 v[236:239], a[28:31], a[156:159], v[236:239]
v_exp_f32 v232, v232
v_mfma_f32_16x16x32_bf16 v[96:99], a[32:35], v[252:255], 0
v_exp_f32 v233, v233
v_mfma_f32_16x16x32_bf16 v[100:103], a[36:39], v[252:255], 0
v_exp_f32 v234, v234
v_mfma_f32_16x16x32_bf16 v[104:107], a[40:43], v[252:255], 0
v_exp_f32 v235, v235
v_mfma_f32_16x16x32_bf16 v[108:111], a[44:47], v[252:255], 0
v_exp_f32 v236, v236
v_mfma_f32_16x16x32_bf16 v[112:115], a[48:51], v[252:255], 0
v_exp_f32 v237, v237
v_mfma_f32_16x16x32_bf16 v[116:119], a[52:55], v[252:255], 0
v_exp_f32 v238, v238
v_mfma_f32_16x16x32_bf16 v[120:123], a[56:59], v[252:255], 0
v_exp_f32 v239, v239
v_mfma_f32_16x16x32_bf16 v[124:127], a[60:63], v[252:255], 0
ds_read_b64_tr_b16 a[74:75], v3 offset:21248
v_cvt_pk_bf16_f32 v248, v232, v233
v_mfma_f32_16x16x32_bf16 v[200:203], a[252:255], v[252:255], 0
ds_read_b64_tr_b16 a[76:77], v4 offset:17152
v_cvt_pk_bf16_f32 v249, v234, v235
v_mfma_f32_16x16x32_bf16 v[240:243], a[0:3], a[160:163], v[228:231]
v_cvt_pk_bf16_f32 v250, v236, v237
v_cvt_pk_bf16_f32 v251, v238, v239
v_mfma_f32_16x16x32_bf16 v[240:243], a[4:7], a[164:167], v[240:243]
ds_read_b64_tr_b16 a[78:79], v4 offset:21248
s_add_u32 s38, s38, 32768
s_and_b32 s38, s38, 0x1ffff
v_mfma_f32_16x16x32_bf16 v[240:243], a[8:11], a[168:171], v[240:243]
ds_read_b128 a[0:3], v2 offset:0
s_add_u32 s37, s37, 8192
v_mfma_f32_16x16x32_bf16 v[240:243], a[12:15], a[172:175], v[240:243]
ds_read_b128 a[4:7], v2 offset:256
s_add_u32 s40, s40, 8192
v_mfma_f32_16x16x32_bf16 v[244:247], a[16:19], a[160:163], v[228:231]
ds_read_b128 a[8:11], v2 offset:512
s_add_u32 s39, s39, 32768
s_and_b32 s39, s39, 0x1ffff
v_mfma_f32_16x16x32_bf16 v[244:247], a[20:23], a[164:167], v[244:247]
ds_read_b128 a[12:15], v2 offset:768
s_waitcnt vmcnt(10)
s_barrier
v_mfma_f32_16x16x32_bf16 v[244:247], a[24:27], a[168:171], v[244:247]
ds_read_b128 a[16:19], v2 offset:4096
s_add_u32 m0, s38, 0
v_mfma_f32_16x16x32_bf16 v[244:247], a[28:31], a[172:175], v[244:247]
ds_read_b128 a[20:23], v2 offset:4352
s_waitcnt vmcnt(0)
s_mov_b64 exec, 1
buffer_atomic_add v11, off, s[88:91], s6
s_mov_b64 exec, -1
v_mfma_f32_16x16x32_bf16 v[128:131], a[32:35], v[248:251], 0
ds_read_b128 a[24:27], v2 offset:4608
v_exp_f32 v240, v240
v_mfma_f32_16x16x32_bf16 v[132:135], a[36:39], v[248:251], 0
ds_read_b128 a[28:31], v2 offset:4864
v_add_u32 v2, 0x8000, v2
v_mfma_f32_16x16x32_bf16 v[136:139], a[40:43], v[248:251], 0
buffer_load_dwordx4 v5, s[12:15], s37 offen nt lds
v_and_b32 v2, 0x1ffff, v2
v_mfma_f32_16x16x32_bf16 v[140:143], a[44:47], v[248:251], 0
v_exp_f32 v241, v241
v_mfma_f32_16x16x32_bf16 v[144:147], a[48:51], v[248:251], 0
v_exp_f32 v242, v242
v_mfma_f32_16x16x32_bf16 v[148:151], a[52:55], v[248:251], 0
buffer_load_dwordx4 v5, s[12:15], s37 offen offset:1024 nt lds
v_cvt_pk_bf16_f32 v252, v240, v241
v_mfma_f32_16x16x32_bf16 v[152:155], a[56:59], v[248:251], 0
v_exp_f32 v243, v243
v_mfma_f32_16x16x32_bf16 v[156:159], a[60:63], v[248:251], 0
v_exp_f32 v244, v244
v_mfma_f32_16x16x32_bf16 v[204:207], a[252:255], v[248:251], 0
v_exp_f32 v245, v245
s_waitcnt lgkmcnt(5)
v_mfma_f32_16x16x32_bf16 v[232:235], a[0:3], a[96:99], v[212:215]
v_exp_f32 v246, v246
v_mfma_f32_16x16x32_bf16 v[232:235], a[4:7], a[100:103], v[232:235]
v_exp_f32 v247, v247
v_mfma_f32_16x16x32_bf16 v[232:235], a[8:11], a[104:107], v[232:235]
v_cvt_pk_bf16_f32 v253, v242, v243
v_cvt_pk_bf16_f32 v254, v244, v245
s_waitcnt lgkmcnt(2)
v_mfma_f32_16x16x32_bf16 v[232:235], a[12:15], a[108:111], v[232:235]
v_cvt_pk_bf16_f32 v255, v246, v247
s_add_u32 m0, s38, 4096
v_mfma_f32_16x16x32_bf16 v[236:239], a[16:19], a[96:99], v[212:215]
buffer_load_dwordx4 v5, s[12:15], s40 offen nt lds
s_add_u32 s38, s38, 32768
s_and_b32 s38, s38, 0x1ffff
v_mfma_f32_16x16x32_bf16 v[236:239], a[20:23], a[100:103], v[236:239]
s_nop 1
v_exp_f32 v232, v232
s_waitcnt lgkmcnt(0)
v_mfma_f32_16x16x32_bf16 v[236:239], a[24:27], a[104:107], v[236:239]
buffer_load_dwordx4 v5, s[12:15], s40 offen offset:1024 nt lds
s_add_u32 m0, s39, 0
v_mfma_f32_16x16x32_bf16 v[236:239], a[28:31], a[108:111], v[236:239]
v_exp_f32 v233, v233
v_mfma_f32_16x16x32_bf16 v[160:163], a[32:35], v[252:255], 0
ds_read_b64_tr_b16 a[32:33], v3 offset:16384
v_cvt_pk_bf16_f32 v248, v232, v233
v_mfma_f32_16x16x32_bf16 v[164:167], a[36:39], v[252:255], 0
buffer_load_dwordx4 v6, s[16:19], s37 offen nt lds
ds_read_b64_tr_b16 a[34:35], v3 offset:20480
v_mfma_f32_16x16x32_bf16 v[168:171], a[40:43], v[252:255], 0
ds_read_b64_tr_b16 a[36:37], v4 offset:16384
v_exp_f32 v234, v234
v_mfma_f32_16x16x32_bf16 v[172:175], a[44:47], v[252:255], 0
ds_read_b64_tr_b16 a[38:39], v4 offset:20480
buffer_load_dwordx4 v6, s[16:19], s37 offen offset:2048 nt lds
v_mfma_f32_16x16x32_bf16 v[176:179], a[48:51], v[252:255], 0
ds_read_b64_tr_b16 a[40:41], v3 offset:16640
s_add_u32 m0, s39, 4096
v_mfma_f32_16x16x32_bf16 v[180:183], a[52:55], v[252:255], 0
ds_read_b64_tr_b16 a[42:43], v3 offset:20736
v_add_u32 v3, 0x8000, v3
v_mfma_f32_16x16x32_bf16 v[184:187], a[56:59], v[252:255], 0
buffer_load_dwordx4 v6, s[16:19], s40 offen nt lds
ds_read_b64_tr_b16 a[44:45], v4 offset:16640
v_mfma_f32_16x16x32_bf16 v[188:191], a[60:63], v[252:255], 0
ds_read_b64_tr_b16 a[46:47], v4 offset:20736
v_and_b32 v3, 0x1ffff, v3
v_mfma_f32_16x16x32_bf16 v[208:211], a[252:255], v[252:255], 0
v_exp_f32 v235, v235
v_mfma_f32_16x16x32_bf16 v[240:243], a[0:3], a[112:115], v[216:219]
buffer_load_dwordx4 v6, s[16:19], s40 offen offset:2048 nt lds
v_cvt_pk_bf16_f32 v249, v234, v235
v_mfma_f32_16x16x32_bf16 v[240:243], a[4:7], a[116:119], v[240:243]
v_exp_f32 v236, v236
v_mfma_f32_16x16x32_bf16 v[240:243], a[8:11], a[120:123], v[240:243]
v_exp_f32 v237, v237
v_mfma_f32_16x16x32_bf16 v[240:243], a[12:15], a[124:127], v[240:243]
v_exp_f32 v238, v238
v_mfma_f32_16x16x32_bf16 v[244:247], a[16:19], a[112:115], v[216:219]
v_exp_f32 v239, v239
v_mfma_f32_16x16x32_bf16 v[244:247], a[20:23], a[116:119], v[244:247]
v_cvt_pk_bf16_f32 v250, v236, v237
v_cvt_pk_bf16_f32 v251, v238, v239
v_mfma_f32_16x16x32_bf16 v[244:247], a[24:27], a[120:123], v[244:247]
ds_read_b64_tr_b16 a[48:49], v3 offset:16896
v_add_u32 v4, 0x8000, v4
v_mfma_f32_16x16x32_bf16 v[244:247], a[28:31], a[124:127], v[244:247]
v_exp_f32 v240, v240
s_waitcnt lgkmcnt(4)
v_mfma_f32_16x16x32_bf16 v[32:35], a[32:35], v[248:251], v[32:35]
v_exp_f32 v241, v241
v_mfma_f32_16x16x32_bf16 v[36:39], a[36:39], v[248:251], v[36:39]
v_exp_f32 v242, v242
s_waitcnt lgkmcnt(2)
v_mfma_f32_16x16x32_bf16 v[40:43], a[40:43], v[248:251], v[40:43]
v_exp_f32 v243, v243
s_waitcnt lgkmcnt(1)
v_mfma_f32_16x16x32_bf16 v[44:47], a[44:47], v[248:251], v[44:47]
v_exp_f32 v244, v244
v_mfma_f32_16x16x32_bf16 v[48:51], a[64:67], v[248:251], v[48:51]
v_exp_f32 v245, v245
v_mfma_f32_16x16x32_bf16 v[52:55], a[68:71], v[248:251], v[52:55]
v_exp_f32 v246, v246
v_mfma_f32_16x16x32_bf16 v[56:59], a[72:75], v[248:251], v[56:59]
s_barrier
v_exp_f32 v247, v247
v_mfma_f32_16x16x32_bf16 v[60:63], a[76:79], v[248:251], v[60:63]
s_add_u32 m0, s38, 0
v_cvt_pk_bf16_f32 v252, v240, v241
v_cvt_pk_bf16_f32 v253, v242, v243
v_mfma_f32_16x16x32_bf16 v[192:195], a[252:255], v[248:251], v[192:195]
v_cvt_pk_bf16_f32 v254, v244, v245
v_cvt_pk_bf16_f32 v255, v246, v247
v_mfma_f32_16x16x32_bf16 v[232:235], a[0:3], a[128:131], v[220:223]
ds_read_b64_tr_b16 a[50:51], v3 offset:20992
v_and_b32 v4, 0x1ffff, v4
v_mfma_f32_16x16x32_bf16 v[232:235], a[4:7], a[132:135], v[232:235]
ds_read_b64_tr_b16 a[52:53], v4 offset:16896
v_mfma_f32_16x16x32_bf16 v[232:235], a[8:11], a[136:139], v[232:235]
ds_read_b64_tr_b16 a[54:55], v4 offset:20992
v_mfma_f32_16x16x32_bf16 v[232:235], a[12:15], a[140:143], v[232:235]
ds_read_b64_tr_b16 a[56:57], v3 offset:17152
s_add_u32 s37, s37, 8192
buffer_load_dwordx4 v5, s[12:15], s37 offen nt lds
buffer_load_dwordx4 v5, s[12:15], s37 offen offset:1024 nt lds
s_add_u32 m0, s38, 4096
s_add_u32 s38, s38, 32768
s_and_b32 s38, s38, 0x1ffff
v_mfma_f32_16x16x32_bf16 v[236:239], a[16:19], a[128:131], v[220:223]
ds_read_b64_tr_b16 a[58:59], v3 offset:21248
v_mfma_f32_16x16x32_bf16 v[236:239], a[20:23], a[132:135], v[236:239]
ds_read_b64_tr_b16 a[60:61], v4 offset:17152
s_add_u32 s40, s40, 8192
v_mfma_f32_16x16x32_bf16 v[236:239], a[24:27], a[136:139], v[236:239]
v_exp_f32 v232, v232
v_mfma_f32_16x16x32_bf16 v[236:239], a[28:31], a[140:143], v[236:239]
v_exp_f32 v233, v233
v_mfma_f32_16x16x32_bf16 v[64:67], a[32:35], v[252:255], v[64:67]
v_exp_f32 v234, v234
v_mfma_f32_16x16x32_bf16 v[68:71], a[36:39], v[252:255], v[68:71]
v_exp_f32 v235, v235
buffer_load_dwordx4 v5, s[12:15], s40 offen nt lds
v_mfma_f32_16x16x32_bf16 v[72:75], a[40:43], v[252:255], v[72:75]
v_cvt_pk_bf16_f32 v248, v232, v233
v_cvt_pk_bf16_f32 v249, v234, v235
v_mfma_f32_16x16x32_bf16 v[76:79], a[44:47], v[252:255], v[76:79]
v_exp_f32 v236, v236
v_mfma_f32_16x16x32_bf16 v[80:83], a[64:67], v[252:255], v[80:83]
v_exp_f32 v237, v237
v_mfma_f32_16x16x32_bf16 v[84:87], a[68:71], v[252:255], v[84:87]
v_exp_f32 v238, v238
v_mfma_f32_16x16x32_bf16 v[88:91], a[72:75], v[252:255], v[88:91]
v_exp_f32 v239, v239
v_mfma_f32_16x16x32_bf16 v[92:95], a[76:79], v[252:255], v[92:95]
buffer_load_dwordx4 v5, s[12:15], s40 offen offset:1024 nt lds
v_cvt_pk_bf16_f32 v250, v236, v237
v_cvt_pk_bf16_f32 v251, v238, v239
v_mfma_f32_16x16x32_bf16 v[196:199], a[252:255], v[252:255], v[196:199]
ds_read_b64_tr_b16 a[62:63], v4 offset:21248
v_mfma_f32_16x16x32_bf16 v[240:243], a[0:3], a[144:147], v[224:227]
s_add_u32 s39, s39, 32768
s_and_b32 s39, s39, 0x1ffff
s_add_u32 m0, s39, 0
v_mfma_f32_16x16x32_bf16 v[240:243], a[4:7], a[148:151], v[240:243]
buffer_load_dwordx4 v6, s[16:19], s37 offen nt lds
v_mfma_f32_16x16x32_bf16 v[240:243], a[8:11], a[152:155], v[240:243]
v_mfma_f32_16x16x32_bf16 v[240:243], a[12:15], a[156:159], v[240:243]
v_mfma_f32_16x16x32_bf16 v[244:247], a[16:19], a[144:147], v[224:227]
buffer_load_dwordx4 v6, s[16:19], s37 offen offset:2048 nt lds
s_add_u32 m0, s39, 4096
v_mfma_f32_16x16x32_bf16 v[244:247], a[20:23], a[148:151], v[244:247]
s_add_u32 s37, s37, 8192
s_add_u32 s39, s39, 32768
s_and_b32 s39, s39, 0x1ffff
v_mfma_f32_16x16x32_bf16 v[244:247], a[24:27], a[152:155], v[244:247]
s_nop 0
v_exp_f32 v240, v240
v_mfma_f32_16x16x32_bf16 v[244:247], a[28:31], a[156:159], v[244:247]
v_exp_f32 v241, v241
v_mfma_f32_16x16x32_bf16 v[96:99], a[32:35], v[248:251], v[96:99]
v_exp_f32 v242, v242
v_mfma_f32_16x16x32_bf16 v[100:103], a[36:39], v[248:251], v[100:103]
v_exp_f32 v243, v243
v_mfma_f32_16x16x32_bf16 v[104:107], a[40:43], v[248:251], v[104:107]
v_cvt_pk_bf16_f32 v252, v240, v241
v_cvt_pk_bf16_f32 v253, v242, v243
v_mfma_f32_16x16x32_bf16 v[108:111], a[44:47], v[248:251], v[108:111]
v_exp_f32 v244, v244
v_mfma_f32_16x16x32_bf16 v[112:115], a[64:67], v[248:251], v[112:115]
v_exp_f32 v245, v245
v_mfma_f32_16x16x32_bf16 v[116:119], a[68:71], v[248:251], v[116:119]
v_exp_f32 v246, v246
v_mfma_f32_16x16x32_bf16 v[120:123], a[72:75], v[248:251], v[120:123]
v_exp_f32 v247, v247
v_mfma_f32_16x16x32_bf16 v[124:127], a[76:79], v[248:251], v[124:127]
v_cvt_pk_bf16_f32 v254, v244, v245
buffer_load_dwordx4 v6, s[16:19], s40 offen nt lds
v_cvt_pk_bf16_f32 v255, v246, v247
v_mfma_f32_16x16x32_bf16 v[200:203], a[252:255], v[248:251], v[200:203]
v_mfma_f32_16x16x32_bf16 v[232:235], a[0:3], a[160:163], v[228:231]
ds_read_b128 a[0:3], v2 offset:0
v_mfma_f32_16x16x32_bf16 v[232:235], a[4:7], a[164:167], v[232:235]
ds_read_b128 a[4:7], v2 offset:256
buffer_load_dwordx4 v6, s[16:19], s40 offen offset:2048 nt lds
v_mfma_f32_16x16x32_bf16 v[232:235], a[8:11], a[168:171], v[232:235]
ds_read_b128 a[8:11], v2 offset:512
s_add_u32 s40, s40, 8192
v_mfma_f32_16x16x32_bf16 v[232:235], a[12:15], a[172:175], v[232:235]
ds_read_b128 a[12:15], v2 offset:768
v_mfma_f32_16x16x32_bf16 v[236:239], a[16:19], a[160:163], v[228:231]
ds_read_b128 a[16:19], v2 offset:4096
v_mfma_f32_16x16x32_bf16 v[236:239], a[20:23], a[164:167], v[236:239]
ds_read_b128 a[20:23], v2 offset:4352
v_mfma_f32_16x16x32_bf16 v[236:239], a[24:27], a[168:171], v[236:239]
ds_read_b128 a[24:27], v2 offset:4608
v_mfma_f32_16x16x32_bf16 v[236:239], a[28:31], a[172:175], v[236:239]
ds_read_b128 a[28:31], v2 offset:4864
v_mfma_f32_16x16x32_bf16 v[128:131], a[32:35], v[252:255], v[128:131]
v_exp_f32 v232, v232
v_mfma_f32_16x16x32_bf16 v[132:135], a[36:39], v[252:255], v[132:135]
v_exp_f32 v233, v233
v_mfma_f32_16x16x32_bf16 v[136:139], a[40:43], v[252:255], v[136:139]
v_exp_f32 v234, v234
v_add_u32 v2, 0x8000, v2
v_mfma_f32_16x16x32_bf16 v[140:143], a[44:47], v[252:255], v[140:143]
v_exp_f32 v235, v235
v_mfma_f32_16x16x32_bf16 v[144:147], a[64:67], v[252:255], v[144:147]
v_exp_f32 v236, v236
v_mfma_f32_16x16x32_bf16 v[148:151], a[68:71], v[252:255], v[148:151]
v_exp_f32 v237, v237
v_mfma_f32_16x16x32_bf16 v[152:155], a[72:75], v[252:255], v[152:155]
v_exp_f32 v238, v238
v_mfma_f32_16x16x32_bf16 v[156:159], a[76:79], v[252:255], v[156:159]
v_exp_f32 v239, v239
v_mfma_f32_16x16x32_bf16 v[204:207], a[252:255], v[252:255], v[204:207]
v_cvt_pk_bf16_f32 v248, v232, v233
v_and_b32 v2, 0x1ffff, v2
v_cvt_pk_bf16_f32 v249, v234, v235
s_waitcnt lgkmcnt(3)
v_mfma_f32_16x16x32_bf16 v[240:243], a[0:3], a[96:99], v[212:215]
v_cvt_pk_bf16_f32 v250, v236, v237
v_cvt_pk_bf16_f32 v251, v238, v239
v_mfma_f32_16x16x32_bf16 v[240:243], a[4:7], a[100:103], v[240:243]
v_mfma_f32_16x16x32_bf16 v[240:243], a[8:11], a[104:107], v[240:243]
v_mfma_f32_16x16x32_bf16 v[240:243], a[12:15], a[108:111], v[240:243]
v_mfma_f32_16x16x32_bf16 v[244:247], a[16:19], a[96:99], v[212:215]
s_waitcnt lgkmcnt(0)
v_mfma_f32_16x16x32_bf16 v[244:247], a[20:23], a[100:103], v[244:247]
s_nop 4
v_exp_f32 v240, v240
v_mfma_f32_16x16x32_bf16 v[244:247], a[24:27], a[104:107], v[244:247]
v_exp_f32 v241, v241
v_mfma_f32_16x16x32_bf16 v[244:247], a[28:31], a[108:111], v[244:247]
v_exp_f32 v242, v242
v_mfma_f32_16x16x32_bf16 v[160:163], a[32:35], v[248:251], v[160:163]
ds_read_b64_tr_b16 a[32:33], v3 offset:16384
v_cvt_pk_bf16_f32 v252, v240, v241
v_mfma_f32_16x16x32_bf16 v[164:167], a[36:39], v[248:251], v[164:167]
ds_read_b64_tr_b16 a[34:35], v3 offset:20480
v_exp_f32 v243, v243
v_mfma_f32_16x16x32_bf16 v[168:171], a[40:43], v[248:251], v[168:171]
ds_read_b64_tr_b16 a[36:37], v4 offset:16384
v_cvt_pk_bf16_f32 v253, v242, v243
v_mfma_f32_16x16x32_bf16 v[172:175], a[44:47], v[248:251], v[172:175]
ds_read_b64_tr_b16 a[38:39], v4 offset:20480
v_exp_f32 v244, v244
v_mfma_f32_16x16x32_bf16 v[176:179], a[64:67], v[248:251], v[176:179]
ds_read_b64_tr_b16 a[40:41], v3 offset:16640
v_exp_f32 v245, v245
v_mfma_f32_16x16x32_bf16 v[180:183], a[68:71], v[248:251], v[180:183]
ds_read_b64_tr_b16 a[42:43], v3 offset:20736
v_cvt_pk_bf16_f32 v254, v244, v245
v_mfma_f32_16x16x32_bf16 v[184:187], a[72:75], v[248:251], v[184:187]
ds_read_b64_tr_b16 a[44:45], v4 offset:16640
v_add_u32 v3, 0x8000, v3
v_mfma_f32_16x16x32_bf16 v[188:191], a[76:79], v[248:251], v[188:191]
ds_read_b64_tr_b16 a[46:47], v4 offset:20736
v_and_b32 v3, 0x1ffff, v3
v_mfma_f32_16x16x32_bf16 v[208:211], a[252:255], v[248:251], v[208:211]
v_exp_f32 v246, v246
v_mfma_f32_16x16x32_bf16 v[232:235], a[0:3], a[112:115], v[216:219]
v_exp_f32 v247, v247
v_mfma_f32_16x16x32_bf16 v[232:235], a[4:7], a[116:119], v[232:235]
v_cvt_pk_bf16_f32 v255, v246, v247
ds_read_b64_tr_b16 a[64:65], v3 offset:16896
v_mfma_f32_16x16x32_bf16 v[232:235], a[8:11], a[120:123], v[232:235]
v_add_u32 v4, 0x8000, v4
ds_read_b64_tr_b16 a[66:67], v3 offset:20992
v_mfma_f32_16x16x32_bf16 v[232:235], a[12:15], a[124:127], v[232:235]
v_and_b32 v4, 0x1ffff, v4
ds_read_b64_tr_b16 a[68:69], v4 offset:16896
v_mfma_f32_16x16x32_bf16 v[236:239], a[16:19], a[112:115], v[216:219]
ds_read_b64_tr_b16 a[70:71], v4 offset:20992
v_mfma_f32_16x16x32_bf16 v[236:239], a[20:23], a[116:119], v[236:239]
ds_read_b64_tr_b16 a[72:73], v3 offset:17152
s_nop 1
v_exp_f32 v232, v232
v_mfma_f32_16x16x32_bf16 v[236:239], a[24:27], a[120:123], v[236:239]
v_exp_f32 v233, v233
v_mfma_f32_16x16x32_bf16 v[236:239], a[28:31], a[124:127], v[236:239]
v_exp_f32 v234, v234
s_waitcnt lgkmcnt(8)
v_mfma_f32_16x16x32_bf16 v[32:35], a[32:35], v[252:255], v[32:35]
v_exp_f32 v235, v235
v_mfma_f32_16x16x32_bf16 v[36:39], a[36:39], v[252:255], v[36:39]
v_cvt_pk_bf16_f32 v248, v232, v233
v_cvt_pk_bf16_f32 v249, v234, v235
s_waitcnt lgkmcnt(5)
v_mfma_f32_16x16x32_bf16 v[40:43], a[40:43], v[252:255], v[40:43]
v_exp_f32 v236, v236
v_mfma_f32_16x16x32_bf16 v[44:47], a[44:47], v[252:255], v[44:47]
v_exp_f32 v237, v237
v_mfma_f32_16x16x32_bf16 v[48:51], a[48:51], v[252:255], v[48:51]
v_exp_f32 v238, v238
v_mfma_f32_16x16x32_bf16 v[52:55], a[52:55], v[252:255], v[52:55]
v_exp_f32 v239, v239
v_mfma_f32_16x16x32_bf16 v[56:59], a[56:59], v[252:255], v[56:59]
v_cvt_pk_bf16_f32 v250, v236, v237
v_cvt_pk_bf16_f32 v251, v238, v239
v_mfma_f32_16x16x32_bf16 v[60:63], a[60:63], v[252:255], v[60:63]
ds_read_b64_tr_b16 a[74:75], v3 offset:21248
s_waitcnt vmcnt(8)
s_barrier
v_mfma_f32_16x16x32_bf16 v[192:195], a[252:255], v[252:255], v[192:195]
ds_read_b64_tr_b16 a[76:77], v4 offset:17152
s_add_u32 m0, s38, 0
v_mfma_f32_16x16x32_bf16 v[240:243], a[0:3], a[128:131], v[220:223]
ds_read_b64_tr_b16 a[78:79], v4 offset:21248
buffer_load_dwordx4 v5, s[12:15], s37 offen nt lds
v_mfma_f32_16x16x32_bf16 v[240:243], a[4:7], a[132:135], v[240:243]
v_mfma_f32_16x16x32_bf16 v[240:243], a[8:11], a[136:139], v[240:243]
v_mfma_f32_16x16x32_bf16 v[240:243], a[12:15], a[140:143], v[240:243]
buffer_load_dwordx4 v5, s[12:15], s37 offen offset:1024 nt lds
s_add_u32 m0, s38, 4096
v_mfma_f32_16x16x32_bf16 v[244:247], a[16:19], a[128:131], v[220:223]
s_add_u32 s38, s38, 32768
s_and_b32 s38, s38, 0x1ffff
v_mfma_f32_16x16x32_bf16 v[244:247], a[20:23], a[132:135], v[244:247]
s_nop 2
v_exp_f32 v240, v240
v_mfma_f32_16x16x32_bf16 v[244:247], a[24:27], a[136:139], v[244:247]
v_exp_f32 v241, v241
v_mfma_f32_16x16x32_bf16 v[244:247], a[28:31], a[140:143], v[244:247]
v_exp_f32 v242, v242
v_mfma_f32_16x16x32_bf16 v[64:67], a[32:35], v[248:251], v[64:67]
v_exp_f32 v243, v243
v_mfma_f32_16x16x32_bf16 v[68:71], a[36:39], v[248:251], v[68:71]
v_cvt_pk_bf16_f32 v252, v240, v241
v_cvt_pk_bf16_f32 v253, v242, v243
v_mfma_f32_16x16x32_bf16 v[72:75], a[40:43], v[248:251], v[72:75]
buffer_load_dwordx4 v5, s[12:15], s40 offen nt lds
v_exp_f32 v244, v244
v_mfma_f32_16x16x32_bf16 v[76:79], a[44:47], v[248:251], v[76:79]
v_exp_f32 v245, v245
v_mfma_f32_16x16x32_bf16 v[80:83], a[48:51], v[248:251], v[80:83]
v_exp_f32 v246, v246
v_mfma_f32_16x16x32_bf16 v[84:87], a[52:55], v[248:251], v[84:87]
v_exp_f32 v247, v247
v_mfma_f32_16x16x32_bf16 v[88:91], a[56:59], v[248:251], v[88:91]
v_cvt_pk_bf16_f32 v254, v244, v245
v_cvt_pk_bf16_f32 v255, v246, v247
v_mfma_f32_16x16x32_bf16 v[92:95], a[60:63], v[248:251], v[92:95]
buffer_load_dwordx4 v5, s[12:15], s40 offen offset:1024 nt lds
s_add_u32 m0, s39, 0
v_mfma_f32_16x16x32_bf16 v[196:199], a[252:255], v[248:251], v[196:199]
v_mfma_f32_16x16x32_bf16 v[232:235], a[0:3], a[144:147], v[224:227]
v_mfma_f32_16x16x32_bf16 v[232:235], a[4:7], a[148:151], v[232:235]
buffer_load_dwordx4 v6, s[16:19], s37 offen nt lds
v_mfma_f32_16x16x32_bf16 v[232:235], a[8:11], a[152:155], v[232:235]
v_mfma_f32_16x16x32_bf16 v[232:235], a[12:15], a[156:159], v[232:235]
v_mfma_f32_16x16x32_bf16 v[236:239], a[16:19], a[144:147], v[224:227]
buffer_load_dwordx4 v6, s[16:19], s37 offen offset:2048 nt lds
s_add_u32 m0, s39, 4096
v_mfma_f32_16x16x32_bf16 v[236:239], a[20:23], a[148:151], v[236:239]
s_add_u32 s37, s37, 8192
s_add_u32 s39, s39, 32768
s_and_b32 s39, s39, 0x1ffff
v_mfma_f32_16x16x32_bf16 v[236:239], a[24:27], a[152:155], v[236:239]
s_nop 0
v_exp_f32 v232, v232
v_mfma_f32_16x16x32_bf16 v[236:239], a[28:31], a[156:159], v[236:239]
v_exp_f32 v233, v233
v_mfma_f32_16x16x32_bf16 v[96:99], a[32:35], v[252:255], v[96:99]
v_exp_f32 v234, v234
v_mfma_f32_16x16x32_bf16 v[100:103], a[36:39], v[252:255], v[100:103]
v_exp_f32 v235, v235
v_mfma_f32_16x16x32_bf16 v[104:107], a[40:43], v[252:255], v[104:107]
v_cvt_pk_bf16_f32 v248, v232, v233
v_cvt_pk_bf16_f32 v249, v234, v235
v_mfma_f32_16x16x32_bf16 v[108:111], a[44:47], v[252:255], v[108:111]
v_exp_f32 v236, v236
v_mfma_f32_16x16x32_bf16 v[112:115], a[48:51], v[252:255], v[112:115]
v_exp_f32 v237, v237
v_mfma_f32_16x16x32_bf16 v[116:119], a[52:55], v[252:255], v[116:119]
v_exp_f32 v238, v238
v_mfma_f32_16x16x32_bf16 v[120:123], a[56:59], v[252:255], v[120:123]
v_exp_f32 v239, v239
v_mfma_f32_16x16x32_bf16 v[124:127], a[60:63], v[252:255], v[124:127]
v_cvt_pk_bf16_f32 v250, v236, v237
v_cvt_pk_bf16_f32 v251, v238, v239
v_mfma_f32_16x16x32_bf16 v[200:203], a[252:255], v[252:255], v[200:203]
buffer_load_dwordx4 v6, s[16:19], s40 offen nt lds
v_mfma_f32_16x16x32_bf16 v[240:243], a[0:3], a[160:163], v[228:231]
ds_read_b128 a[0:3], v2 offset:0
v_mfma_f32_16x16x32_bf16 v[240:243], a[4:7], a[164:167], v[240:243]
ds_read_b128 a[4:7], v2 offset:256
v_mfma_f32_16x16x32_bf16 v[240:243], a[8:11], a[168:171], v[240:243]
ds_read_b128 a[8:11], v2 offset:512
buffer_load_dwordx4 v6, s[16:19], s40 offen offset:2048 nt lds
v_mfma_f32_16x16x32_bf16 v[240:243], a[12:15], a[172:175], v[240:243]
ds_read_b128 a[12:15], v2 offset:768
s_add_u32 s40, s40, 8192
v_mfma_f32_16x16x32_bf16 v[244:247], a[16:19], a[160:163], v[228:231]
ds_read_b128 a[16:19], v2 offset:4096
v_mfma_f32_16x16x32_bf16 v[244:247], a[20:23], a[164:167], v[244:247]
ds_read_b128 a[20:23], v2 offset:4352
s_nop 1
v_exp_f32 v240, v240
v_mfma_f32_16x16x32_bf16 v[244:247], a[24:27], a[168:171], v[244:247]
ds_read_b128 a[24:27], v2 offset:4608
v_exp_f32 v241, v241
v_mfma_f32_16x16x32_bf16 v[244:247], a[28:31], a[172:175], v[244:247]
ds_read_b128 a[28:31], v2 offset:4864
v_cvt_pk_bf16_f32 v252, v240, v241
v_mfma_f32_16x16x32_bf16 v[128:131], a[32:35], v[248:251], v[128:131]
v_exp_f32 v242, v242
v_mfma_f32_16x16x32_bf16 v[132:135], a[36:39], v[248:251], v[132:135]
v_exp_f32 v243, v243
v_mfma_f32_16x16x32_bf16 v[136:139], a[40:43], v[248:251], v[136:139]
v_cvt_pk_bf16_f32 v253, v242, v243
v_add_u32 v2, 0x8000, v2
v_mfma_f32_16x16x32_bf16 v[140:143], a[44:47], v[248:251], v[140:143]
v_exp_f32 v244, v244
v_mfma_f32_16x16x32_bf16 v[144:147], a[48:51], v[248:251], v[144:147]
v_exp_f32 v245, v245
v_mfma_f32_16x16x32_bf16 v[148:151], a[52:55], v[248:251], v[148:151]
v_exp_f32 v246, v246
v_mfma_f32_16x16x32_bf16 v[152:155], a[56:59], v[248:251], v[152:155]
v_exp_f32 v247, v247
v_mfma_f32_16x16x32_bf16 v[156:159], a[60:63], v[248:251], v[156:159]
v_cvt_pk_bf16_f32 v254, v244, v245
v_cvt_pk_bf16_f32 v255, v246, v247
v_mfma_f32_16x16x32_bf16 v[204:207], a[252:255], v[248:251], v[204:207]
v_and_b32 v2, 0x1ffff, v2
s_waitcnt lgkmcnt(2)
v_mfma_f32_16x16x32_bf16 v[232:235], a[0:3], a[96:99], v[212:215]
v_mfma_f32_16x16x32_bf16 v[232:235], a[4:7], a[100:103], v[232:235]
v_mfma_f32_16x16x32_bf16 v[232:235], a[8:11], a[104:107], v[232:235]
v_mfma_f32_16x16x32_bf16 v[232:235], a[12:15], a[108:111], v[232:235]
v_mfma_f32_16x16x32_bf16 v[236:239], a[16:19], a[96:99], v[212:215]
v_mfma_f32_16x16x32_bf16 v[236:239], a[20:23], a[100:103], v[236:239]
s_nop 5
v_exp_f32 v232, v232
s_waitcnt lgkmcnt(0)
v_mfma_f32_16x16x32_bf16 v[236:239], a[24:27], a[104:107], v[236:239]
v_exp_f32 v233, v233
v_mfma_f32_16x16x32_bf16 v[236:239], a[28:31], a[108:111], v[236:239]
v_exp_f32 v234, v234
v_mfma_f32_16x16x32_bf16 v[160:163], a[32:35], v[252:255], v[160:163]
ds_read_b64_tr_b16 a[32:33], v3 offset:16384
v_cvt_pk_bf16_f32 v248, v232, v233
v_mfma_f32_16x16x32_bf16 v[164:167], a[36:39], v[252:255], v[164:167]
ds_read_b64_tr_b16 a[34:35], v3 offset:20480
v_exp_f32 v235, v235
v_mfma_f32_16x16x32_bf16 v[168:171], a[40:43], v[252:255], v[168:171]
ds_read_b64_tr_b16 a[36:37], v4 offset:16384
v_cvt_pk_bf16_f32 v249, v234, v235
v_mfma_f32_16x16x32_bf16 v[172:175], a[44:47], v[252:255], v[172:175]
ds_read_b64_tr_b16 a[38:39], v4 offset:20480
v_exp_f32 v236, v236
v_mfma_f32_16x16x32_bf16 v[176:179], a[48:51], v[252:255], v[176:179]
ds_read_b64_tr_b16 a[40:41], v3 offset:16640
v_exp_f32 v237, v237
v_mfma_f32_16x16x32_bf16 v[180:183], a[52:55], v[252:255], v[180:183]
ds_read_b64_tr_b16 a[42:43], v3 offset:20736
v_cvt_pk_bf16_f32 v250, v236, v237
v_mfma_f32_16x16x32_bf16 v[184:187], a[56:59], v[252:255], v[184:187]
ds_read_b64_tr_b16 a[44:45], v4 offset:16640
v_add_u32 v3, 0x8000, v3
v_mfma_f32_16x16x32_bf16 v[188:191], a[60:63], v[252:255], v[188:191]
ds_read_b64_tr_b16 a[46:47], v4 offset:20736
v_and_b32 v3, 0x1ffff, v3
v_mfma_f32_16x16x32_bf16 v[208:211], a[252:255], v[252:255], v[208:211]
v_exp_f32 v238, v238
v_mfma_f32_16x16x32_bf16 v[240:243], a[0:3], a[112:115], v[216:219]
v_exp_f32 v239, v239
v_mfma_f32_16x16x32_bf16 v[240:243], a[4:7], a[116:119], v[240:243]
v_cvt_pk_bf16_f32 v251, v238, v239
ds_read_b64_tr_b16 a[48:49], v3 offset:16896
v_mfma_f32_16x16x32_bf16 v[240:243], a[8:11], a[120:123], v[240:243]
v_add_u32 v4, 0x8000, v4
ds_read_b64_tr_b16 a[50:51], v3 offset:20992
v_mfma_f32_16x16x32_bf16 v[240:243], a[12:15], a[124:127], v[240:243]
v_and_b32 v4, 0x1ffff, v4
ds_read_b64_tr_b16 a[52:53], v4 offset:16896
v_mfma_f32_16x16x32_bf16 v[244:247], a[16:19], a[112:115], v[216:219]
ds_read_b64_tr_b16 a[54:55], v4 offset:20992
v_mfma_f32_16x16x32_bf16 v[244:247], a[20:23], a[116:119], v[244:247]
ds_read_b64_tr_b16 a[56:57], v3 offset:17152
s_nop 1
v_exp_f32 v240, v240
v_mfma_f32_16x16x32_bf16 v[244:247], a[24:27], a[120:123], v[244:247]
v_exp_f32 v241, v241
v_mfma_f32_16x16x32_bf16 v[244:247], a[28:31], a[124:127], v[244:247]
v_exp_f32 v242, v242
s_waitcnt lgkmcnt(8)
v_mfma_f32_16x16x32_bf16 v[32:35], a[32:35], v[248:251], v[32:35]
v_exp_f32 v243, v243
v_mfma_f32_16x16x32_bf16 v[36:39], a[36:39], v[248:251], v[36:39]
v_cvt_pk_bf16_f32 v252, v240, v241
v_cvt_pk_bf16_f32 v253, v242, v243
s_waitcnt lgkmcnt(5)
v_mfma_f32_16x16x32_bf16 v[40:43], a[40:43], v[248:251], v[40:43]
v_exp_f32 v244, v244
v_mfma_f32_16x16x32_bf16 v[44:47], a[44:47], v[248:251], v[44:47]
v_exp_f32 v245, v245
v_mfma_f32_16x16x32_bf16 v[48:51], a[64:67], v[248:251], v[48:51]
v_exp_f32 v246, v246
v_mfma_f32_16x16x32_bf16 v[52:55], a[68:71], v[248:251], v[52:55]
v_exp_f32 v247, v247
v_mfma_f32_16x16x32_bf16 v[56:59], a[72:75], v[248:251], v[56:59]
v_cvt_pk_bf16_f32 v254, v244, v245
v_cvt_pk_bf16_f32 v255, v246, v247
v_mfma_f32_16x16x32_bf16 v[60:63], a[76:79], v[248:251], v[60:63]
ds_read_b64_tr_b16 a[58:59], v3 offset:21248
s_waitcnt vmcnt(8)
s_barrier
v_mfma_f32_16x16x32_bf16 v[192:195], a[252:255], v[248:251], v[192:195]
ds_read_b64_tr_b16 a[60:61], v4 offset:17152
s_add_u32 m0, s38, 0
v_mfma_f32_16x16x32_bf16 v[232:235], a[0:3], a[128:131], v[220:223]
ds_read_b64_tr_b16 a[62:63], v4 offset:21248
buffer_load_dwordx4 v5, s[12:15], s37 offen nt lds
v_mfma_f32_16x16x32_bf16 v[232:235], a[4:7], a[132:135], v[232:235]
v_mfma_f32_16x16x32_bf16 v[232:235], a[8:11], a[136:139], v[232:235]
v_mfma_f32_16x16x32_bf16 v[232:235], a[12:15], a[140:143], v[232:235]
buffer_load_dwordx4 v5, s[12:15], s37 offen offset:1024 nt lds
s_add_u32 m0, s38, 4096
v_mfma_f32_16x16x32_bf16 v[236:239], a[16:19], a[128:131], v[220:223]
s_add_u32 s38, s38, 32768
s_and_b32 s38, s38, 0x1ffff
v_mfma_f32_16x16x32_bf16 v[236:239], a[20:23], a[132:135], v[236:239]
s_nop 2
v_exp_f32 v232, v232
v_mfma_f32_16x16x32_bf16 v[236:239], a[24:27], a[136:139], v[236:239]
v_exp_f32 v233, v233
v_mfma_f32_16x16x32_bf16 v[236:239], a[28:31], a[140:143], v[236:239]
v_exp_f32 v234, v234
v_mfma_f32_16x16x32_bf16 v[64:67], a[32:35], v[252:255], v[64:67]
v_exp_f32 v235, v235
v_mfma_f32_16x16x32_bf16 v[68:71], a[36:39], v[252:255], v[68:71]
v_cvt_pk_bf16_f32 v248, v232, v233
v_cvt_pk_bf16_f32 v249, v234, v235
v_mfma_f32_16x16x32_bf16 v[72:75], a[40:43], v[252:255], v[72:75]
buffer_load_dwordx4 v5, s[12:15], s40 offen nt lds
v_exp_f32 v236, v236
v_mfma_f32_16x16x32_bf16 v[76:79], a[44:47], v[252:255], v[76:79]
v_exp_f32 v237, v237
v_mfma_f32_16x16x32_bf16 v[80:83], a[64:67], v[252:255], v[80:83]
v_exp_f32 v238, v238
v_mfma_f32_16x16x32_bf16 v[84:87], a[68:71], v[252:255], v[84:87]
v_exp_f32 v239, v239
v_mfma_f32_16x16x32_bf16 v[88:91], a[72:75], v[252:255], v[88:91]
v_cvt_pk_bf16_f32 v250, v236, v237
v_cvt_pk_bf16_f32 v251, v238, v239
v_mfma_f32_16x16x32_bf16 v[92:95], a[76:79], v[252:255], v[92:95]
buffer_load_dwordx4 v5, s[12:15], s40 offen offset:1024 nt lds
s_add_u32 m0, s39, 0
v_mfma_f32_16x16x32_bf16 v[196:199], a[252:255], v[252:255], v[196:199]
v_mfma_f32_16x16x32_bf16 v[240:243], a[0:3], a[144:147], v[224:227]
v_mfma_f32_16x16x32_bf16 v[240:243], a[4:7], a[148:151], v[240:243]
buffer_load_dwordx4 v6, s[16:19], s37 offen nt lds
v_mfma_f32_16x16x32_bf16 v[240:243], a[8:11], a[152:155], v[240:243]
v_mfma_f32_16x16x32_bf16 v[240:243], a[12:15], a[156:159], v[240:243]
v_mfma_f32_16x16x32_bf16 v[244:247], a[16:19], a[144:147], v[224:227]
buffer_load_dwordx4 v6, s[16:19], s37 offen offset:2048 nt lds
s_add_u32 m0, s39, 4096
v_mfma_f32_16x16x32_bf16 v[244:247], a[20:23], a[148:151], v[244:247]
s_add_u32 s37, s37, 8192
s_add_u32 s39, s39, 32768
s_and_b32 s39, s39, 0x1ffff
v_mfma_f32_16x16x32_bf16 v[244:247], a[24:27], a[152:155], v[244:247]
s_nop 0
v_exp_f32 v240, v240
v_mfma_f32_16x16x32_bf16 v[244:247], a[28:31], a[156:159], v[244:247]
v_exp_f32 v241, v241
v_mfma_f32_16x16x32_bf16 v[96:99], a[32:35], v[248:251], v[96:99]
v_exp_f32 v242, v242
v_mfma_f32_16x16x32_bf16 v[100:103], a[36:39], v[248:251], v[100:103]
v_exp_f32 v243, v243
v_mfma_f32_16x16x32_bf16 v[104:107], a[40:43], v[248:251], v[104:107]
v_cvt_pk_bf16_f32 v252, v240, v241
v_cvt_pk_bf16_f32 v253, v242, v243
v_mfma_f32_16x16x32_bf16 v[108:111], a[44:47], v[248:251], v[108:111]
v_exp_f32 v244, v244
v_mfma_f32_16x16x32_bf16 v[112:115], a[64:67], v[248:251], v[112:115]
v_exp_f32 v245, v245
v_mfma_f32_16x16x32_bf16 v[116:119], a[68:71], v[248:251], v[116:119]
v_exp_f32 v246, v246
v_mfma_f32_16x16x32_bf16 v[120:123], a[72:75], v[248:251], v[120:123]
v_exp_f32 v247, v247
v_mfma_f32_16x16x32_bf16 v[124:127], a[76:79], v[248:251], v[124:127]
v_cvt_pk_bf16_f32 v254, v244, v245
v_cvt_pk_bf16_f32 v255, v246, v247
v_mfma_f32_16x16x32_bf16 v[200:203], a[252:255], v[248:251], v[200:203]
buffer_load_dwordx4 v6, s[16:19], s40 offen nt lds
v_mfma_f32_16x16x32_bf16 v[232:235], a[0:3], a[160:163], v[228:231]
ds_read_b128 a[0:3], v2 offset:0
v_mfma_f32_16x16x32_bf16 v[232:235], a[4:7], a[164:167], v[232:235]
ds_read_b128 a[4:7], v2 offset:256
v_mfma_f32_16x16x32_bf16 v[232:235], a[8:11], a[168:171], v[232:235]
ds_read_b128 a[8:11], v2 offset:512
buffer_load_dwordx4 v6, s[16:19], s40 offen offset:2048 nt lds
v_mfma_f32_16x16x32_bf16 v[232:235], a[12:15], a[172:175], v[232:235]
ds_read_b128 a[12:15], v2 offset:768
s_add_u32 s40, s40, 8192
v_mfma_f32_16x16x32_bf16 v[236:239], a[16:19], a[160:163], v[228:231]
ds_read_b128 a[16:19], v2 offset:4096
v_mfma_f32_16x16x32_bf16 v[236:239], a[20:23], a[164:167], v[236:239]
ds_read_b128 a[20:23], v2 offset:4352
s_nop 1
v_exp_f32 v232, v232
v_mfma_f32_16x16x32_bf16 v[236:239], a[24:27], a[168:171], v[236:239]
ds_read_b128 a[24:27], v2 offset:4608
v_exp_f32 v233, v233
v_mfma_f32_16x16x32_bf16 v[236:239], a[28:31], a[172:175], v[236:239]
ds_read_b128 a[28:31], v2 offset:4864
v_cvt_pk_bf16_f32 v248, v232, v233
v_mfma_f32_16x16x32_bf16 v[128:131], a[32:35], v[252:255], v[128:131]
v_exp_f32 v234, v234
v_mfma_f32_16x16x32_bf16 v[132:135], a[36:39], v[252:255], v[132:135]
v_exp_f32 v235, v235
v_mfma_f32_16x16x32_bf16 v[136:139], a[40:43], v[252:255], v[136:139]
v_cvt_pk_bf16_f32 v249, v234, v235
v_add_u32 v2, 0x8000, v2
v_mfma_f32_16x16x32_bf16 v[140:143], a[44:47], v[252:255], v[140:143]
v_exp_f32 v236, v236
v_mfma_f32_16x16x32_bf16 v[144:147], a[64:67], v[252:255], v[144:147]
v_exp_f32 v237, v237
v_mfma_f32_16x16x32_bf16 v[148:151], a[68:71], v[252:255], v[148:151]
v_exp_f32 v238, v238
v_mfma_f32_16x16x32_bf16 v[152:155], a[72:75], v[252:255], v[152:155]
v_exp_f32 v239, v239
v_mfma_f32_16x16x32_bf16 v[156:159], a[76:79], v[252:255], v[156:159]
v_cvt_pk_bf16_f32 v250, v236, v237
v_cvt_pk_bf16_f32 v251, v238, v239
v_mfma_f32_16x16x32_bf16 v[204:207], a[252:255], v[252:255], v[204:207]
v_and_b32 v2, 0x1ffff, v2
s_waitcnt lgkmcnt(2)
s_mov_b32 s41, 4
K1_L1:
v_mfma_f32_16x16x32_bf16 v[240:243], a[0:3], a[96:99], v[212:215]
v_mfma_f32_16x16x32_bf16 v[240:243], a[4:7], a[100:103], v[240:243]
v_mfma_f32_16x16x32_bf16 v[240:243], a[8:11], a[104:107], v[240:243]
v_mfma_f32_16x16x32_bf16 v[240:243], a[12:15], a[108:111], v[240:243]
v_mfma_f32_16x16x32_bf16 v[244:247], a[16:19], a[96:99], v[212:215]
v_mfma_f32_16x16x32_bf16 v[244:247], a[20:23], a[100:103], v[244:247]
s_nop 5
v_exp_f32 v240, v240
s_waitcnt lgkmcnt(0)
v_mfma_f32_16x16x32_bf16 v[244:247], a[24:27], a[104:107], v[244:247]
v_exp_f32 v241, v241
v_mfma_f32_16x16x32_bf16 v[244:247], a[28:31], a[108:111], v[244:247]
v_exp_f32 v242, v242
v_mfma_f32_16x16x32_bf16 v[160:163], a[32:35], v[248:251], v[160:163]
ds_read_b64_tr_b16 a[32:33], v3 offset:16384
v_cvt_pk_bf16_f32 v252, v240, v241
v_mfma_f32_16x16x32_bf16 v[164:167], a[36:39], v[248:251], v[164:167]
ds_read_b64_tr_b16 a[34:35], v3 offset:20480
v_exp_f32 v243, v243
v_mfma_f32_16x16x32_bf16 v[168:171], a[40:43], v[248:251], v[168:171]
ds_read_b64_tr_b16 a[36:37], v4 offset:16384
v_cvt_pk_bf16_f32 v253, v242, v243
v_mfma_f32_16x16x32_bf16 v[172:175], a[44:47], v[248:251], v[172:175]
ds_read_b64_tr_b16 a[38:39], v4 offset:20480
v_exp_f32 v244, v244
v_mfma_f32_16x16x32_bf16 v[176:179], a[64:67], v[248:251], v[176:179]
ds_read_b64_tr_b16 a[40:41], v3 offset:16640
v_exp_f32 v245, v245
v_mfma_f32_16x16x32_bf16 v[180:183], a[68:71], v[248:251], v[180:183]
ds_read_b64_tr_b16 a[42:43], v3 offset:20736
v_cvt_pk_bf16_f32 v254, v244, v245
v_mfma_f32_16x16x32_bf16 v[184:187], a[72:75], v[248:251], v[184:187]
ds_read_b64_tr_b16 a[44:45], v4 offset:16640
v_add_u32 v3, 0x8000, v3
v_mfma_f32_16x16x32_bf16 v[188:191], a[76:79], v[248:251], v[188:191]
ds_read_b64_tr_b16 a[46:47], v4 offset:20736
v_and_b32 v3, 0x1ffff, v3
v_mfma_f32_16x16x32_bf16 v[208:211], a[252:255], v[248:251], v[208:211]
v_exp_f32 v246, v246
v_mfma_f32_16x16x32_bf16 v[232:235], a[0:3], a[112:115], v[216:219]
v_exp_f32 v247, v247
v_mfma_f32_16x16x32_bf16 v[232:235], a[4:7], a[116:119], v[232:235]
v_cvt_pk_bf16_f32 v255, v246, v247
ds_read_b64_tr_b16 a[64:65], v3 offset:16896
v_mfma_f32_16x16x32_bf16 v[232:235], a[8:11], a[120:123], v[232:235]
v_add_u32 v4, 0x8000, v4
ds_read_b64_tr_b16 a[66:67], v3 offset:20992
v_mfma_f32_16x16x32_bf16 v[232:235], a[12:15], a[124:127], v[232:235]
v_and_b32 v4, 0x1ffff, v4
ds_read_b64_tr_b16 a[68:69], v4 offset:16896
v_mfma_f32_16x16x32_bf16 v[236:239], a[16:19], a[112:115], v[216:219]
ds_read_b64_tr_b16 a[70:71], v4 offset:20992
v_mfma_f32_16x16x32_bf16 v[236:239], a[20:23], a[116:119], v[236:239]
ds_read_b64_tr_b16 a[72:73], v3 offset:17152
s_nop 1
v_exp_f32 v232, v232
v_mfma_f32_16x16x32_bf16 v[236:239], a[24:27], a[120:123], v[236:239]
v_exp_f32 v233, v233
v_mfma_f32_16x16x32_bf16 v[236:239], a[28:31], a[124:127], v[236:239]
v_exp_f32 v234, v234
s_waitcnt lgkmcnt(8)
v_mfma_f32_16x16x32_bf16 v[32:35], a[32:35], v[252:255], v[32:35]
v_exp_f32 v235, v235
v_mfma_f32_16x16x32_bf16 v[36:39], a[36:39], v[252:255], v[36:39]
v_cvt_pk_bf16_f32 v248, v232, v233
v_cvt_pk_bf16_f32 v249, v234, v235
s_waitcnt lgkmcnt(5)
v_mfma_f32_16x16x32_bf16 v[40:43], a[40:43], v[252:255], v[40:43]
v_exp_f32 v236, v236
v_mfma_f32_16x16x32_bf16 v[44:47], a[44:47], v[252:255], v[44:47]
v_exp_f32 v237, v237
v_mfma_f32_16x16x32_bf16 v[48:51], a[48:51], v[252:255], v[48:51]
v_exp_f32 v238, v238
v_mfma_f32_16x16x32_bf16 v[52:55], a[52:55], v[252:255], v[52:55]
v_exp_f32 v239, v239
v_mfma_f32_16x16x32_bf16 v[56:59], a[56:59], v[252:255], v[56:59]
v_cvt_pk_bf16_f32 v250, v236, v237
v_cvt_pk_bf16_f32 v251, v238, v239
v_mfma_f32_16x16x32_bf16 v[60:63], a[60:63], v[252:255], v[60:63]
ds_read_b64_tr_b16 a[74:75], v3 offset:21248
s_waitcnt vmcnt(8)
s_barrier
v_mfma_f32_16x16x32_bf16 v[192:195], a[252:255], v[252:255], v[192:195]
ds_read_b64_tr_b16 a[76:77], v4 offset:17152
s_add_u32 m0, s38, 0
v_mfma_f32_16x16x32_bf16 v[240:243], a[0:3], a[128:131], v[220:223]
ds_read_b64_tr_b16 a[78:79], v4 offset:21248
buffer_load_dwordx4 v5, s[12:15], s37 offen nt lds
v_mfma_f32_16x16x32_bf16 v[240:243], a[4:7], a[132:135], v[240:243]
v_mfma_f32_16x16x32_bf16 v[240:243], a[8:11], a[136:139], v[240:243]
v_mfma_f32_16x16x32_bf16 v[240:243], a[12:15], a[140:143], v[240:243]
buffer_load_dwordx4 v5, s[12:15], s37 offen offset:1024 nt lds
s_add_u32 m0, s38, 4096
v_mfma_f32_16x16x32_bf16 v[244:247], a[16:19], a[128:131], v[220:223]
s_add_u32 s38, s38, 32768
s_and_b32 s38, s38, 0x1ffff
v_mfma_f32_16x16x32_bf16 v[244:247], a[20:23], a[132:135], v[244:247]
s_nop 2
v_exp_f32 v240, v240
v_mfma_f32_16x16x32_bf16 v[244:247], a[24:27], a[136:139], v[244:247]
v_exp_f32 v241, v241
v_mfma_f32_16x16x32_bf16 v[244:247], a[28:31], a[140:143], v[244:247]
v_exp_f32 v242, v242
v_mfma_f32_16x16x32_bf16 v[64:67], a[32:35], v[248:251], v[64:67]
v_exp_f32 v243, v243
v_mfma_f32_16x16x32_bf16 v[68:71], a[36:39], v[248:251], v[68:71]
v_cvt_pk_bf16_f32 v252, v240, v241
v_cvt_pk_bf16_f32 v253, v242, v243
v_mfma_f32_16x16x32_bf16 v[72:75], a[40:43], v[248:251], v[72:75]
buffer_load_dwordx4 v5, s[12:15], s40 offen nt lds
v_exp_f32 v244, v244
v_mfma_f32_16x16x32_bf16 v[76:79], a[44:47], v[248:251], v[76:79]
v_exp_f32 v245, v245
v_mfma_f32_16x16x32_bf16 v[80:83], a[48:51], v[248:251], v[80:83]
v_exp_f32 v246, v246
v_mfma_f32_16x16x32_bf16 v[84:87], a[52:55], v[248:251], v[84:87]
v_exp_f32 v247, v247
v_mfma_f32_16x16x32_bf16 v[88:91], a[56:59], v[248:251], v[88:91]
v_cvt_pk_bf16_f32 v254, v244, v245
v_cvt_pk_bf16_f32 v255, v246, v247
v_mfma_f32_16x16x32_bf16 v[92:95], a[60:63], v[248:251], v[92:95]
buffer_load_dwordx4 v5, s[12:15], s40 offen offset:1024 nt lds
s_add_u32 m0, s39, 0
v_mfma_f32_16x16x32_bf16 v[196:199], a[252:255], v[248:251], v[196:199]
v_mfma_f32_16x16x32_bf16 v[232:235], a[0:3], a[144:147], v[224:227]
v_mfma_f32_16x16x32_bf16 v[232:235], a[4:7], a[148:151], v[232:235]
buffer_load_dwordx4 v6, s[16:19], s37 offen nt lds
v_mfma_f32_16x16x32_bf16 v[232:235], a[8:11], a[152:155], v[232:235]
v_mfma_f32_16x16x32_bf16 v[232:235], a[12:15], a[156:159], v[232:235]
v_mfma_f32_16x16x32_bf16 v[236:239], a[16:19], a[144:147], v[224:227]
buffer_load_dwordx4 v6, s[16:19], s37 offen offset:2048 nt lds
s_add_u32 m0, s39, 4096
v_mfma_f32_16x16x32_bf16 v[236:239], a[20:23], a[148:151], v[236:239]
s_add_u32 s37, s37, 8192
s_add_u32 s39, s39, 32768
s_and_b32 s39, s39, 0x1ffff
v_mfma_f32_16x16x32_bf16 v[236:239], a[24:27], a[152:155], v[236:239]
s_nop 0
v_exp_f32 v232, v232
v_mfma_f32_16x16x32_bf16 v[236:239], a[28:31], a[156:159], v[236:239]
v_exp_f32 v233, v233
v_mfma_f32_16x16x32_bf16 v[96:99], a[32:35], v[252:255], v[96:99]
v_exp_f32 v234, v234
v_mfma_f32_16x16x32_bf16 v[100:103], a[36:39], v[252:255], v[100:103]
v_exp_f32 v235, v235
v_mfma_f32_16x16x32_bf16 v[104:107], a[40:43], v[252:255], v[104:107]
v_cvt_pk_bf16_f32 v248, v232, v233
v_cvt_pk_bf16_f32 v249, v234, v235
v_mfma_f32_16x16x32_bf16 v[108:111], a[44:47], v[252:255], v[108:111]
v_exp_f32 v236, v236
v_mfma_f32_16x16x32_bf16 v[112:115], a[48:51], v[252:255], v[112:115]
v_exp_f32 v237, v237
v_mfma_f32_16x16x32_bf16 v[116:119], a[52:55], v[252:255], v[116:119]
v_exp_f32 v238, v238
v_mfma_f32_16x16x32_bf16 v[120:123], a[56:59], v[252:255], v[120:123]
v_exp_f32 v239, v239
v_mfma_f32_16x16x32_bf16 v[124:127], a[60:63], v[252:255], v[124:127]
v_cvt_pk_bf16_f32 v250, v236, v237
v_cvt_pk_bf16_f32 v251, v238, v239
v_mfma_f32_16x16x32_bf16 v[200:203], a[252:255], v[252:255], v[200:203]
buffer_load_dwordx4 v6, s[16:19], s40 offen nt lds
v_mfma_f32_16x16x32_bf16 v[240:243], a[0:3], a[160:163], v[228:231]
ds_read_b128 a[0:3], v2 offset:0
v_mfma_f32_16x16x32_bf16 v[240:243], a[4:7], a[164:167], v[240:243]
ds_read_b128 a[4:7], v2 offset:256
v_mfma_f32_16x16x32_bf16 v[240:243], a[8:11], a[168:171], v[240:243]
ds_read_b128 a[8:11], v2 offset:512
buffer_load_dwordx4 v6, s[16:19], s40 offen offset:2048 nt lds
v_mfma_f32_16x16x32_bf16 v[240:243], a[12:15], a[172:175], v[240:243]
ds_read_b128 a[12:15], v2 offset:768
s_add_u32 s40, s40, 8192
v_mfma_f32_16x16x32_bf16 v[244:247], a[16:19], a[160:163], v[228:231]
ds_read_b128 a[16:19], v2 offset:4096
v_mfma_f32_16x16x32_bf16 v[244:247], a[20:23], a[164:167], v[244:247]
ds_read_b128 a[20:23], v2 offset:4352
s_nop 1
v_exp_f32 v240, v240
v_mfma_f32_16x16x32_bf16 v[244:247], a[24:27], a[168:171], v[244:247]
ds_read_b128 a[24:27], v2 offset:4608
v_exp_f32 v241, v241
v_mfma_f32_16x16x32_bf16 v[244:247], a[28:31], a[172:175], v[244:247]
ds_read_b128 a[28:31], v2 offset:4864
v_cvt_pk_bf16_f32 v252, v240, v241
v_mfma_f32_16x16x32_bf16 v[128:131], a[32:35], v[248:251], v[128:131]
v_exp_f32 v242, v242
v_mfma_f32_16x16x32_bf16 v[132:135], a[36:39], v[248:251], v[132:135]
v_exp_f32 v243, v243
v_mfma_f32_16x16x32_bf16 v[136:139], a[40:43], v[248:251], v[136:139]
v_cvt_pk_bf16_f32 v253, v242, v243
v_add_u32 v2, 0x8000, v2
v_mfma_f32_16x16x32_bf16 v[140:143], a[44:47], v[248:251], v[140:143]
v_exp_f32 v244, v244
v_mfma_f32_16x16x32_bf16 v[144:147], a[48:51], v[248:251], v[144:147]
v_exp_f32 v245, v245
v_mfma_f32_16x16x32_bf16 v[148:151], a[52:55], v[248:251], v[148:151]
v_exp_f32 v246, v246
v_mfma_f32_16x16x32_bf16 v[152:155], a[56:59], v[248:251], v[152:155]
v_exp_f32 v247, v247
v_mfma_f32_16x16x32_bf16 v[156:159], a[60:63], v[248:251], v[156:159]
v_cvt_pk_bf16_f32 v254, v244, v245
v_cvt_pk_bf16_f32 v255, v246, v247
v_mfma_f32_16x16x32_bf16 v[204:207], a[252:255], v[248:251], v[204:207]
v_and_b32 v2, 0x1ffff, v2
s_waitcnt lgkmcnt(2)
v_mfma_f32_16x16x32_bf16 v[232:235], a[0:3], a[96:99], v[212:215]
v_mfma_f32_16x16x32_bf16 v[232:235], a[4:7], a[100:103], v[232:235]
v_mfma_f32_16x16x32_bf16 v[232:235], a[8:11], a[104:107], v[232:235]
v_mfma_f32_16x16x32_bf16 v[232:235], a[12:15], a[108:111], v[232:235]
v_mfma_f32_16x16x32_bf16 v[236:239], a[16:19], a[96:99], v[212:215]
v_mfma_f32_16x16x32_bf16 v[236:239], a[20:23], a[100:103], v[236:239]
s_nop 5
v_exp_f32 v232, v232
s_waitcnt lgkmcnt(0)
v_mfma_f32_16x16x32_bf16 v[236:239], a[24:27], a[104:107], v[236:239]
v_exp_f32 v233, v233
v_mfma_f32_16x16x32_bf16 v[236:239], a[28:31], a[108:111], v[236:239]
v_exp_f32 v234, v234
v_mfma_f32_16x16x32_bf16 v[160:163], a[32:35], v[252:255], v[160:163]
ds_read_b64_tr_b16 a[32:33], v3 offset:16384
v_cvt_pk_bf16_f32 v248, v232, v233
v_mfma_f32_16x16x32_bf16 v[164:167], a[36:39], v[252:255], v[164:167]
ds_read_b64_tr_b16 a[34:35], v3 offset:20480
v_exp_f32 v235, v235
v_mfma_f32_16x16x32_bf16 v[168:171], a[40:43], v[252:255], v[168:171]
ds_read_b64_tr_b16 a[36:37], v4 offset:16384
v_cvt_pk_bf16_f32 v249, v234, v235
v_mfma_f32_16x16x32_bf16 v[172:175], a[44:47], v[252:255], v[172:175]
ds_read_b64_tr_b16 a[38:39], v4 offset:20480
v_exp_f32 v236, v236
v_mfma_f32_16x16x32_bf16 v[176:179], a[48:51], v[252:255], v[176:179]
ds_read_b64_tr_b16 a[40:41], v3 offset:16640
v_exp_f32 v237, v237
v_mfma_f32_16x16x32_bf16 v[180:183], a[52:55], v[252:255], v[180:183]
ds_read_b64_tr_b16 a[42:43], v3 offset:20736
v_cvt_pk_bf16_f32 v250, v236, v237
v_mfma_f32_16x16x32_bf16 v[184:187], a[56:59], v[252:255], v[184:187]
ds_read_b64_tr_b16 a[44:45], v4 offset:16640
v_add_u32 v3, 0x8000, v3
v_mfma_f32_16x16x32_bf16 v[188:191], a[60:63], v[252:255], v[188:191]
ds_read_b64_tr_b16 a[46:47], v4 offset:20736
v_and_b32 v3, 0x1ffff, v3
v_mfma_f32_16x16x32_bf16 v[208:211], a[252:255], v[252:255], v[208:211]
v_exp_f32 v238, v238
v_mfma_f32_16x16x32_bf16 v[240:243], a[0:3], a[112:115], v[216:219]
v_exp_f32 v239, v239
v_mfma_f32_16x16x32_bf16 v[240:243], a[4:7], a[116:119], v[240:243]
v_cvt_pk_bf16_f32 v251, v238, v239
ds_read_b64_tr_b16 a[48:49], v3 offset:16896
v_mfma_f32_16x16x32_bf16 v[240:243], a[8:11], a[120:123], v[240:243]
v_add_u32 v4, 0x8000, v4
ds_read_b64_tr_b16 a[50:51], v3 offset:20992
v_mfma_f32_16x16x32_bf16 v[240:243], a[12:15], a[124:127], v[240:243]
v_and_b32 v4, 0x1ffff, v4
ds_read_b64_tr_b16 a[52:53], v4 offset:16896
v_mfma_f32_16x16x32_bf16 v[244:247], a[16:19], a[112:115], v[216:219]
ds_read_b64_tr_b16 a[54:55], v4 offset:20992
v_mfma_f32_16x16x32_bf16 v[244:247], a[20:23], a[116:119], v[244:247]
ds_read_b64_tr_b16 a[56:57], v3 offset:17152
s_nop 1
v_exp_f32 v240, v240
v_mfma_f32_16x16x32_bf16 v[244:247], a[24:27], a[120:123], v[244:247]
v_exp_f32 v241, v241
v_mfma_f32_16x16x32_bf16 v[244:247], a[28:31], a[124:127], v[244:247]
v_exp_f32 v242, v242
s_waitcnt lgkmcnt(8)
v_mfma_f32_16x16x32_bf16 v[32:35], a[32:35], v[248:251], v[32:35]
v_exp_f32 v243, v243
v_mfma_f32_16x16x32_bf16 v[36:39], a[36:39], v[248:251], v[36:39]
v_cvt_pk_bf16_f32 v252, v240, v241
v_cvt_pk_bf16_f32 v253, v242, v243
s_waitcnt lgkmcnt(5)
v_mfma_f32_16x16x32_bf16 v[40:43], a[40:43], v[248:251], v[40:43]
v_exp_f32 v244, v244
v_mfma_f32_16x16x32_bf16 v[44:47], a[44:47], v[248:251], v[44:47]
v_exp_f32 v245, v245
v_mfma_f32_16x16x32_bf16 v[48:51], a[64:67], v[248:251], v[48:51]
v_exp_f32 v246, v246
v_mfma_f32_16x16x32_bf16 v[52:55], a[68:71], v[248:251], v[52:55]
v_exp_f32 v247, v247
v_mfma_f32_16x16x32_bf16 v[56:59], a[72:75], v[248:251], v[56:59]
v_cvt_pk_bf16_f32 v254, v244, v245
v_cvt_pk_bf16_f32 v255, v246, v247
v_mfma_f32_16x16x32_bf16 v[60:63], a[76:79], v[248:251], v[60:63]
ds_read_b64_tr_b16 a[58:59], v3 offset:21248
s_waitcnt vmcnt(8)
s_barrier
v_mfma_f32_16x16x32_bf16 v[192:195], a[252:255], v[248:251], v[192:195]
ds_read_b64_tr_b16 a[60:61], v4 offset:17152
s_add_u32 m0, s38, 0
v_mfma_f32_16x16x32_bf16 v[232:235], a[0:3], a[128:131], v[220:223]
ds_read_b64_tr_b16 a[62:63], v4 offset:21248
buffer_load_dwordx4 v5, s[12:15], s37 offen nt lds
v_mfma_f32_16x16x32_bf16 v[232:235], a[4:7], a[132:135], v[232:235]
v_mfma_f32_16x16x32_bf16 v[232:235], a[8:11], a[136:139], v[232:235]
v_mfma_f32_16x16x32_bf16 v[232:235], a[12:15], a[140:143], v[232:235]
buffer_load_dwordx4 v5, s[12:15], s37 offen offset:1024 nt lds
s_add_u32 m0, s38, 4096
v_mfma_f32_16x16x32_bf16 v[236:239], a[16:19], a[128:131], v[220:223]
s_add_u32 s38, s38, 32768
s_and_b32 s38, s38, 0x1ffff
v_mfma_f32_16x16x32_bf16 v[236:239], a[20:23], a[132:135], v[236:239]
s_nop 2
v_exp_f32 v232, v232
v_mfma_f32_16x16x32_bf16 v[236:239], a[24:27], a[136:139], v[236:239]
v_exp_f32 v233, v233
v_mfma_f32_16x16x32_bf16 v[236:239], a[28:31], a[140:143], v[236:239]
v_exp_f32 v234, v234
v_mfma_f32_16x16x32_bf16 v[64:67], a[32:35], v[252:255], v[64:67]
v_exp_f32 v235, v235
v_mfma_f32_16x16x32_bf16 v[68:71], a[36:39], v[252:255], v[68:71]
v_cvt_pk_bf16_f32 v248, v232, v233
v_cvt_pk_bf16_f32 v249, v234, v235
v_mfma_f32_16x16x32_bf16 v[72:75], a[40:43], v[252:255], v[72:75]
buffer_load_dwordx4 v5, s[12:15], s40 offen nt lds
v_exp_f32 v236, v236
v_mfma_f32_16x16x32_bf16 v[76:79], a[44:47], v[252:255], v[76:79]
v_exp_f32 v237, v237
v_mfma_f32_16x16x32_bf16 v[80:83], a[64:67], v[252:255], v[80:83]
v_exp_f32 v238, v238
v_mfma_f32_16x16x32_bf16 v[84:87], a[68:71], v[252:255], v[84:87]
v_exp_f32 v239, v239
v_mfma_f32_16x16x32_bf16 v[88:91], a[72:75], v[252:255], v[88:91]
v_cvt_pk_bf16_f32 v250, v236, v237
v_cvt_pk_bf16_f32 v251, v238, v239
v_mfma_f32_16x16x32_bf16 v[92:95], a[76:79], v[252:255], v[92:95]
buffer_load_dwordx4 v5, s[12:15], s40 offen offset:1024 nt lds
s_add_u32 m0, s39, 0
v_mfma_f32_16x16x32_bf16 v[196:199], a[252:255], v[252:255], v[196:199]
v_mfma_f32_16x16x32_bf16 v[240:243], a[0:3], a[144:147], v[224:227]
v_mfma_f32_16x16x32_bf16 v[240:243], a[4:7], a[148:151], v[240:243]
buffer_load_dwordx4 v6, s[16:19], s37 offen nt lds
v_mfma_f32_16x16x32_bf16 v[240:243], a[8:11], a[152:155], v[240:243]
v_mfma_f32_16x16x32_bf16 v[240:243], a[12:15], a[156:159], v[240:243]
v_mfma_f32_16x16x32_bf16 v[244:247], a[16:19], a[144:147], v[224:227]
buffer_load_dwordx4 v6, s[16:19], s37 offen offset:2048 nt lds
s_add_u32 m0, s39, 4096
v_mfma_f32_16x16x32_bf16 v[244:247], a[20:23], a[148:151], v[244:247]
s_add_u32 s37, s37, 8192
s_add_u32 s39, s39, 32768
s_and_b32 s39, s39, 0x1ffff
v_mfma_f32_16x16x32_bf16 v[244:247], a[24:27], a[152:155], v[244:247]
s_nop 0
v_exp_f32 v240, v240
v_mfma_f32_16x16x32_bf16 v[244:247], a[28:31], a[156:159], v[244:247]
v_exp_f32 v241, v241
v_mfma_f32_16x16x32_bf16 v[96:99], a[32:35], v[248:251], v[96:99]
v_exp_f32 v242, v242
v_mfma_f32_16x16x32_bf16 v[100:103], a[36:39], v[248:251], v[100:103]
v_exp_f32 v243, v243
v_mfma_f32_16x16x32_bf16 v[104:107], a[40:43], v[248:251], v[104:107]
v_cvt_pk_bf16_f32 v252, v240, v241
v_cvt_pk_bf16_f32 v253, v242, v243
v_mfma_f32_16x16x32_bf16 v[108:111], a[44:47], v[248:251], v[108:111]
v_exp_f32 v244, v244
v_mfma_f32_16x16x32_bf16 v[112:115], a[64:67], v[248:251], v[112:115]
v_exp_f32 v245, v245
v_mfma_f32_16x16x32_bf16 v[116:119], a[68:71], v[248:251], v[116:119]
v_exp_f32 v246, v246
v_mfma_f32_16x16x32_bf16 v[120:123], a[72:75], v[248:251], v[120:123]
v_exp_f32 v247, v247
v_mfma_f32_16x16x32_bf16 v[124:127], a[76:79], v[248:251], v[124:127]
v_cvt_pk_bf16_f32 v254, v244, v245
v_cvt_pk_bf16_f32 v255, v246, v247
v_mfma_f32_16x16x32_bf16 v[200:203], a[252:255], v[248:251], v[200:203]
buffer_load_dwordx4 v6, s[16:19], s40 offen nt lds
v_mfma_f32_16x16x32_bf16 v[232:235], a[0:3], a[160:163], v[228:231]
ds_read_b128 a[0:3], v2 offset:0
v_mfma_f32_16x16x32_bf16 v[232:235], a[4:7], a[164:167], v[232:235]
ds_read_b128 a[4:7], v2 offset:256
v_mfma_f32_16x16x32_bf16 v[232:235], a[8:11], a[168:171], v[232:235]
ds_read_b128 a[8:11], v2 offset:512
buffer_load_dwordx4 v6, s[16:19], s40 offen offset:2048 nt lds
v_mfma_f32_16x16x32_bf16 v[232:235], a[12:15], a[172:175], v[232:235]
ds_read_b128 a[12:15], v2 offset:768
s_add_u32 s40, s40, 8192
v_mfma_f32_16x16x32_bf16 v[236:239], a[16:19], a[160:163], v[228:231]
ds_read_b128 a[16:19], v2 offset:4096
v_mfma_f32_16x16x32_bf16 v[236:239], a[20:23], a[164:167], v[236:239]
ds_read_b128 a[20:23], v2 offset:4352
s_nop 1
v_exp_f32 v232, v232
v_mfma_f32_16x16x32_bf16 v[236:239], a[24:27], a[168:171], v[236:239]
ds_read_b128 a[24:27], v2 offset:4608
v_exp_f32 v233, v233
v_mfma_f32_16x16x32_bf16 v[236:239], a[28:31], a[172:175], v[236:239]
ds_read_b128 a[28:31], v2 offset:4864
v_cvt_pk_bf16_f32 v248, v232, v233
v_mfma_f32_16x16x32_bf16 v[128:131], a[32:35], v[252:255], v[128:131]
v_exp_f32 v234, v234
v_mfma_f32_16x16x32_bf16 v[132:135], a[36:39], v[252:255], v[132:135]
v_exp_f32 v235, v235
v_mfma_f32_16x16x32_bf16 v[136:139], a[40:43], v[252:255], v[136:139]
v_cvt_pk_bf16_f32 v249, v234, v235
v_add_u32 v2, 0x8000, v2
v_mfma_f32_16x16x32_bf16 v[140:143], a[44:47], v[252:255], v[140:143]
v_exp_f32 v236, v236
v_mfma_f32_16x16x32_bf16 v[144:147], a[64:67], v[252:255], v[144:147]
v_exp_f32 v237, v237
v_mfma_f32_16x16x32_bf16 v[148:151], a[68:71], v[252:255], v[148:151]
v_exp_f32 v238, v238
v_mfma_f32_16x16x32_bf16 v[152:155], a[72:75], v[252:255], v[152:155]
v_exp_f32 v239, v239
v_mfma_f32_16x16x32_bf16 v[156:159], a[76:79], v[252:255], v[156:159]
v_cvt_pk_bf16_f32 v250, v236, v237
v_cvt_pk_bf16_f32 v251, v238, v239
v_mfma_f32_16x16x32_bf16 v[204:207], a[252:255], v[252:255], v[204:207]
v_and_b32 v2, 0x1ffff, v2
s_waitcnt lgkmcnt(2)
s_sub_u32 s41, s41, 1
s_cmp_lg_u32 s41, 0
s_cbranch_scc1 K1_L1
v_mfma_f32_16x16x32_bf16 v[240:243], a[0:3], a[96:99], v[212:215]
v_mfma_f32_16x16x32_bf16 v[240:243], a[4:7], a[100:103], v[240:243]
v_mfma_f32_16x16x32_bf16 v[240:243], a[8:11], a[104:107], v[240:243]
v_mfma_f32_16x16x32_bf16 v[240:243], a[12:15], a[108:111], v[240:243]
v_mfma_f32_16x16x32_bf16 v[244:247], a[16:19], a[96:99], v[212:215]
v_mfma_f32_16x16x32_bf16 v[244:247], a[20:23], a[100:103], v[244:247]
s_nop 5
v_exp_f32 v240, v240
s_waitcnt lgkmcnt(0)
v_mfma_f32_16x16x32_bf16 v[244:247], a[24:27], a[104:107], v[244:247]
v_exp_f32 v241, v241
v_mfma_f32_16x16x32_bf16 v[244:247], a[28:31], a[108:111], v[244:247]
v_exp_f32 v242, v242
v_mfma_f32_16x16x32_bf16 v[160:163], a[32:35], v[248:251], v[160:163]
ds_read_b64_tr_b16 a[32:33], v3 offset:16384
v_cvt_pk_bf16_f32 v252, v240, v241
v_mfma_f32_16x16x32_bf16 v[164:167], a[36:39], v[248:251], v[164:167]
ds_read_b64_tr_b16 a[34:35], v3 offset:20480
v_exp_f32 v243, v243
v_mfma_f32_16x16x32_bf16 v[168:171], a[40:43], v[248:251], v[168:171]
ds_read_b64_tr_b16 a[36:37], v4 offset:16384
v_cvt_pk_bf16_f32 v253, v242, v243
v_mfma_f32_16x16x32_bf16 v[172:175], a[44:47], v[248:251], v[172:175]
ds_read_b64_tr_b16 a[38:39], v4 offset:20480
v_exp_f32 v244, v244
v_mfma_f32_16x16x32_bf16 v[176:179], a[64:67], v[248:251], v[176:179]
ds_read_b64_tr_b16 a[40:41], v3 offset:16640
v_exp_f32 v245, v245
v_mfma_f32_16x16x32_bf16 v[180:183], a[68:71], v[248:251], v[180:183]
ds_read_b64_tr_b16 a[42:43], v3 offset:20736
v_cvt_pk_bf16_f32 v254, v244, v245
v_mfma_f32_16x16x32_bf16 v[184:187], a[72:75], v[248:251], v[184:187]
ds_read_b64_tr_b16 a[44:45], v4 offset:16640
v_add_u32 v3, 0x8000, v3
v_mfma_f32_16x16x32_bf16 v[188:191], a[76:79], v[248:251], v[188:191]
ds_read_b64_tr_b16 a[46:47], v4 offset:20736
v_and_b32 v3, 0x1ffff, v3
v_mfma_f32_16x16x32_bf16 v[208:211], a[252:255], v[248:251], v[208:211]
v_exp_f32 v246, v246
v_mfma_f32_16x16x32_bf16 v[232:235], a[0:3], a[112:115], v[216:219]
v_exp_f32 v247, v247
v_mfma_f32_16x16x32_bf16 v[232:235], a[4:7], a[116:119], v[232:235]
v_cvt_pk_bf16_f32 v255, v246, v247
ds_read_b64_tr_b16 a[64:65], v3 offset:16896
v_mfma_f32_16x16x32_bf16 v[232:235], a[8:11], a[120:123], v[232:235]
v_add_u32 v4, 0x8000, v4
ds_read_b64_tr_b16 a[66:67], v3 offset:20992
v_mfma_f32_16x16x32_bf16 v[232:235], a[12:15], a[124:127], v[232:235]
v_and_b32 v4, 0x1ffff, v4
ds_read_b64_tr_b16 a[68:69], v4 offset:16896
v_mfma_f32_16x16x32_bf16 v[236:239], a[16:19], a[112:115], v[216:219]
ds_read_b64_tr_b16 a[70:71], v4 offset:20992
v_mfma_f32_16x16x32_bf16 v[236:239], a[20:23], a[116:119], v[236:239]
ds_read_b64_tr_b16 a[72:73], v3 offset:17152
s_nop 1
v_exp_f32 v232, v232
v_mfma_f32_16x16x32_bf16 v[236:239], a[24:27], a[120:123], v[236:239]
v_exp_f32 v233, v233
v_mfma_f32_16x16x32_bf16 v[236:239], a[28:31], a[124:127], v[236:239]
v_exp_f32 v234, v234
s_waitcnt lgkmcnt(8)
v_mfma_f32_16x16x32_bf16 v[32:35], a[32:35], v[252:255], v[32:35]
v_exp_f32 v235, v235
v_mfma_f32_16x16x32_bf16 v[36:39], a[36:39], v[252:255], v[36:39]
v_cvt_pk_bf16_f32 v248, v232, v233
v_cvt_pk_bf16_f32 v249, v234, v235
s_waitcnt lgkmcnt(5)
v_mfma_f32_16x16x32_bf16 v[40:43], a[40:43], v[252:255], v[40:43]
v_exp_f32 v236, v236
v_mfma_f32_16x16x32_bf16 v[44:47], a[44:47], v[252:255], v[44:47]
v_exp_f32 v237, v237
v_mfma_f32_16x16x32_bf16 v[48:51], a[48:51], v[252:255], v[48:51]
v_exp_f32 v238, v238
v_mfma_f32_16x16x32_bf16 v[52:55], a[52:55], v[252:255], v[52:55]
v_exp_f32 v239, v239
v_mfma_f32_16x16x32_bf16 v[56:59], a[56:59], v[252:255], v[56:59]
v_cvt_pk_bf16_f32 v250, v236, v237
v_cvt_pk_bf16_f32 v251, v238, v239
v_mfma_f32_16x16x32_bf16 v[60:63], a[60:63], v[252:255], v[60:63]
ds_read_b64_tr_b16 a[74:75], v3 offset:21248
s_waitcnt vmcnt(8)
s_barrier
v_mfma_f32_16x16x32_bf16 v[192:195], a[252:255], v[252:255], v[192:195]
ds_read_b64_tr_b16 a[76:77], v4 offset:17152
buffer_load_dword a248, v13, s[24:27], s45 offen
v_mfma_f32_16x16x32_bf16 v[240:243], a[0:3], a[128:131], v[220:223]
ds_read_b64_tr_b16 a[78:79], v4 offset:21248
s_add_u32 s45, s45, 8192
v_mfma_f32_16x16x32_bf16 v[240:243], a[4:7], a[132:135], v[240:243]
v_mfma_f32_16x16x32_bf16 v[240:243], a[8:11], a[136:139], v[240:243]
v_mfma_f32_16x16x32_bf16 v[240:243], a[12:15], a[140:143], v[240:243]
v_mfma_f32_16x16x32_bf16 v[244:247], a[16:19], a[128:131], v[220:223]
v_mfma_f32_16x16x32_bf16 v[244:247], a[20:23], a[132:135], v[244:247]
s_nop 5
v_exp_f32 v240, v240
v_mfma_f32_16x16x32_bf16 v[244:247], a[24:27], a[136:139], v[244:247]
v_exp_f32 v241, v241
v_mfma_f32_16x16x32_bf16 v[244:247], a[28:31], a[140:143], v[244:247]
v_exp_f32 v242, v242
v_mfma_f32_16x16x32_bf16 v[64:67], a[32:35], v[248:251], v[64:67]
v_exp_f32 v243, v243
v_mfma_f32_16x16x32_bf16 v[68:71], a[36:39], v[248:251], v[68:71]
v_cvt_pk_bf16_f32 v252, v240, v241
v_cvt_pk_bf16_f32 v253, v242, v243
v_mfma_f32_16x16x32_bf16 v[72:75], a[40:43], v[248:251], v[72:75]
s_nop 0
v_exp_f32 v244, v244
v_mfma_f32_16x16x32_bf16 v[76:79], a[44:47], v[248:251], v[76:79]
v_exp_f32 v245, v245
v_mfma_f32_16x16x32_bf16 v[80:83], a[48:51], v[248:251], v[80:83]
v_exp_f32 v246, v246
v_mfma_f32_16x16x32_bf16 v[84:87], a[52:55], v[248:251], v[84:87]
v_exp_f32 v247, v247
v_mfma_f32_16x16x32_bf16 v[88:91], a[56:59], v[248:251], v[88:91]
v_cvt_pk_bf16_f32 v254, v244, v245
v_cvt_pk_bf16_f32 v255, v246, v247
v_mfma_f32_16x16x32_bf16 v[92:95], a[60:63], v[248:251], v[92:95]
v_mfma_f32_16x16x32_bf16 v[196:199], a[252:255], v[248:251], v[196:199]
v_mfma_f32_16x16x32_bf16 v[232:235], a[0:3], a[144:147], v[224:227]
v_mfma_f32_16x16x32_bf16 v[232:235], a[4:7], a[148:151], v[232:235]
v_mfma_f32_16x16x32_bf16 v[232:235], a[8:11], a[152:155], v[232:235]
v_mfma_f32_16x16x32_bf16 v[232:235], a[12:15], a[156:159], v[232:235]
v_mfma_f32_16x16x32_bf16 v[236:239], a[16:19], a[144:147], v[224:227]
v_mfma_f32_16x16x32_bf16 v[236:239], a[20:23], a[148:151], v[236:239]
s_nop 5
v_exp_f32 v232, v232
v_mfma_f32_16x16x32_bf16 v[236:239], a[24:27], a[152:155], v[236:239]
v_exp_f32 v233, v233
v_mfma_f32_16x16x32_bf16 v[236:239], a[28:31], a[156:159], v[236:239]
v_exp_f32 v234, v234
v_mfma_f32_16x16x32_bf16 v[96:99], a[32:35], v[252:255], v[96:99]
v_exp_f32 v235, v235
v_mfma_f32_16x16x32_bf16 v[100:103], a[36:39], v[252:255], v[100:103]
v_cvt_pk_bf16_f32 v248, v232, v233
v_cvt_pk_bf16_f32 v249, v234, v235
v_mfma_f32_16x16x32_bf16 v[104:107], a[40:43], v[252:255], v[104:107]
s_nop 0
v_exp_f32 v236, v236
v_mfma_f32_16x16x32_bf16 v[108:111], a[44:47], v[252:255], v[108:111]
v_exp_f32 v237, v237
v_mfma_f32_16x16x32_bf16 v[112:115], a[48:51], v[252:255], v[112:115]
v_exp_f32 v238, v238
v_mfma_f32_16x16x32_bf16 v[116:119], a[52:55], v[252:255], v[116:119]
v_exp_f32 v239, v239
v_mfma_f32_16x16x32_bf16 v[120:123], a[56:59], v[252:255], v[120:123]
v_cvt_pk_bf16_f32 v250, v236, v237
v_cvt_pk_bf16_f32 v251, v238, v239
v_mfma_f32_16x16x32_bf16 v[124:127], a[60:63], v[252:255], v[124:127]
v_mfma_f32_16x16x32_bf16 v[200:203], a[252:255], v[252:255], v[200:203]
v_mfma_f32_16x16x32_bf16 v[240:243], a[0:3], a[160:163], v[228:231]
ds_read_b128 a[0:3], v2 offset:0
v_mfma_f32_16x16x32_bf16 v[240:243], a[4:7], a[164:167], v[240:243]
ds_read_b128 a[4:7], v2 offset:256
v_mfma_f32_16x16x32_bf16 v[240:243], a[8:11], a[168:171], v[240:243]
ds_read_b128 a[8:11], v2 offset:512
v_mfma_f32_16x16x32_bf16 v[240:243], a[12:15], a[172:175], v[240:243]
ds_read_b128 a[12:15], v2 offset:768
v_mfma_f32_16x16x32_bf16 v[244:247], a[16:19], a[160:163], v[228:231]
ds_read_b128 a[16:19], v2 offset:4096
v_mfma_f32_16x16x32_bf16 v[244:247], a[20:23], a[164:167], v[244:247]
ds_read_b128 a[20:23], v2 offset:4352
s_nop 2
v_exp_f32 v240, v240
v_mfma_f32_16x16x32_bf16 v[244:247], a[24:27], a[168:171], v[244:247]
ds_read_b128 a[24:27], v2 offset:4608
v_exp_f32 v241, v241
v_mfma_f32_16x16x32_bf16 v[244:247], a[28:31], a[172:175], v[244:247]
ds_read_b128 a[28:31], v2 offset:4864
v_cvt_pk_bf16_f32 v252, v240, v241
v_mfma_f32_16x16x32_bf16 v[128:131], a[32:35], v[248:251], v[128:131]
v_exp_f32 v242, v242
v_mfma_f32_16x16x32_bf16 v[132:135], a[36:39], v[248:251], v[132:135]
v_exp_f32 v243, v243
v_mfma_f32_16x16x32_bf16 v[136:139], a[40:43], v[248:251], v[136:139]
v_cvt_pk_bf16_f32 v253, v242, v243
v_add_u32 v2, 0x8000, v2
v_mfma_f32_16x16x32_bf16 v[140:143], a[44:47], v[248:251], v[140:143]
v_exp_f32 v244, v244
v_mfma_f32_16x16x32_bf16 v[144:147], a[48:51], v[248:251], v[144:147]
v_exp_f32 v245, v245
v_mfma_f32_16x16x32_bf16 v[148:151], a[52:55], v[248:251], v[148:151]
v_exp_f32 v246, v246
v_mfma_f32_16x16x32_bf16 v[152:155], a[56:59], v[248:251], v[152:155]
v_exp_f32 v247, v247
v_mfma_f32_16x16x32_bf16 v[156:159], a[60:63], v[248:251], v[156:159]
v_cvt_pk_bf16_f32 v254, v244, v245
v_cvt_pk_bf16_f32 v255, v246, v247
v_mfma_f32_16x16x32_bf16 v[204:207], a[252:255], v[248:251], v[204:207]
v_and_b32 v2, 0x1ffff, v2
s_waitcnt lgkmcnt(2)
v_mfma_f32_16x16x32_bf16 v[232:235], a[0:3], a[96:99], v[212:215]
v_mfma_f32_16x16x32_bf16 v[232:235], a[4:7], a[100:103], v[232:235]
v_mfma_f32_16x16x32_bf16 v[232:235], a[8:11], a[104:107], v[232:235]
v_mfma_f32_16x16x32_bf16 v[232:235], a[12:15], a[108:111], v[232:235]
v_mfma_f32_16x16x32_bf16 v[236:239], a[16:19], a[96:99], v[212:215]
v_mfma_f32_16x16x32_bf16 v[236:239], a[20:23], a[100:103], v[236:239]
s_nop 5
v_exp_f32 v232, v232
s_waitcnt lgkmcnt(0)
v_mfma_f32_16x16x32_bf16 v[236:239], a[24:27], a[104:107], v[236:239]
v_exp_f32 v233, v233
v_mfma_f32_16x16x32_bf16 v[236:239], a[28:31], a[108:111], v[236:239]
v_exp_f32 v234, v234
v_mfma_f32_16x16x32_bf16 v[160:163], a[32:35], v[252:255], v[160:163]
ds_read_b64_tr_b16 a[32:33], v3 offset:16384
v_cvt_pk_bf16_f32 v248, v232, v233
v_mfma_f32_16x16x32_bf16 v[164:167], a[36:39], v[252:255], v[164:167]
ds_read_b64_tr_b16 a[34:35], v3 offset:20480
v_exp_f32 v235, v235
v_mfma_f32_16x16x32_bf16 v[168:171], a[40:43], v[252:255], v[168:171]
ds_read_b64_tr_b16 a[36:37], v4 offset:16384
v_cvt_pk_bf16_f32 v249, v234, v235
v_mfma_f32_16x16x32_bf16 v[172:175], a[44:47], v[252:255], v[172:175]
ds_read_b64_tr_b16 a[38:39], v4 offset:20480
v_exp_f32 v236, v236
v_mfma_f32_16x16x32_bf16 v[176:179], a[48:51], v[252:255], v[176:179]
ds_read_b64_tr_b16 a[40:41], v3 offset:16640
v_exp_f32 v237, v237
v_mfma_f32_16x16x32_bf16 v[180:183], a[52:55], v[252:255], v[180:183]
ds_read_b64_tr_b16 a[42:43], v3 offset:20736
v_cvt_pk_bf16_f32 v250, v236, v237
v_mfma_f32_16x16x32_bf16 v[184:187], a[56:59], v[252:255], v[184:187]
ds_read_b64_tr_b16 a[44:45], v4 offset:16640
v_add_u32 v3, 0x8000, v3
v_mfma_f32_16x16x32_bf16 v[188:191], a[60:63], v[252:255], v[188:191]
ds_read_b64_tr_b16 a[46:47], v4 offset:20736
v_and_b32 v3, 0x1ffff, v3
v_mfma_f32_16x16x32_bf16 v[208:211], a[252:255], v[252:255], v[208:211]
v_exp_f32 v238, v238
v_mfma_f32_16x16x32_bf16 v[240:243], a[0:3], a[112:115], v[216:219]
v_exp_f32 v239, v239
v_mfma_f32_16x16x32_bf16 v[240:243], a[4:7], a[116:119], v[240:243]
v_cvt_pk_bf16_f32 v251, v238, v239
ds_read_b64_tr_b16 a[48:49], v3 offset:16896
v_mfma_f32_16x16x32_bf16 v[240:243], a[8:11], a[120:123], v[240:243]
v_add_u32 v4, 0x8000, v4
ds_read_b64_tr_b16 a[50:51], v3 offset:20992
v_mfma_f32_16x16x32_bf16 v[240:243], a[12:15], a[124:127], v[240:243]
v_and_b32 v4, 0x1ffff, v4
ds_read_b64_tr_b16 a[52:53], v4 offset:16896
v_mfma_f32_16x16x32_bf16 v[244:247], a[16:19], a[112:115], v[216:219]
ds_read_b64_tr_b16 a[54:55], v4 offset:20992
v_mfma_f32_16x16x32_bf16 v[244:247], a[20:23], a[116:119], v[244:247]
ds_read_b64_tr_b16 a[56:57], v3 offset:17152
s_nop 1
v_exp_f32 v240, v240
v_mfma_f32_16x16x32_bf16 v[244:247], a[24:27], a[120:123], v[244:247]
v_exp_f32 v241, v241
v_mfma_f32_16x16x32_bf16 v[244:247], a[28:31], a[124:127], v[244:247]
v_exp_f32 v242, v242
s_waitcnt lgkmcnt(8)
v_mfma_f32_16x16x32_bf16 v[32:35], a[32:35], v[248:251], v[32:35]
v_exp_f32 v243, v243
v_mfma_f32_16x16x32_bf16 v[36:39], a[36:39], v[248:251], v[36:39]
v_cvt_pk_bf16_f32 v252, v240, v241
v_cvt_pk_bf16_f32 v253, v242, v243
s_waitcnt lgkmcnt(5)
v_mfma_f32_16x16x32_bf16 v[40:43], a[40:43], v[248:251], v[40:43]
v_exp_f32 v244, v244
v_mfma_f32_16x16x32_bf16 v[44:47], a[44:47], v[248:251], v[44:47]
v_exp_f32 v245, v245
v_mfma_f32_16x16x32_bf16 v[48:51], a[64:67], v[248:251], v[48:51]
v_exp_f32 v246, v246
v_mfma_f32_16x16x32_bf16 v[52:55], a[68:71], v[248:251], v[52:55]
v_exp_f32 v247, v247
v_mfma_f32_16x16x32_bf16 v[56:59], a[72:75], v[248:251], v[56:59]
v_cvt_pk_bf16_f32 v254, v244, v245
v_cvt_pk_bf16_f32 v255, v246, v247
v_mfma_f32_16x16x32_bf16 v[60:63], a[76:79], v[248:251], v[60:63]
ds_read_b64_tr_b16 a[58:59], v3 offset:21248
s_waitcnt vmcnt(1)
s_barrier
v_mfma_f32_16x16x32_bf16 v[192:195], a[252:255], v[248:251], v[192:195]
ds_read_b64_tr_b16 a[60:61], v4 offset:17152
buffer_load_dword a248, v13, s[24:27], s45 offen
v_mfma_f32_16x16x32_bf16 v[232:235], a[0:3], a[128:131], v[220:223]
ds_read_b64_tr_b16 a[62:63], v4 offset:21248
s_add_u32 s45, s45, 8192
v_mfma_f32_16x16x32_bf16 v[232:235], a[4:7], a[132:135], v[232:235]
v_mfma_f32_16x16x32_bf16 v[232:235], a[8:11], a[136:139], v[232:235]
v_mfma_f32_16x16x32_bf16 v[232:235], a[12:15], a[140:143], v[232:235]
v_mfma_f32_16x16x32_bf16 v[236:239], a[16:19], a[128:131], v[220:223]
v_mfma_f32_16x16x32_bf16 v[236:239], a[20:23], a[132:135], v[236:239]
s_nop 5
v_exp_f32 v232, v232
v_mfma_f32_16x16x32_bf16 v[236:239], a[24:27], a[136:139], v[236:239]
v_exp_f32 v233, v233
v_mfma_f32_16x16x32_bf16 v[236:239], a[28:31], a[140:143], v[236:239]
v_exp_f32 v234, v234
v_mfma_f32_16x16x32_bf16 v[64:67], a[32:35], v[252:255], v[64:67]
v_exp_f32 v235, v235
v_mfma_f32_16x16x32_bf16 v[68:71], a[36:39], v[252:255], v[68:71]
v_cvt_pk_bf16_f32 v248, v232, v233
v_cvt_pk_bf16_f32 v249, v234, v235
v_mfma_f32_16x16x32_bf16 v[72:75], a[40:43], v[252:255], v[72:75]
s_nop 0
v_exp_f32 v236, v236
v_mfma_f32_16x16x32_bf16 v[76:79], a[44:47], v[252:255], v[76:79]
v_exp_f32 v237, v237
v_mfma_f32_16x16x32_bf16 v[80:83], a[64:67], v[252:255], v[80:83]
v_exp_f32 v238, v238
v_mfma_f32_16x16x32_bf16 v[84:87], a[68:71], v[252:255], v[84:87]
v_exp_f32 v239, v239
v_mfma_f32_16x16x32_bf16 v[88:91], a[72:75], v[252:255], v[88:91]
v_cvt_pk_bf16_f32 v250, v236, v237
v_cvt_pk_bf16_f32 v251, v238, v239
v_mfma_f32_16x16x32_bf16 v[92:95], a[76:79], v[252:255], v[92:95]
v_mfma_f32_16x16x32_bf16 v[196:199], a[252:255], v[252:255], v[196:199]
v_mfma_f32_16x16x32_bf16 v[240:243], a[0:3], a[144:147], v[224:227]
v_mfma_f32_16x16x32_bf16 v[240:243], a[4:7], a[148:151], v[240:243]
v_mfma_f32_16x16x32_bf16 v[240:243], a[8:11], a[152:155], v[240:243]
v_mfma_f32_16x16x32_bf16 v[240:243], a[12:15], a[156:159], v[240:243]
v_mfma_f32_16x16x32_bf16 v[244:247], a[16:19], a[144:147], v[224:227]
v_mfma_f32_16x16x32_bf16 v[244:247], a[20:23], a[148:151], v[244:247]
s_nop 5
v_exp_f32 v240, v240
v_mfma_f32_16x16x32_bf16 v[244:247], a[24:27], a[152:155], v[244:247]
v_exp_f32 v241, v241
v_mfma_f32_16x16x32_bf16 v[244:247], a[28:31], a[156:159], v[244:247]
v_exp_f32 v242, v242
v_mfma_f32_16x16x32_bf16 v[96:99], a[32:35], v[248:251], v[96:99]
v_exp_f32 v243, v243
v_mfma_f32_16x16x32_bf16 v[100:103], a[36:39], v[248:251], v[100:103]
v_cvt_pk_bf16_f32 v252, v240, v241
v_cvt_pk_bf16_f32 v253, v242, v243
v_mfma_f32_16x16x32_bf16 v[104:107], a[40:43], v[248:251], v[104:107]
s_nop 0
v_exp_f32 v244, v244
v_mfma_f32_16x16x32_bf16 v[108:111], a[44:47], v[248:251], v[108:111]
v_exp_f32 v245, v245
v_mfma_f32_16x16x32_bf16 v[112:115], a[64:67], v[248:251], v[112:115]
v_exp_f32 v246, v246
v_mfma_f32_16x16x32_bf16 v[116:119], a[68:71], v[248:251], v[116:119]
v_exp_f32 v247, v247
v_mfma_f32_16x16x32_bf16 v[120:123], a[72:75], v[248:251], v[120:123]
v_cvt_pk_bf16_f32 v254, v244, v245
v_cvt_pk_bf16_f32 v255, v246, v247
v_mfma_f32_16x16x32_bf16 v[124:127], a[76:79], v[248:251], v[124:127]
v_mfma_f32_16x16x32_bf16 v[200:203], a[252:255], v[248:251], v[200:203]
v_mfma_f32_16x16x32_bf16 v[232:235], a[0:3], a[160:163], v[228:231]
ds_read_b128 a[0:3], v2 offset:0
v_mfma_f32_16x16x32_bf16 v[232:235], a[4:7], a[164:167], v[232:235]
ds_read_b128 a[4:7], v2 offset:256
v_mfma_f32_16x16x32_bf16 v[232:235], a[8:11], a[168:171], v[232:235]
ds_read_b128 a[8:11], v2 offset:512
v_mfma_f32_16x16x32_bf16 v[232:235], a[12:15], a[172:175], v[232:235]
ds_read_b128 a[12:15], v2 offset:768
v_mfma_f32_16x16x32_bf16 v[236:239], a[16:19], a[160:163], v[228:231]
ds_read_b128 a[16:19], v2 offset:4096
v_mfma_f32_16x16x32_bf16 v[236:239], a[20:23], a[164:167], v[236:239]
ds_read_b128 a[20:23], v2 offset:4352
s_nop 2
v_exp_f32 v232, v232
v_mfma_f32_16x16x32_bf16 v[236:239], a[24:27], a[168:171], v[236:239]
ds_read_b128 a[24:27], v2 offset:4608
v_exp_f32 v233, v233
v_mfma_f32_16x16x32_bf16 v[236:239], a[28:31], a[172:175], v[236:239]
ds_read_b128 a[28:31], v2 offset:4864
v_cvt_pk_bf16_f32 v248, v232, v233
v_mfma_f32_16x16x32_bf16 v[128:131], a[32:35], v[252:255], v[128:131]
v_exp_f32 v234, v234
v_mfma_f32_16x16x32_bf16 v[132:135], a[36:39], v[252:255], v[132:135]
v_exp_f32 v235, v235
v_mfma_f32_16x16x32_bf16 v[136:139], a[40:43], v[252:255], v[136:139]
v_cvt_pk_bf16_f32 v249, v234, v235
v_add_u32 v2, 0x8000, v2
v_mfma_f32_16x16x32_bf16 v[140:143], a[44:47], v[252:255], v[140:143]
v_exp_f32 v236, v236
v_mfma_f32_16x16x32_bf16 v[144:147], a[64:67], v[252:255], v[144:147]
v_exp_f32 v237, v237
v_mfma_f32_16x16x32_bf16 v[148:151], a[68:71], v[252:255], v[148:151]
v_exp_f32 v238, v238
v_mfma_f32_16x16x32_bf16 v[152:155], a[72:75], v[252:255], v[152:155]
v_exp_f32 v239, v239
v_mfma_f32_16x16x32_bf16 v[156:159], a[76:79], v[252:255], v[156:159]
v_cvt_pk_bf16_f32 v250, v236, v237
v_cvt_pk_bf16_f32 v251, v238, v239
v_mfma_f32_16x16x32_bf16 v[204:207], a[252:255], v[252:255], v[204:207]
v_and_b32 v2, 0x1ffff, v2
s_waitcnt lgkmcnt(2)
v_mfma_f32_16x16x32_bf16 v[240:243], a[0:3], a[96:99], v[212:215]
v_mfma_f32_16x16x32_bf16 v[240:243], a[4:7], a[100:103], v[240:243]
v_mfma_f32_16x16x32_bf16 v[240:243], a[8:11], a[104:107], v[240:243]
v_mfma_f32_16x16x32_bf16 v[240:243], a[12:15], a[108:111], v[240:243]
v_mfma_f32_16x16x32_bf16 v[244:247], a[16:19], a[96:99], v[212:215]
v_mfma_f32_16x16x32_bf16 v[244:247], a[20:23], a[100:103], v[244:247]
s_nop 5
v_exp_f32 v240, v240
s_waitcnt lgkmcnt(0)
v_mfma_f32_16x16x32_bf16 v[244:247], a[24:27], a[104:107], v[244:247]
v_exp_f32 v241, v241
v_mfma_f32_16x16x32_bf16 v[244:247], a[28:31], a[108:111], v[244:247]
v_exp_f32 v242, v242
v_mfma_f32_16x16x32_bf16 v[160:163], a[32:35], v[248:251], v[160:163]
ds_read_b64_tr_b16 a[32:33], v3 offset:16384
v_cvt_pk_bf16_f32 v252, v240, v241
v_mfma_f32_16x16x32_bf16 v[164:167], a[36:39], v[248:251], v[164:167]
ds_read_b64_tr_b16 a[34:35], v3 offset:20480
v_exp_f32 v243, v243
v_mfma_f32_16x16x32_bf16 v[168:171], a[40:43], v[248:251], v[168:171]
ds_read_b64_tr_b16 a[36:37], v4 offset:16384
v_cvt_pk_bf16_f32 v253, v242, v243
v_mfma_f32_16x16x32_bf16 v[172:175], a[44:47], v[248:251], v[172:175]
ds_read_b64_tr_b16 a[38:39], v4 offset:20480
v_exp_f32 v244, v244
v_mfma_f32_16x16x32_bf16 v[176:179], a[64:67], v[248:251], v[176:179]
ds_read_b64_tr_b16 a[40:41], v3 offset:16640
v_exp_f32 v245, v245
v_mfma_f32_16x16x32_bf16 v[180:183], a[68:71], v[248:251], v[180:183]
ds_read_b64_tr_b16 a[42:43], v3 offset:20736
v_cvt_pk_bf16_f32 v254, v244, v245
v_mfma_f32_16x16x32_bf16 v[184:187], a[72:75], v[248:251], v[184:187]
ds_read_b64_tr_b16 a[44:45], v4 offset:16640
v_add_u32 v3, 0x8000, v3
v_mfma_f32_16x16x32_bf16 v[188:191], a[76:79], v[248:251], v[188:191]
ds_read_b64_tr_b16 a[46:47], v4 offset:20736
v_and_b32 v3, 0x1ffff, v3
v_mfma_f32_16x16x32_bf16 v[208:211], a[252:255], v[248:251], v[208:211]
v_exp_f32 v246, v246
v_mfma_f32_16x16x32_bf16 v[232:235], a[0:3], a[112:115], v[216:219]
v_exp_f32 v247, v247
v_mfma_f32_16x16x32_bf16 v[232:235], a[4:7], a[116:119], v[232:235]
v_cvt_pk_bf16_f32 v255, v246, v247
ds_read_b64_tr_b16 a[64:65], v3 offset:16896
v_mfma_f32_16x16x32_bf16 v[232:235], a[8:11], a[120:123], v[232:235]
v_add_u32 v4, 0x8000, v4
ds_read_b64_tr_b16 a[66:67], v3 offset:20992
v_mfma_f32_16x16x32_bf16 v[232:235], a[12:15], a[124:127], v[232:235]
v_and_b32 v4, 0x1ffff, v4
ds_read_b64_tr_b16 a[68:69], v4 offset:16896
v_mfma_f32_16x16x32_bf16 v[236:239], a[16:19], a[112:115], v[216:219]
ds_read_b64_tr_b16 a[70:71], v4 offset:20992
v_mfma_f32_16x16x32_bf16 v[236:239], a[20:23], a[116:119], v[236:239]
ds_read_b64_tr_b16 a[72:73], v3 offset:17152
s_nop 1
v_exp_f32 v232, v232
v_mfma_f32_16x16x32_bf16 v[236:239], a[24:27], a[120:123], v[236:239]
v_exp_f32 v233, v233
v_mfma_f32_16x16x32_bf16 v[236:239], a[28:31], a[124:127], v[236:239]
v_exp_f32 v234, v234
s_waitcnt lgkmcnt(8)
v_mfma_f32_16x16x32_bf16 v[32:35], a[32:35], v[252:255], v[32:35]
v_exp_f32 v235, v235
v_mfma_f32_16x16x32_bf16 v[36:39], a[36:39], v[252:255], v[36:39]
v_cvt_pk_bf16_f32 v248, v232, v233
v_cvt_pk_bf16_f32 v249, v234, v235
s_waitcnt lgkmcnt(5)
v_mfma_f32_16x16x32_bf16 v[40:43], a[40:43], v[252:255], v[40:43]
v_exp_f32 v236, v236
v_mfma_f32_16x16x32_bf16 v[44:47], a[44:47], v[252:255], v[44:47]
v_exp_f32 v237, v237
v_mfma_f32_16x16x32_bf16 v[48:51], a[48:51], v[252:255], v[48:51]
v_exp_f32 v238, v238
v_mfma_f32_16x16x32_bf16 v[52:55], a[52:55], v[252:255], v[52:55]
v_exp_f32 v239, v239
v_mfma_f32_16x16x32_bf16 v[56:59], a[56:59], v[252:255], v[56:59]
v_cvt_pk_bf16_f32 v250, v236, v237
v_cvt_pk_bf16_f32 v251, v238, v239
v_mfma_f32_16x16x32_bf16 v[60:63], a[60:63], v[252:255], v[60:63]
ds_read_b64_tr_b16 a[74:75], v3 offset:21248
v_mfma_f32_16x16x32_bf16 v[192:195], a[252:255], v[252:255], v[192:195]
ds_read_b64_tr_b16 a[76:77], v4 offset:17152
v_mfma_f32_16x16x32_bf16 v[240:243], a[0:3], a[128:131], v[220:223]
ds_read_b64_tr_b16 a[78:79], v4 offset:21248
v_mfma_f32_16x16x32_bf16 v[240:243], a[4:7], a[132:135], v[240:243]
v_mfma_f32_16x16x32_bf16 v[240:243], a[8:11], a[136:139], v[240:243]
v_mfma_f32_16x16x32_bf16 v[240:243], a[12:15], a[140:143], v[240:243]
v_mfma_f32_16x16x32_bf16 v[244:247], a[16:19], a[128:131], v[220:223]
v_mfma_f32_16x16x32_bf16 v[244:247], a[20:23], a[132:135], v[244:247]
s_nop 5
v_exp_f32 v240, v240
v_mfma_f32_16x16x32_bf16 v[244:247], a[24:27], a[136:139], v[244:247]
v_exp_f32 v241, v241
v_mfma_f32_16x16x32_bf16 v[244:247], a[28:31], a[140:143], v[244:247]
v_exp_f32 v242, v242
v_mfma_f32_16x16x32_bf16 v[64:67], a[32:35], v[248:251], v[64:67]
v_exp_f32 v243, v243
v_mfma_f32_16x16x32_bf16 v[68:71], a[36:39], v[248:251], v[68:71]
v_cvt_pk_bf16_f32 v252, v240, v241
v_cvt_pk_bf16_f32 v253, v242, v243
v_mfma_f32_16x16x32_bf16 v[72:75], a[40:43], v[248:251], v[72:75]
s_nop 0
v_exp_f32 v244, v244
v_mfma_f32_16x16x32_bf16 v[76:79], a[44:47], v[248:251], v[76:79]
v_exp_f32 v245, v245
v_mfma_f32_16x16x32_bf16 v[80:83], a[48:51], v[248:251], v[80:83]
v_exp_f32 v246, v246
v_mfma_f32_16x16x32_bf16 v[84:87], a[52:55], v[248:251], v[84:87]
v_exp_f32 v247, v247
v_mfma_f32_16x16x32_bf16 v[88:91], a[56:59], v[248:251], v[88:91]
v_cvt_pk_bf16_f32 v254, v244, v245
v_cvt_pk_bf16_f32 v255, v246, v247
v_mfma_f32_16x16x32_bf16 v[92:95], a[60:63], v[248:251], v[92:95]
v_mfma_f32_16x16x32_bf16 v[196:199], a[252:255], v[248:251], v[196:199]
v_mfma_f32_16x16x32_bf16 v[232:235], a[0:3], a[144:147], v[224:227]
v_mfma_f32_16x16x32_bf16 v[232:235], a[4:7], a[148:151], v[232:235]
v_mfma_f32_16x16x32_bf16 v[232:235], a[8:11], a[152:155], v[232:235]
v_mfma_f32_16x16x32_bf16 v[232:235], a[12:15], a[156:159], v[232:235]
v_mfma_f32_16x16x32_bf16 v[236:239], a[16:19], a[144:147], v[224:227]
v_mfma_f32_16x16x32_bf16 v[236:239], a[20:23], a[148:151], v[236:239]
s_nop 5
v_exp_f32 v232, v232
v_mfma_f32_16x16x32_bf16 v[236:239], a[24:27], a[152:155], v[236:239]
v_exp_f32 v233, v233
v_mfma_f32_16x16x32_bf16 v[236:239], a[28:31], a[156:159], v[236:239]
v_exp_f32 v234, v234
v_mfma_f32_16x16x32_bf16 v[96:99], a[32:35], v[252:255], v[96:99]
v_exp_f32 v235, v235
v_mfma_f32_16x16x32_bf16 v[100:103], a[36:39], v[252:255], v[100:103]
v_cvt_pk_bf16_f32 v248, v232, v233
v_cvt_pk_bf16_f32 v249, v234, v235
v_mfma_f32_16x16x32_bf16 v[104:107], a[40:43], v[252:255], v[104:107]
s_nop 0
v_exp_f32 v236, v236
v_mfma_f32_16x16x32_bf16 v[108:111], a[44:47], v[252:255], v[108:111]
v_exp_f32 v237, v237
v_mfma_f32_16x16x32_bf16 v[112:115], a[48:51], v[252:255], v[112:115]
v_exp_f32 v238, v238
v_mfma_f32_16x16x32_bf16 v[116:119], a[52:55], v[252:255], v[116:119]
v_exp_f32 v239, v239
v_mfma_f32_16x16x32_bf16 v[120:123], a[56:59], v[252:255], v[120:123]
v_cvt_pk_bf16_f32 v250, v236, v237
v_cvt_pk_bf16_f32 v251, v238, v239
v_mfma_f32_16x16x32_bf16 v[124:127], a[60:63], v[252:255], v[124:127]
v_mfma_f32_16x16x32_bf16 v[200:203], a[252:255], v[252:255], v[200:203]
v_mfma_f32_16x16x32_bf16 v[240:243], a[0:3], a[160:163], v[228:231]
ds_read_b128 a[0:3], v2 offset:0
v_mfma_f32_16x16x32_bf16 v[240:243], a[4:7], a[164:167], v[240:243]
ds_read_b128 a[4:7], v2 offset:256
v_mfma_f32_16x16x32_bf16 v[240:243], a[8:11], a[168:171], v[240:243]
ds_read_b128 a[8:11], v2 offset:512
v_mfma_f32_16x16x32_bf16 v[240:243], a[12:15], a[172:175], v[240:243]
ds_read_b128 a[12:15], v2 offset:768
v_mfma_f32_16x16x32_bf16 v[244:247], a[16:19], a[160:163], v[228:231]
ds_read_b128 a[16:19], v2 offset:4096
v_mfma_f32_16x16x32_bf16 v[244:247], a[20:23], a[164:167], v[244:247]
ds_read_b128 a[20:23], v2 offset:4352
s_nop 2
v_exp_f32 v240, v240
v_mfma_f32_16x16x32_bf16 v[244:247], a[24:27], a[168:171], v[244:247]
ds_read_b128 a[24:27], v2 offset:4608
v_exp_f32 v241, v241
v_mfma_f32_16x16x32_bf16 v[244:247], a[28:31], a[172:175], v[244:247]
ds_read_b128 a[28:31], v2 offset:4864
v_cvt_pk_bf16_f32 v252, v240, v241
v_mfma_f32_16x16x32_bf16 v[128:131], a[32:35], v[248:251], v[128:131]
v_exp_f32 v242, v242
v_mfma_f32_16x16x32_bf16 v[132:135], a[36:39], v[248:251], v[132:135]
v_exp_f32 v243, v243
v_mfma_f32_16x16x32_bf16 v[136:139], a[40:43], v[248:251], v[136:139]
v_cvt_pk_bf16_f32 v253, v242, v243
v_add_u32 v2, 0x8000, v2
v_mfma_f32_16x16x32_bf16 v[140:143], a[44:47], v[248:251], v[140:143]
v_exp_f32 v244, v244
v_mfma_f32_16x16x32_bf16 v[144:147], a[48:51], v[248:251], v[144:147]
v_exp_f32 v245, v245
v_mfma_f32_16x16x32_bf16 v[148:151], a[52:55], v[248:251], v[148:151]
v_exp_f32 v246, v246
v_mfma_f32_16x16x32_bf16 v[152:155], a[56:59], v[248:251], v[152:155]
v_exp_f32 v247, v247
v_mfma_f32_16x16x32_bf16 v[156:159], a[60:63], v[248:251], v[156:159]
v_cvt_pk_bf16_f32 v254, v244, v245
v_cvt_pk_bf16_f32 v255, v246, v247
v_mfma_f32_16x16x32_bf16 v[204:207], a[252:255], v[248:251], v[204:207]
v_and_b32 v2, 0x1ffff, v2
s_waitcnt lgkmcnt(2)
v_mfma_f32_16x16x32_bf16 v[232:235], a[0:3], a[96:99], v[212:215]
v_mfma_f32_16x16x32_bf16 v[232:235], a[4:7], a[100:103], v[232:235]
v_mfma_f32_16x16x32_bf16 v[232:235], a[8:11], a[104:107], v[232:235]
v_mfma_f32_16x16x32_bf16 v[232:235], a[12:15], a[108:111], v[232:235]
v_mfma_f32_16x16x32_bf16 v[236:239], a[16:19], a[96:99], v[212:215]
v_mfma_f32_16x16x32_bf16 v[236:239], a[20:23], a[100:103], v[236:239]
s_nop 5
v_exp_f32 v232, v232
s_waitcnt lgkmcnt(0)
v_mfma_f32_16x16x32_bf16 v[236:239], a[24:27], a[104:107], v[236:239]
v_exp_f32 v233, v233
v_mfma_f32_16x16x32_bf16 v[236:239], a[28:31], a[108:111], v[236:239]
v_exp_f32 v234, v234
v_mfma_f32_16x16x32_bf16 v[160:163], a[32:35], v[252:255], v[160:163]
ds_read_b64_tr_b16 a[32:33], v3 offset:16384
v_cvt_pk_bf16_f32 v248, v232, v233
v_mfma_f32_16x16x32_bf16 v[164:167], a[36:39], v[252:255], v[164:167]
ds_read_b64_tr_b16 a[34:35], v3 offset:20480
v_exp_f32 v235, v235
v_mfma_f32_16x16x32_bf16 v[168:171], a[40:43], v[252:255], v[168:171]
ds_read_b64_tr_b16 a[36:37], v4 offset:16384
v_cvt_pk_bf16_f32 v249, v234, v235
v_mfma_f32_16x16x32_bf16 v[172:175], a[44:47], v[252:255], v[172:175]
ds_read_b64_tr_b16 a[38:39], v4 offset:20480
v_exp_f32 v236, v236
v_mfma_f32_16x16x32_bf16 v[176:179], a[48:51], v[252:255], v[176:179]
ds_read_b64_tr_b16 a[40:41], v3 offset:16640
v_exp_f32 v237, v237
v_mfma_f32_16x16x32_bf16 v[180:183], a[52:55], v[252:255], v[180:183]
ds_read_b64_tr_b16 a[42:43], v3 offset:20736
v_cvt_pk_bf16_f32 v250, v236, v237
v_mfma_f32_16x16x32_bf16 v[184:187], a[56:59], v[252:255], v[184:187]
ds_read_b64_tr_b16 a[44:45], v4 offset:16640
v_add_u32 v3, 0x8000, v3
v_mfma_f32_16x16x32_bf16 v[188:191], a[60:63], v[252:255], v[188:191]
ds_read_b64_tr_b16 a[46:47], v4 offset:20736
v_add_u32 v4, 0x8000, v4
v_mfma_f32_16x16x32_bf16 v[208:211], a[252:255], v[252:255], v[208:211]
v_exp_f32 v238, v238
v_mfma_f32_16x16x32_bf16 v[240:243], a[0:3], a[112:115], v[216:219]
v_exp_f32 v239, v239
v_mfma_f32_16x16x32_bf16 v[240:243], a[4:7], a[116:119], v[240:243]
v_cvt_pk_bf16_f32 v251, v238, v239
v_and_b32 v3, 0x1ffff, v3
v_mfma_f32_16x16x32_bf16 v[240:243], a[8:11], a[120:123], v[240:243]
v_and_b32 v4, 0x1ffff, v4
v_mfma_f32_16x16x32_bf16 v[240:243], a[12:15], a[124:127], v[240:243]
v_mfma_f32_16x16x32_bf16 v[244:247], a[16:19], a[112:115], v[216:219]
v_mfma_f32_16x16x32_bf16 v[244:247], a[20:23], a[116:119], v[244:247]
s_nop 5
v_exp_f32 v240, v240
v_mfma_f32_16x16x32_bf16 v[244:247], a[24:27], a[120:123], v[244:247]
s_waitcnt lgkmcnt(0)
s_barrier
v_mfma_f32_16x16x32_bf16 v[244:247], a[28:31], a[124:127], v[244:247]
buffer_load_dword a248, v13, s[24:27], s45 offen
s_mov_b32 s56, 0
v_mfma_f32_16x16x32_bf16 v[32:35], a[32:35], v[248:251], v[32:35]
s_add_u32 s54, s56, s47
s_add_u32 m0, s54, 20480
v_mfma_f32_16x16x32_bf16 v[36:39], a[36:39], v[248:251], v[36:39]
s_mul_i32 s55, s61, 81920
s_add_u32 s55, s55, s98
s_add_u32 s61, s61, 1
s_and_b32 s61, s61, 15
s_add_u32 s56, s56, 40960
s_cmp_lt_u32 s56, 163840
s_cselect_b32 s56, s56, 0
v_mfma_f32_16x16x32_bf16 v[40:43], a[40:43], v[248:251], v[40:43]
buffer_load_dwordx4 v14, s[64:67], s55 offen lds
s_mov_b32 s57, 0
v_mfma_f32_16x16x32_bf16 v[44:47], a[44:47], v[248:251], v[44:47]
v_exp_f32 v241, v241
v_mfma_f32_16x16x32_bf16 v[48:51], a[64:67], v[248:251], v[48:51]
v_exp_f32 v242, v242
v_mfma_f32_16x16x32_bf16 v[52:55], a[68:71], v[248:251], v[52:55]
buffer_load_dwordx4 v15, s[64:67], s55 offen offset:1024 lds
v_cvt_pk_bf16_f32 v252, v240, v241
v_mfma_f32_16x16x32_bf16 v[56:59], a[72:75], v[248:251], v[56:59]
v_exp_f32 v243, v243
v_mfma_f32_16x16x32_bf16 v[60:63], a[76:79], v[248:251], v[60:63]
v_exp_f32 v244, v244
v_mfma_f32_16x16x32_bf16 v[192:195], a[252:255], v[248:251], v[192:195]
buffer_load_dwordx4 v16, s[64:67], s55 offen offset:2048 lds
v_cvt_pk_bf16_f32 v253, v242, v243
v_mfma_f32_16x16x32_bf16 v[232:235], a[0:3], a[128:131], v[220:223]
v_exp_f32 v245, v245
v_mfma_f32_16x16x32_bf16 v[232:235], a[4:7], a[132:135], v[232:235]
v_exp_f32 v246, v246
v_mfma_f32_16x16x32_bf16 v[232:235], a[8:11], a[136:139], v[232:235]
buffer_load_dwordx4 v17, s[64:67], s55 offen offset:3072 lds
s_add_u32 m0, s54, 24576
v_mfma_f32_16x16x32_bf16 v[232:235], a[12:15], a[140:143], v[232:235]
v_rcp_f32 v192, v192
v_mfma_f32_16x16x32_bf16 v[236:239], a[16:19], a[128:131], v[220:223]
v_mov_b32 v193, v192
v_pk_mul_f32 v[32:33], v[32:33], v[192:193]
v_mfma_f32_16x16x32_bf16 v[236:239], a[20:23], a[132:135], v[236:239]
buffer_load_dwordx4 v18, s[64:67], s55 offen lds
v_pk_mul_f32 v[34:35], v[34:35], v[192:193]
v_mfma_f32_16x16x32_bf16 v[236:239], a[24:27], a[136:139], v[236:239]
v_cvt_pk_bf16_f32 v32, v32, v33
s_add_u32 s54, s56, s47
v_mfma_f32_16x16x32_bf16 v[236:239], a[28:31], a[140:143], v[236:239]
v_pk_mul_f32 v[36:37], v[36:37], v[192:193]
v_pk_mul_f32 v[38:39], v[38:39], v[192:193]
v_cvt_pk_bf16_f32 v33, v34, v35
s_add_u32 m0, s54, 20480
v_cvt_pk_bf16_f32 v34, v36, v37
v_cvt_pk_bf16_f32 v35, v38, v39
v_exp_f32 v247, v247
s_mul_i32 s55, s61, 81920
s_add_u32 s55, s55, s98
s_add_u32 s61, s61, 1
s_and_b32 s61, s61, 15
ds_write_b128 v19, v[32:35] offset:0
buffer_load_dwordx4 v14, s[64:67], s55 offen lds
v_cvt_pk_bf16_f32 v254, v244, v245
v_cvt_pk_bf16_f32 v255, v246, v247
v_pk_mul_f32 v[40:41], v[40:41], v[192:193]
v_pk_mul_f32 v[42:43], v[42:43], v[192:193]
v_mfma_f32_16x16x32_bf16 v[64:67], a[32:35], v[252:255], v[64:67]
v_cvt_pk_bf16_f32 v40, v40, v41
v_pk_mul_f32 v[44:45], v[44:45], v[192:193]
v_mfma_f32_16x16x32_bf16 v[68:71], a[36:39], v[252:255], v[68:71]
v_pk_mul_f32 v[46:47], v[46:47], v[192:193]
v_cvt_pk_bf16_f32 v41, v42, v43
v_mfma_f32_16x16x32_bf16 v[72:75], a[40:43], v[252:255], v[72:75]
v_cvt_pk_bf16_f32 v42, v44, v45
v_cvt_pk_bf16_f32 v43, v46, v47
v_mfma_f32_16x16x32_bf16 v[76:79], a[44:47], v[252:255], v[76:79]
ds_write_b128 v19, v[40:43] offset:10240
v_mfma_f32_16x16x32_bf16 v[80:83], a[64:67], v[252:255], v[80:83]
buffer_load_dwordx4 v15, s[64:67], s55 offen offset:1024 lds
v_pk_mul_f32 v[48:49], v[48:49], v[192:193]
v_mfma_f32_16x16x32_bf16 v[84:87], a[68:71], v[252:255], v[84:87]
v_pk_mul_f32 v[50:51], v[50:51], v[192:193]
v_cvt_pk_bf16_f32 v48, v48, v49
v_mfma_f32_16x16x32_bf16 v[88:91], a[72:75], v[252:255], v[88:91]
v_pk_mul_f32 v[52:53], v[52:53], v[192:193]
v_pk_mul_f32 v[54:55], v[54:55], v[192:193]
v_mfma_f32_16x16x32_bf16 v[92:95], a[76:79], v[252:255], v[92:95]
v_cvt_pk_bf16_f32 v49, v50, v51
v_cvt_pk_bf16_f32 v50, v52, v53
v_mfma_f32_16x16x32_bf16 v[196:199], a[252:255], v[252:255], v[196:199]
v_cvt_pk_bf16_f32 v51, v54, v55
buffer_load_dwordx4 v16, s[64:67], s55 offen offset:2048 lds
v_mfma_f32_16x16x32_bf16 v[240:243], a[0:3], a[144:147], v[224:227]
ds_write_b128 v19, v[48:51] offset:40960
v_mfma_f32_16x16x32_bf16 v[240:243], a[4:7], a[148:151], v[240:243]
v_pk_mul_f32 v[56:57], v[56:57], v[192:193]
v_pk_mul_f32 v[58:59], v[58:59], v[192:193]
v_mfma_f32_16x16x32_bf16 v[240:243], a[8:11], a[152:155], v[240:243]
v_cvt_pk_bf16_f32 v56, v56, v57
v_pk_mul_f32 v[60:61], v[60:61], v[192:193]
v_mfma_f32_16x16x32_bf16 v[240:243], a[12:15], a[156:159], v[240:243]
v_pk_mul_f32 v[62:63], v[62:63], v[192:193]
v_cvt_pk_bf16_f32 v57, v58, v59
v_mfma_f32_16x16x32_bf16 v[244:247], a[16:19], a[144:147], v[224:227]
v_cvt_pk_bf16_f32 v58, v60, v61
v_cvt_pk_bf16_f32 v59, v62, v63
v_mfma_f32_16x16x32_bf16 v[244:247], a[20:23], a[148:151], v[244:247]
ds_write_b128 v19, v[56:59] offset:51200
v_mfma_f32_16x16x32_bf16 v[244:247], a[24:27], a[152:155], v[244:247]
buffer_load_dwordx4 v17, s[64:67], s55 offen offset:3072 lds
s_add_u32 m0, s54, 24576
v_mfma_f32_16x16x32_bf16 v[244:247], a[28:31], a[156:159], v[244:247]
v_rcp_f32 v196, v196
v_exp_f32 v232, v232
v_mov_b32 v197, v196
v_pk_mul_f32 v[64:65], v[64:65], v[196:197]
v_pk_mul_f32 v[66:67], v[66:67], v[196:197]
v_cvt_pk_bf16_f32 v64, v64, v65
v_pk_mul_f32 v[68:69], v[68:69], v[196:197]
v_pk_mul_f32 v[70:71], v[70:71], v[196:197]
v_cvt_pk_bf16_f32 v65, v66, v67
v_cvt_pk_bf16_f32 v66, v68, v69
v_cvt_pk_bf16_f32 v67, v70, v71
v_exp_f32 v233, v233
v_exp_f32 v234, v234
v_exp_f32 v235, v235
v_exp_f32 v236, v236
v_exp_f32 v237, v237
v_exp_f32 v238, v238
v_exp_f32 v239, v239
ds_write_b128 v19, v[64:67] offset:1024
buffer_load_dwordx4 v18, s[64:67], s55 offen lds
v_cvt_pk_bf16_f32 v248, v232, v233
v_cvt_pk_bf16_f32 v249, v234, v235
v_cvt_pk_bf16_f32 v250, v236, v237
v_cvt_pk_bf16_f32 v251, v238, v239
v_pk_mul_f32 v[72:73], v[72:73], v[196:197]
v_pk_mul_f32 v[74:75], v[74:75], v[196:197]
v_mfma_f32_16x16x32_bf16 v[96:99], a[32:35], v[248:251], v[96:99]
v_cvt_pk_bf16_f32 v72, v72, v73
v_pk_mul_f32 v[76:77], v[76:77], v[196:197]
v_mfma_f32_16x16x32_bf16 v[100:103], a[36:39], v[248:251], v[100:103]
v_pk_mul_f32 v[78:79], v[78:79], v[196:197]
v_cvt_pk_bf16_f32 v73, v74, v75
v_mfma_f32_16x16x32_bf16 v[104:107], a[40:43], v[248:251], v[104:107]
v_cvt_pk_bf16_f32 v74, v76, v77
v_cvt_pk_bf16_f32 v75, v78, v79
v_mfma_f32_16x16x32_bf16 v[108:111], a[44:47], v[248:251], v[108:111]
ds_write_b128 v19, v[72:75] offset:11264
v_mfma_f32_16x16x32_bf16 v[112:115], a[64:67], v[248:251], v[112:115]
v_pk_mul_f32 v[80:81], v[80:81], v[196:197]
v_pk_mul_f32 v[82:83], v[82:83], v[196:197]
v_mfma_f32_16x16x32_bf16 v[116:119], a[68:71], v[248:251], v[116:119]
v_cvt_pk_bf16_f32 v80, v80, v81
v_pk_mul_f32 v[84:85], v[84:85], v[196:197]
v_mfma_f32_16x16x32_bf16 v[120:123], a[72:75], v[248:251], v[120:123]
v_pk_mul_f32 v[86:87], v[86:87], v[196:197]
v_cvt_pk_bf16_f32 v81, v82, v83
v_mfma_f32_16x16x32_bf16 v[124:127], a[76:79], v[248:251], v[124:127]
v_cvt_pk_bf16_f32 v82, v84, v85
v_cvt_pk_bf16_f32 v83, v86, v87
v_mfma_f32_16x16x32_bf16 v[200:203], a[252:255], v[248:251], v[200:203]
ds_write_b128 v19, v[80:83] offset:41984
v_mfma_f32_16x16x32_bf16 v[232:235], a[0:3], a[160:163], v[228:231]
v_pk_mul_f32 v[88:89], v[88:89], v[196:197]
v_pk_mul_f32 v[90:91], v[90:91], v[196:197]
v_mfma_f32_16x16x32_bf16 v[232:235], a[4:7], a[164:167], v[232:235]
v_cvt_pk_bf16_f32 v88, v88, v89
v_pk_mul_f32 v[92:93], v[92:93], v[196:197]
v_mfma_f32_16x16x32_bf16 v[232:235], a[8:11], a[168:171], v[232:235]
v_pk_mul_f32 v[94:95], v[94:95], v[196:197]
v_cvt_pk_bf16_f32 v89, v90, v91
v_mfma_f32_16x16x32_bf16 v[232:235], a[12:15], a[172:175], v[232:235]
v_cvt_pk_bf16_f32 v90, v92, v93
v_cvt_pk_bf16_f32 v91, v94, v95
v_mfma_f32_16x16x32_bf16 v[236:239], a[16:19], a[160:163], v[228:231]
ds_write_b128 v19, v[88:91] offset:52224
v_mfma_f32_16x16x32_bf16 v[236:239], a[20:23], a[164:167], v[236:239]
v_rcp_f32 v200, v200
v_mfma_f32_16x16x32_bf16 v[236:239], a[24:27], a[168:171], v[236:239]
v_mov_b32 v201, v200
v_pk_mul_f32 v[96:97], v[96:97], v[200:201]
v_mfma_f32_16x16x32_bf16 v[236:239], a[28:31], a[172:175], v[236:239]
v_pk_mul_f32 v[98:99], v[98:99], v[200:201]
v_cvt_pk_bf16_f32 v96, v96, v97
v_pk_mul_f32 v[100:101], v[100:101], v[200:201]
v_pk_mul_f32 v[102:103], v[102:103], v[200:201]
v_cvt_pk_bf16_f32 v97, v98, v99
v_cvt_pk_bf16_f32 v98, v100, v101
v_cvt_pk_bf16_f32 v99, v102, v103
v_exp_f32 v240, v240
v_exp_f32 v241, v241
v_exp_f32 v242, v242
v_exp_f32 v243, v243
v_exp_f32 v244, v244
v_exp_f32 v245, v245
v_exp_f32 v246, v246
v_exp_f32 v247, v247
ds_write_b128 v19, v[96:99] offset:2048
v_cvt_pk_bf16_f32 v252, v240, v241
v_cvt_pk_bf16_f32 v253, v242, v243
v_cvt_pk_bf16_f32 v254, v244, v245
v_cvt_pk_bf16_f32 v255, v246, v247
v_pk_mul_f32 v[104:105], v[104:105], v[200:201]
v_pk_mul_f32 v[106:107], v[106:107], v[200:201]
v_mfma_f32_16x16x32_bf16 v[128:131], a[32:35], v[252:255], v[128:131]
v_cvt_pk_bf16_f32 v104, v104, v105
v_pk_mul_f32 v[108:109], v[108:109], v[200:201]
v_mfma_f32_16x16x32_bf16 v[132:135], a[36:39], v[252:255], v[132:135]
v_pk_mul_f32 v[110:111], v[110:111], v[200:201]
v_cvt_pk_bf16_f32 v105, v106, v107
v_mfma_f32_16x16x32_bf16 v[136:139], a[40:43], v[252:255], v[136:139]
v_cvt_pk_bf16_f32 v106, v108, v109
v_cvt_pk_bf16_f32 v107, v110, v111
v_mfma_f32_16x16x32_bf16 v[140:143], a[44:47], v[252:255], v[140:143]
ds_write_b128 v19, v[104:107] offset:12288
v_mfma_f32_16x16x32_bf16 v[144:147], a[64:67], v[252:255], v[144:147]
v_pk_mul_f32 v[112:113], v[112:113], v[200:201]
v_pk_mul_f32 v[114:115], v[114:115], v[200:201]
v_mfma_f32_16x16x32_bf16 v[148:151], a[68:71], v[252:255], v[148:151]
v_cvt_pk_bf16_f32 v112, v112, v113
v_pk_mul_f32 v[116:117], v[116:117], v[200:201]
v_mfma_f32_16x16x32_bf16 v[152:155], a[72:75], v[252:255], v[152:155]
v_pk_mul_f32 v[118:119], v[118:119], v[200:201]
v_cvt_pk_bf16_f32 v113, v114, v115
v_mfma_f32_16x16x32_bf16 v[156:159], a[76:79], v[252:255], v[156:159]
v_cvt_pk_bf16_f32 v114, v116, v117
v_cvt_pk_bf16_f32 v115, v118, v119
v_mfma_f32_16x16x32_bf16 v[204:207], a[252:255], v[252:255], v[204:207]
ds_write_b128 v19, v[112:115] offset:43008
v_pk_mul_f32 v[120:121], v[120:121], v[200:201]
v_pk_mul_f32 v[122:123], v[122:123], v[200:201]
v_cvt_pk_bf16_f32 v120, v120, v121
v_pk_mul_f32 v[124:125], v[124:125], v[200:201]
v_pk_mul_f32 v[126:127], v[126:127], v[200:201]
v_cvt_pk_bf16_f32 v121, v122, v123
v_cvt_pk_bf16_f32 v122, v124, v125
v_cvt_pk_bf16_f32 v123, v126, v127
ds_write_b128 v19, v[120:123] offset:53248
v_rcp_f32 v204, v204
v_exp_f32 v232, v232
v_mov_b32 v205, v204
v_pk_mul_f32 v[128:129], v[128:129], v[204:205]
v_pk_mul_f32 v[130:131], v[130:131], v[204:205]
v_cvt_pk_bf16_f32 v128, v128, v129
v_pk_mul_f32 v[132:133], v[132:133], v[204:205]
v_pk_mul_f32 v[134:135], v[134:135], v[204:205]
v_cvt_pk_bf16_f32 v129, v130, v131
v_cvt_pk_bf16_f32 v130, v132, v133
v_cvt_pk_bf16_f32 v131, v134, v135
v_exp_f32 v233, v233
v_exp_f32 v234, v234
v_exp_f32 v235, v235
v_exp_f32 v236, v236
v_exp_f32 v237, v237
v_exp_f32 v238, v238
v_exp_f32 v239, v239
ds_write_b128 v19, v[128:131] offset:3072
v_cvt_pk_bf16_f32 v248, v232, v233
v_cvt_pk_bf16_f32 v249, v234, v235
v_cvt_pk_bf16_f32 v250, v236, v237
v_cvt_pk_bf16_f32 v251, v238, v239
v_pk_mul_f32 v[136:137], v[136:137], v[204:205]
v_pk_mul_f32 v[138:139], v[138:139], v[204:205]
v_mfma_f32_16x16x32_bf16 v[160:163], a[32:35], v[248:251], v[160:163]
v_cvt_pk_bf16_f32 v136, v136, v137
v_pk_mul_f32 v[140:141], v[140:141], v[204:205]
v_mfma_f32_16x16x32_bf16 v[164:167], a[36:39], v[248:251], v[164:167]
v_pk_mul_f32 v[142:143], v[142:143], v[204:205]
v_cvt_pk_bf16_f32 v137, v138, v139
v_mfma_f32_16x16x32_bf16 v[168:171], a[40:43], v[248:251], v[168:171]
v_cvt_pk_bf16_f32 v138, v140, v141
v_cvt_pk_bf16_f32 v139, v142, v143
v_mfma_f32_16x16x32_bf16 v[172:175], a[44:47], v[248:251], v[172:175]
s_add_u32 s56, s56, 40960
s_cmp_lt_u32 s56, 163840
s_cselect_b32 s56, s56, 0
s_add_u32 s54, s56, s47
v_mfma_f32_16x16x32_bf16 v[176:179], a[64:67], v[248:251], v[176:179]
ds_write_b128 v19, v[136:139] offset:13312
v_mfma_f32_16x16x32_bf16 v[180:183], a[68:71], v[248:251], v[180:183]
s_add_u32 m0, s54, 20480
s_mul_i32 s55, s61, 81920
s_add_u32 s55, s55, s98
s_add_u32 s61, s61, 1
s_and_b32 s61, s61, 15
v_mfma_f32_16x16x32_bf16 v[184:187], a[72:75], v[248:251], v[184:187]
buffer_load_dwordx4 v14, s[64:67], s55 offen lds
v_pk_mul_f32 v[144:145], v[144:145], v[204:205]
v_mfma_f32_16x16x32_bf16 v[188:191], a[76:79], v[248:251], v[188:191]
v_pk_mul_f32 v[146:147], v[146:147], v[204:205]
v_cvt_pk_bf16_f32 v144, v144, v145
v_mfma_f32_16x16x32_bf16 v[208:211], a[252:255], v[248:251], v[208:211]
v_pk_mul_f32 v[148:149], v[148:149], v[204:205]
v_pk_mul_f32 v[150:151], v[150:151], v[204:205]
v_cvt_pk_bf16_f32 v145, v146, v147
v_cvt_pk_bf16_f32 v146, v148, v149
v_cvt_pk_bf16_f32 v147, v150, v151
ds_write_b128 v19, v[144:147] offset:44032
buffer_load_dwordx4 v15, s[64:67], s55 offen offset:1024 lds
v_pk_mul_f32 v[152:153], v[152:153], v[204:205]
v_pk_mul_f32 v[154:155], v[154:155], v[204:205]
v_cvt_pk_bf16_f32 v152, v152, v153
v_pk_mul_f32 v[156:157], v[156:157], v[204:205]
v_pk_mul_f32 v[158:159], v[158:159], v[204:205]
v_cvt_pk_bf16_f32 v153, v154, v155
v_cvt_pk_bf16_f32 v154, v156, v157
v_cvt_pk_bf16_f32 v155, v158, v159
ds_write_b128 v19, v[152:155] offset:54272
v_rcp_f32 v208, v208
buffer_load_dwordx4 v16, s[64:67], s55 offen offset:2048 lds
v_mov_b32 v209, v208
v_pk_mul_f32 v[160:161], v[160:161], v[208:209]
v_pk_mul_f32 v[162:163], v[162:163], v[208:209]
v_cvt_pk_bf16_f32 v160, v160, v161
v_pk_mul_f32 v[164:165], v[164:165], v[208:209]
v_pk_mul_f32 v[166:167], v[166:167], v[208:209]
v_cvt_pk_bf16_f32 v161, v162, v163
v_cvt_pk_bf16_f32 v162, v164, v165
v_cvt_pk_bf16_f32 v163, v166, v167
ds_write_b128 v19, v[160:163] offset:4096
buffer_load_dwordx4 v17, s[64:67], s55 offen offset:3072 lds
v_pk_mul_f32 v[168:169], v[168:169], v[208:209]
v_pk_mul_f32 v[170:171], v[170:171], v[208:209]
v_cvt_pk_bf16_f32 v168, v168, v169
v_pk_mul_f32 v[172:173], v[172:173], v[208:209]
v_pk_mul_f32 v[174:175], v[174:175], v[208:209]
v_cvt_pk_bf16_f32 v169, v170, v171
v_cvt_pk_bf16_f32 v170, v172, v173
v_cvt_pk_bf16_f32 v171, v174, v175
ds_write_b128 v19, v[168:171] offset:14336
s_add_u32 m0, s54, 24576
v_pk_mul_f32 v[176:177], v[176:177], v[208:209]
buffer_load_dwordx4 v18, s[64:67], s55 offen lds
v_pk_mul_f32 v[178:179], v[178:179], v[208:209]
v_cvt_pk_bf16_f32 v176, v176, v177
v_pk_mul_f32 v[180:181], v[180:181], v[208:209]
v_pk_mul_f32 v[182:183], v[182:183], v[208:209]
v_cvt_pk_bf16_f32 v177, v178, v179
v_cvt_pk_bf16_f32 v178, v180, v181
v_cvt_pk_bf16_f32 v179, v182, v183
s_add_u32 s56, s56, 40960
s_cmp_lt_u32 s56, 163840
s_cselect_b32 s56, s56, 0
ds_write_b128 v19, v[176:179] offset:45056
s_add_u32 s54, s56, s47
s_add_u32 m0, s54, 20480
s_mul_i32 s55, s61, 81920
s_add_u32 s55, s55, s98
s_add_u32 s61, s61, 1
s_and_b32 s61, s61, 15
buffer_load_dwordx4 v14, s[64:67], s55 offen lds
v_pk_mul_f32 v[184:185], v[184:185], v[208:209]
v_pk_mul_f32 v[186:187], v[186:187], v[208:209]
v_cvt_pk_bf16_f32 v184, v184, v185
v_pk_mul_f32 v[188:189], v[188:189], v[208:209]
v_pk_mul_f32 v[190:191], v[190:191], v[208:209]
v_cvt_pk_bf16_f32 v185, v186, v187
v_cvt_pk_bf16_f32 v186, v188, v189
v_cvt_pk_bf16_f32 v187, v190, v191
ds_write_b128 v19, v[184:187] offset:55296
buffer_load_dwordx4 v15, s[64:67], s55 offen offset:1024 lds
s_add_u32 s56, s56, 40960
s_cmp_lt_u32 s56, 163840
s_cselect_b32 s56, s56, 0
s_add_u32 s57, s57, 40960
s_cmp_lt_u32 s57, 163840
s_cselect_b32 s57, s57, 0
s_mov_b32 s58, 0
s_add_u32 s45, s45, 8192
buffer_load_dwordx4 v16, s[64:67], s55 offen offset:2048 lds
buffer_load_dwordx4 v17, s[64:67], s55 offen offset:3072 lds
s_add_u32 m0, s54, 24576
s_nop 0
buffer_load_dwordx4 v18, s[64:67], s55 offen lds
s_waitcnt lgkmcnt(0)
v_cmp_nle_f32 vcc, 1.0, v192
v_cmp_nle_f32 s[62:63], 1.0, v196
s_or_b64 vcc, vcc, s[62:63]
v_cmp_nle_f32 s[62:63], 1.0, v200
s_or_b64 vcc, vcc, s[62:63]
v_cmp_nle_f32 s[62:63], 1.0, v204
s_or_b64 vcc, vcc, s[62:63]
v_cmp_nle_f32 s[62:63], 1.0, v208
s_or_b64 vcc, vcc, s[62:63]
s_cmp_lg_u64 vcc, 0
s_cbranch_scc1 K1_slow
K1_rejoin:
v_add_u32 v241, s34, v21
v_mov_b32 v233, v241
s_waitcnt vmcnt(15)
s_barrier
ds_read_b64_tr_b16 a[120:121], v233 offset:0
v_add_u32 v240, s35, v7
ds_read_b64_tr_b16 a[122:123], v233 offset:5120
v_mov_b32 v232, v240
ds_read_b128 a[100:103], v232 offset:0
s_add_u32 s51, s44, 0
buffer_store_dwordx4 v[32:35], v7, s[28:31], s51 offen sc1
v_xor_b32 v242, 32, v21
ds_read_b128 a[104:107], v232 offset:1024
s_add_u32 s51, s44, 10240
v_add_u32 v242, s75, v242
v_mov_b32 v234, v242
ds_read_b128 a[108:111], v232 offset:2048
v_add_u32 v243, 1024, v241
v_mov_b32 v235, v243
v_add_u32 v244, 1024, v242
ds_read_b128 a[112:115], v232 offset:3072
buffer_store_dwordx4 v[40:43], v7, s[28:31], s51 offen sc1
v_mov_b32 v236, v244
v_add_u32 v245, 2048, v241
ds_read_b128 a[116:119], v232 offset:4096
s_add_u32 s51, s44, 20480
v_mov_b32 v237, v245
s_mul_i32 s50, s32, 20480
s_add_u32 s50, s50, s97
s_add_u32 s32, s32, 1
s_and_b32 s32, s32, 15
ds_read_b64_tr_b16 a[124:125], v234 offset:0
ds_read_b64_tr_b16 a[126:127], v234 offset:5120
buffer_store_dwordx4 v[48:51], v7, s[28:31], s51 offen sc1
ds_read_b64_tr_b16 a[128:129], v235 offset:0
ds_read_b64_tr_b16 a[130:131], v235 offset:5120
s_add_u32 s51, s44, 30720
ds_read_b64_tr_b16 a[132:133], v236 offset:0
ds_read_b64_tr_b16 a[134:135], v236 offset:5120
ds_read_b64_tr_b16 a[136:137], v237 offset:0
buffer_store_dwordx4 v[56:59], v7, s[28:31], s51 offen sc1
ds_read_b64_tr_b16 a[138:139], v237 offset:5120
s_waitcnt lgkmcnt(12)
v_mfma_f32_16x16x32_bf16 a[0:3], a[120:123], a[100:103], 0
ds_read_b64_tr_b16 a[160:161], v233 offset:10240
s_add_u32 s51, s44, 1024
s_waitcnt lgkmcnt(12)
v_mfma_f32_16x16x32_bf16 a[4:7], a[120:123], a[104:107], 0
ds_read_b64_tr_b16 a[162:163], v233 offset:15360
buffer_store_dwordx4 v[64:67], v7, s[28:31], s51 offen sc1
s_waitcnt lgkmcnt(12)
v_mfma_f32_16x16x32_bf16 a[8:11], a[120:123], a[108:111], 0
ds_read_b128 a[140:143], v232 offset:10240
s_add_u32 s51, s44, 11264
s_waitcnt lgkmcnt(12)
v_mfma_f32_16x16x32_bf16 a[12:15], a[120:123], a[112:115], 0
ds_read_b128 a[144:147], v232 offset:11264
buffer_store_dwordx4 v[72:75], v7, s[28:31], s51 offen sc1
s_waitcnt lgkmcnt(12)
v_mfma_f32_16x16x32_bf16 a[16:19], a[120:123], a[116:119], 0
ds_read_b128 a[148:151], v232 offset:12288
s_add_u32 s51, s44, 21504
s_waitcnt lgkmcnt(11)
v_mfma_f32_16x16x32_bf16 a[20:23], a[124:127], a[100:103], 0
ds_read_b128 a[152:155], v232 offset:13312
buffer_store_dwordx4 v[80:83], v7, s[28:31], s51 offen sc1
v_mfma_f32_16x16x32_bf16 a[24:27], a[124:127], a[104:107], 0
ds_read_b128 a[156:159], v232 offset:14336
v_add_u32 v233, s57, v241
v_mfma_f32_16x16x32_bf16 a[28:31], a[124:127], a[108:111], 0
ds_read_b64_tr_b16 a[164:165], v234 offset:10240
v_add_u32 v232, s57, v240
v_mfma_f32_16x16x32_bf16 a[32:35], a[124:127], a[112:115], 0
ds_read_b64_tr_b16 a[166:167], v234 offset:15360
s_add_u32 s51, s44, 31744
v_mfma_f32_16x16x32_bf16 a[36:39], a[124:127], a[116:119], 0
ds_read_b64_tr_b16 a[168:169], v235 offset:10240
buffer_store_dwordx4 v[88:91], v7, s[28:31], s51 offen sc1
s_waitcnt lgkmcnt(12)
v_mfma_f32_16x16x32_bf16 a[40:43], a[128:131], a[100:103], 0
ds_read_b64_tr_b16 a[170:171], v235 offset:15360
v_add_u32 v234, s57, v242
v_mfma_f32_16x16x32_bf16 a[44:47], a[128:131], a[104:107], 0
ds_read_b64_tr_b16 a[172:173], v236 offset:10240
v_add_u32 v235, s57, v243
v_mfma_f32_16x16x32_bf16 a[48:51], a[128:131], a[108:111], 0
ds_read_b64_tr_b16 a[174:175], v236 offset:15360
v_add_u32 v236, s57, v244
v_mfma_f32_16x16x32_bf16 a[52:55], a[128:131], a[112:115], 0
ds_read_b64_tr_b16 a[176:177], v237 offset:10240
s_add_u32 s51, s44, 2048
v_mfma_f32_16x16x32_bf16 a[56:59], a[128:131], a[116:119], 0
ds_read_b64_tr_b16 a[178:179], v237 offset:15360
buffer_store_dwordx4 v[96:99], v7, s[28:31], s51 offen sc1
v_mfma_f32_16x16x32_bf16 a[60:63], a[132:135], a[100:103], 0
v_add_u32 v237, s57, v245
s_add_u32 s57, s57, 40960
s_cmp_lt_u32 s57, 163840
s_cselect_b32 s57, s57, 0
v_mfma_f32_16x16x32_bf16 a[64:67], a[132:135], a[104:107], 0
v_mfma_f32_16x16x32_bf16 a[68:71], a[132:135], a[108:111], 0
s_nop 3
s_add_u32 s51, s44, 12288
v_mfma_f32_16x16x32_bf16 a[72:75], a[132:135], a[112:115], 0
buffer_store_dwordx4 v[104:107], v7, s[28:31], s51 offen sc1
v_mfma_f32_16x16x32_bf16 a[76:79], a[132:135], a[116:119], 0
s_waitcnt lgkmcnt(6)
v_mfma_f32_16x16x32_bf16 a[80:83], a[136:139], a[100:103], 0
v_mfma_f32_16x16x32_bf16 a[84:87], a[136:139], a[104:107], 0
v_mfma_f32_16x16x32_bf16 a[88:91], a[136:139], a[108:111], 0
s_waitcnt vmcnt(20) lgkmcnt(0)
s_barrier
v_mfma_f32_16x16x32_bf16 a[92:95], a[136:139], a[112:115], 0
s_add_u32 s54, s56, s47
s_add_u32 m0, s54, 20480
v_mfma_f32_16x16x32_bf16 a[96:99], a[136:139], a[116:119], 0
s_add_u32 s51, s44, 22528
buffer_store_dwordx4 v[112:115], v7, s[28:31], s51 offen sc1
v_mfma_f32_16x16x32_bf16 a[0:3], a[160:163], a[140:143], a[0:3]
s_mul_i32 s55, s61, 81920
s_add_u32 s55, s55, s98
s_add_u32 s61, s61, 1
s_and_b32 s61, s61, 15
ds_read_b64_tr_b16 a[120:121], v233 offset:0
v_mfma_f32_16x16x32_bf16 a[4:7], a[160:163], a[144:147], a[4:7]
ds_read_b64_tr_b16 a[122:123], v233 offset:5120
s_add_u32 s56, s56, 40960
s_cmp_lt_u32 s56, 163840
s_cselect_b32 s56, s56, 0
v_mfma_f32_16x16x32_bf16 a[8:11], a[160:163], a[148:151], a[8:11]
buffer_load_dwordx4 v14, s[64:67], s55 offen lds
ds_read_b128 a[100:103], v232 offset:0
v_mfma_f32_16x16x32_bf16 a[12:15], a[160:163], a[152:155], a[12:15]
s_add_u32 s51, s44, 32768
ds_read_b128 a[104:107], v232 offset:1024
v_mfma_f32_16x16x32_bf16 a[16:19], a[160:163], a[156:159], a[16:19]
ds_read_b128 a[108:111], v232 offset:2048
v_mfma_f32_16x16x32_bf16 a[20:23], a[164:167], a[140:143], a[20:23]
buffer_load_dwordx4 v15, s[64:67], s55 offen offset:1024 lds
ds_read_b128 a[112:115], v232 offset:3072
v_mfma_f32_16x16x32_bf16 a[24:27], a[164:167], a[144:147], a[24:27]
ds_read_b128 a[116:119], v232 offset:4096
v_mfma_f32_16x16x32_bf16 a[28:31], a[164:167], a[148:151], a[28:31]
ds_read_b64_tr_b16 a[124:125], v234 offset:0
v_mfma_f32_16x16x32_bf16 a[32:35], a[164:167], a[152:155], a[32:35]
buffer_load_dwordx4 v16, s[64:67], s55 offen offset:2048 lds
ds_read_b64_tr_b16 a[126:127], v234 offset:5120
v_mfma_f32_16x16x32_bf16 a[36:39], a[164:167], a[156:159], a[36:39]
ds_read_b64_tr_b16 a[128:129], v235 offset:0
v_mfma_f32_16x16x32_bf16 a[40:43], a[168:171], a[140:143], a[40:43]
ds_read_b64_tr_b16 a[130:131], v235 offset:5120
v_mfma_f32_16x16x32_bf16 a[44:47], a[168:171], a[144:147], a[44:47]
buffer_load_dwordx4 v17, s[64:67], s55 offen offset:3072 lds
s_add_u32 m0, s54, 24576
v_mfma_f32_16x16x32_bf16 a[48:51], a[168:171], a[148:151], a[48:51]
ds_read_b64_tr_b16 a[132:133], v236 offset:0
v_mfma_f32_16x16x32_bf16 a[52:55], a[168:171], a[152:155], a[52:55]
ds_read_b64_tr_b16 a[134:135], v236 offset:5120
v_mfma_f32_16x16x32_bf16 a[56:59], a[168:171], a[156:159], a[56:59]
buffer_load_dwordx4 v18, s[64:67], s55 offen lds
ds_read_b64_tr_b16 a[136:137], v237 offset:0
v_mfma_f32_16x16x32_bf16 a[60:63], a[172:175], a[140:143], a[60:63]
ds_read_b64_tr_b16 a[138:139], v237 offset:5120
v_mfma_f32_16x16x32_bf16 a[64:67], a[172:175], a[144:147], a[64:67]
ds_read_b64_tr_b16 a[160:161], v233 offset:10240
v_mfma_f32_16x16x32_bf16 a[68:71], a[172:175], a[148:151], a[68:71]
buffer_store_dwordx4 v[120:123], v7, s[28:31], s51 offen sc1
ds_read_b64_tr_b16 a[162:163], v233 offset:15360
v_mfma_f32_16x16x32_bf16 a[72:75], a[172:175], a[152:155], a[72:75]
s_add_u32 s51, s44, 3072
v_add_u32 v233, s57, v241
v_mfma_f32_16x16x32_bf16 a[76:79], a[172:175], a[156:159], a[76:79]
v_mfma_f32_16x16x32_bf16 a[80:83], a[176:179], a[140:143], a[80:83]
buffer_store_dwordx4 v[128:131], v7, s[28:31], s51 offen sc1
ds_read_b128 a[140:143], v232 offset:10240
v_mfma_f32_16x16x32_bf16 a[84:87], a[176:179], a[144:147], a[84:87]
s_add_u32 s51, s44, 13312
ds_read_b128 a[144:147], v232 offset:11264
v_mfma_f32_16x16x32_bf16 a[88:91], a[176:179], a[148:151], a[88:91]
ds_read_b128 a[148:151], v232 offset:12288
v_mfma_f32_16x16x32_bf16 a[92:95], a[176:179], a[152:155], a[92:95]
buffer_store_dwordx4 v[136:139], v7, s[28:31], s51 offen sc1
ds_read_b128 a[152:155], v232 offset:13312
v_mfma_f32_16x16x32_bf16 a[96:99], a[176:179], a[156:159], a[96:99]
s_add_u32 s51, s44, 23552
ds_read_b128 a[156:159], v232 offset:14336
s_waitcnt lgkmcnt(10)
v_mfma_f32_16x16x32_bf16 a[0:3], a[120:123], a[100:103], a[0:3]
ds_read_b64_tr_b16 a[164:165], v234 offset:10240
buffer_store_dwordx4 v[144:147], v7, s[28:31], s51 offen sc1
v_mfma_f32_16x16x32_bf16 a[4:7], a[120:123], a[104:107], a[4:7]
s_add_u32 s51, s44, 33792
ds_read_b64_tr_b16 a[166:167], v234 offset:15360
v_mfma_f32_16x16x32_bf16 a[8:11], a[120:123], a[108:111], a[8:11]
ds_read_b64_tr_b16 a[168:169], v235 offset:10240
v_add_u32 v232, s57, v240
v_mfma_f32_16x16x32_bf16 a[12:15], a[120:123], a[112:115], a[12:15]
buffer_store_dwordx4 v[152:155], v7, s[28:31], s51 offen sc1
ds_read_b64_tr_b16 a[170:171], v235 offset:15360
v_mfma_f32_16x16x32_bf16 a[16:19], a[120:123], a[116:119], a[16:19]
s_add_u32 s51, s44, 4096
ds_read_b64_tr_b16 a[172:173], v236 offset:10240
v_mfma_f32_16x16x32_bf16 a[20:23], a[124:127], a[100:103], a[20:23]
ds_read_b64_tr_b16 a[174:175], v236 offset:15360
v_add_u32 v234, s57, v242
v_mfma_f32_16x16x32_bf16 a[24:27], a[124:127], a[104:107], a[24:27]
buffer_store_dwordx4 v[160:163], v7, s[28:31], s51 offen sc1
ds_read_b64_tr_b16 a[176:177], v237 offset:10240
v_mfma_f32_16x16x32_bf16 a[28:31], a[124:127], a[108:111], a[28:31]
ds_read_b64_tr_b16 a[178:179], v237 offset:15360
v_add_u32 v235, s57, v243
v_mfma_f32_16x16x32_bf16 a[32:35], a[124:127], a[112:115], a[32:35]
s_add_u32 s51, s44, 14336
v_add_u32 v236, s57, v244
v_mfma_f32_16x16x32_bf16 a[36:39], a[124:127], a[116:119], a[36:39]
buffer_store_dwordx4 v[168:171], v7, s[28:31], s51 offen sc1
v_add_u32 v237, s57, v245
v_mfma_f32_16x16x32_bf16 a[40:43], a[128:131], a[100:103], a[40:43]
s_add_u32 s57, s57, 40960
s_cmp_lt_u32 s57, 163840
s_cselect_b32 s57, s57, 0
v_mfma_f32_16x16x32_bf16 a[44:47], a[128:131], a[104:107], a[44:47]
v_mfma_f32_16x16x32_bf16 a[48:51], a[128:131], a[108:111], a[48:51]
s_nop 4
s_add_u32 s51, s44, 24576
v_mfma_f32_16x16x32_bf16 a[52:55], a[128:131], a[112:115], a[52:55]
buffer_store_dwordx4 v[176:179], v7, s[28:31], s51 offen sc1
v_mfma_f32_16x16x32_bf16 a[56:59], a[128:131], a[116:119], a[56:59]
s_waitcnt lgkmcnt(5)
v_mfma_f32_16x16x32_bf16 a[60:63], a[132:135], a[100:103], a[60:63]
s_waitcnt vmcnt(29) lgkmcnt(0)
s_barrier
v_mfma_f32_16x16x32_bf16 a[64:67], a[132:135], a[104:107], a[64:67]
ds_read_b64_tr_b16 a[120:121], v233 offset:0
s_add_u32 s54, s56, s47
v_mfma_f32_16x16x32_bf16 a[68:71], a[132:135], a[108:111], a[68:71]
ds_read_b64_tr_b16 a[122:123], v233 offset:5120
s_add_u32 m0, s54, 20480
v_mfma_f32_16x16x32_bf16 a[72:75], a[132:135], a[112:115], a[72:75]
s_add_u32 s51, s44, 34816
buffer_store_dwordx4 v[184:187], v7, s[28:31], s51 offen sc1
v_mfma_f32_16x16x32_bf16 a[76:79], a[132:135], a[116:119], a[76:79]
s_mul_i32 s55, s61, 81920
s_add_u32 s55, s55, s98
s_add_u32 s61, s61, 1
s_and_b32 s61, s61, 15
s_add_u32 s56, s56, 40960
s_cmp_lt_u32 s56, 163840
s_cselect_b32 s56, s56, 0
v_mfma_f32_16x16x32_bf16 a[80:83], a[136:139], a[100:103], a[80:83]
ds_read_b128 a[100:103], v232 offset:0
v_mfma_f32_16x16x32_bf16 a[84:87], a[136:139], a[104:107], a[84:87]
ds_read_b128 a[104:107], v232 offset:1024
buffer_load_dwordx4 v14, s[64:67], s55 offen lds
v_mfma_f32_16x16x32_bf16 a[88:91], a[136:139], a[108:111], a[88:91]
ds_read_b128 a[108:111], v232 offset:2048
v_mfma_f32_16x16x32_bf16 a[92:95], a[136:139], a[112:115], a[92:95]
ds_read_b128 a[112:115], v232 offset:3072
v_mfma_f32_16x16x32_bf16 a[96:99], a[136:139], a[116:119], a[96:99]
ds_read_b128 a[116:119], v232 offset:4096
buffer_load_dwordx4 v15, s[64:67], s55 offen offset:1024 lds
v_mfma_f32_16x16x32_bf16 a[0:3], a[160:163], a[140:143], a[0:3]
ds_read_b64_tr_b16 a[124:125], v234 offset:0
v_mfma_f32_16x16x32_bf16 a[4:7], a[160:163], a[144:147], a[4:7]
ds_read_b64_tr_b16 a[126:127], v234 offset:5120
v_mfma_f32_16x16x32_bf16 a[8:11], a[160:163], a[148:151], a[8:11]
ds_read_b64_tr_b16 a[128:129], v235 offset:0
buffer_load_dwordx4 v16, s[64:67], s55 offen offset:2048 lds
v_mfma_f32_16x16x32_bf16 a[12:15], a[160:163], a[152:155], a[12:15]
ds_read_b64_tr_b16 a[130:131], v235 offset:5120
v_mfma_f32_16x16x32_bf16 a[16:19], a[160:163], a[156:159], a[16:19]
ds_read_b64_tr_b16 a[132:133], v236 offset:0
v_mfma_f32_16x16x32_bf16 a[20:23], a[164:167], a[140:143], a[20:23]
ds_read_b64_tr_b16 a[134:135], v236 offset:5120
buffer_load_dwordx4 v17, s[64:67], s55 offen offset:3072 lds
v_mfma_f32_16x16x32_bf16 a[24:27], a[164:167], a[144:147], a[24:27]
ds_read_b64_tr_b16 a[136:137], v237 offset:0
s_add_u32 m0, s54, 24576
v_mfma_f32_16x16x32_bf16 a[28:31], a[164:167], a[148:151], a[28:31]
ds_read_b64_tr_b16 a[138:139], v237 offset:5120
v_mfma_f32_16x16x32_bf16 a[32:35], a[164:167], a[152:155], a[32:35]
ds_read_b64_tr_b16 a[160:161], v233 offset:10240
buffer_load_dwordx4 v18, s[64:67], s55 offen lds
v_mfma_f32_16x16x32_bf16 a[36:39], a[164:167], a[156:159], a[36:39]
ds_read_b64_tr_b16 a[162:163], v233 offset:15360
v_add_u32 v233, s57, v241
v_mfma_f32_16x16x32_bf16 a[40:43], a[168:171], a[140:143], a[40:43]
v_mfma_f32_16x16x32_bf16 a[44:47], a[168:171], a[144:147], a[44:47]
v_mfma_f32_16x16x32_bf16 a[48:51], a[168:171], a[148:151], a[48:51]
v_mfma_f32_16x16x32_bf16 a[52:55], a[168:171], a[152:155], a[52:55]
v_mfma_f32_16x16x32_bf16 a[56:59], a[168:171], a[156:159], a[56:59]
v_mfma_f32_16x16x32_bf16 a[60:63], a[172:175], a[140:143], a[60:63]
v_mfma_f32_16x16x32_bf16 a[64:67], a[172:175], a[144:147], a[64:67]
v_mfma_f32_16x16x32_bf16 a[68:71], a[172:175], a[148:151], a[68:71]
v_mfma_f32_16x16x32_bf16 a[72:75], a[172:175], a[152:155], a[72:75]
v_mfma_f32_16x16x32_bf16 a[76:79], a[172:175], a[156:159], a[76:79]
v_mfma_f32_16x16x32_bf16 a[80:83], a[176:179], a[140:143], a[80:83]
ds_read_b128 a[140:143], v232 offset:10240
v_mfma_f32_16x16x32_bf16 a[84:87], a[176:179], a[144:147], a[84:87]
ds_read_b128 a[144:147], v232 offset:11264
v_mfma_f32_16x16x32_bf16 a[88:91], a[176:179], a[148:151], a[88:91]
ds_read_b128 a[148:151], v232 offset:12288
v_mfma_f32_16x16x32_bf16 a[92:95], a[176:179], a[152:155], a[92:95]
ds_read_b128 a[152:155], v232 offset:13312
v_mfma_f32_16x16x32_bf16 a[96:99], a[176:179], a[156:159], a[96:99]
ds_read_b128 a[156:159], v232 offset:14336
v_add_u32 v232, s57, v240
s_waitcnt lgkmcnt(5)
v_mfma_f32_16x16x32_bf16 a[0:3], a[120:123], a[100:103], a[0:3]
ds_read_b64_tr_b16 a[164:165], v234 offset:10240
v_mfma_f32_16x16x32_bf16 a[4:7], a[120:123], a[104:107], a[4:7]
ds_read_b64_tr_b16 a[166:167], v234 offset:15360
v_add_u32 v234, s57, v242
v_mfma_f32_16x16x32_bf16 a[8:11], a[120:123], a[108:111], a[8:11]
ds_read_b64_tr_b16 a[168:169], v235 offset:10240
v_mfma_f32_16x16x32_bf16 a[12:15], a[120:123], a[112:115], a[12:15]
ds_read_b64_tr_b16 a[170:171], v235 offset:15360
v_add_u32 v235, s57, v243
v_mfma_f32_16x16x32_bf16 a[16:19], a[120:123], a[116:119], a[16:19]
ds_read_b64_tr_b16 a[172:173], v236 offset:10240
v_mfma_f32_16x16x32_bf16 a[20:23], a[124:127], a[100:103], a[20:23]
ds_read_b64_tr_b16 a[174:175], v236 offset:15360
v_add_u32 v236, s57, v244
v_mfma_f32_16x16x32_bf16 a[24:27], a[124:127], a[104:107], a[24:27]
ds_read_b64_tr_b16 a[176:177], v237 offset:10240
v_mfma_f32_16x16x32_bf16 a[28:31], a[124:127], a[108:111], a[28:31]
ds_read_b64_tr_b16 a[178:179], v237 offset:15360
v_add_u32 v237, s57, v245
v_mfma_f32_16x16x32_bf16 a[32:35], a[124:127], a[112:115], a[32:35]
s_add_u32 s57, s57, 40960
s_cmp_lt_u32 s57, 163840
s_cselect_b32 s57, s57, 0
v_mfma_f32_16x16x32_bf16 a[36:39], a[124:127], a[116:119], a[36:39]
v_mfma_f32_16x16x32_bf16 a[40:43], a[128:131], a[100:103], a[40:43]
v_mfma_f32_16x16x32_bf16 a[44:47], a[128:131], a[104:107], a[44:47]
v_mfma_f32_16x16x32_bf16 a[48:51], a[128:131], a[108:111], a[48:51]
v_mfma_f32_16x16x32_bf16 a[52:55], a[128:131], a[112:115], a[52:55]
v_mfma_f32_16x16x32_bf16 a[56:59], a[128:131], a[116:119], a[56:59]
v_mfma_f32_16x16x32_bf16 a[60:63], a[132:135], a[100:103], a[60:63]
v_mfma_f32_16x16x32_bf16 a[64:67], a[132:135], a[104:107], a[64:67]
v_mfma_f32_16x16x32_bf16 a[68:71], a[132:135], a[108:111], a[68:71]
v_mfma_f32_16x16x32_bf16 a[72:75], a[132:135], a[112:115], a[72:75]
v_mfma_f32_16x16x32_bf16 a[76:79], a[132:135], a[116:119], a[76:79]
v_mfma_f32_16x16x32_bf16 a[80:83], a[136:139], a[100:103], a[80:83]
v_mfma_f32_16x16x32_bf16 a[84:87], a[136:139], a[104:107], a[84:87]
v_mfma_f32_16x16x32_bf16 a[88:91], a[136:139], a[108:111], a[88:91]
v_mfma_f32_16x16x32_bf16 a[92:95], a[136:139], a[112:115], a[92:95]
v_mfma_f32_16x16x32_bf16 a[96:99], a[136:139], a[116:119], a[96:99]
s_waitcnt lgkmcnt(0)
v_mfma_f32_16x16x32_bf16 a[0:3], a[160:163], a[140:143], a[0:3]
v_mfma_f32_16x16x32_bf16 a[4:7], a[160:163], a[144:147], a[4:7]
v_mfma_f32_16x16x32_bf16 a[8:11], a[160:163], a[148:151], a[8:11]
v_mfma_f32_16x16x32_bf16 a[12:15], a[160:163], a[152:155], a[12:15]
v_mfma_f32_16x16x32_bf16 a[16:19], a[160:163], a[156:159], a[16:19]
v_mfma_f32_16x16x32_bf16 a[20:23], a[164:167], a[140:143], a[20:23]
v_mfma_f32_16x16x32_bf16 a[24:27], a[164:167], a[144:147], a[24:27]
v_mfma_f32_16x16x32_bf16 a[28:31], a[164:167], a[148:151], a[28:31]
v_mfma_f32_16x16x32_bf16 a[32:35], a[164:167], a[152:155], a[32:35]
v_mfma_f32_16x16x32_bf16 a[36:39], a[164:167], a[156:159], a[36:39]
v_mfma_f32_16x16x32_bf16 a[40:43], a[168:171], a[140:143], a[40:43]
v_mfma_f32_16x16x32_bf16 a[44:47], a[168:171], a[144:147], a[44:47]
v_mfma_f32_16x16x32_bf16 a[48:51], a[168:171], a[148:151], a[48:51]
v_mfma_f32_16x16x32_bf16 a[52:55], a[168:171], a[152:155], a[52:55]
v_mfma_f32_16x16x32_bf16 a[56:59], a[168:171], a[156:159], a[56:59]
v_mfma_f32_16x16x32_bf16 a[60:63], a[172:175], a[140:143], a[60:63]
v_mfma_f32_16x16x32_bf16 a[64:67], a[172:175], a[144:147], a[64:67]
v_mfma_f32_16x16x32_bf16 a[68:71], a[172:175], a[148:151], a[68:71]
v_mfma_f32_16x16x32_bf16 a[72:75], a[172:175], a[152:155], a[72:75]
s_waitcnt vmcnt(5)
s_barrier
v_mfma_f32_16x16x32_bf16 a[76:79], a[172:175], a[156:159], a[76:79]
buffer_store_dword v11, off, s[28:31], s96 sc1
s_add_u32 s54, s56, s47
v_mfma_f32_16x16x32_bf16 a[80:83], a[176:179], a[140:143], a[80:83]
s_add_u32 m0, s54, 20480
s_mul_i32 s55, s61, 81920
s_add_u32 s55, s55, s98
s_add_u32 s61, s61, 1
s_and_b32 s61, s61, 15
v_mfma_f32_16x16x32_bf16 a[84:87], a[176:179], a[144:147], a[84:87]
ds_read_b64_tr_b16 a[120:121], v233 offset:0
s_add_u32 s56, s56, 40960
s_cmp_lt_u32 s56, 163840
s_cselect_b32 s56, s56, 0
v_mfma_f32_16x16x32_bf16 a[88:91], a[176:179], a[148:151], a[88:91]
buffer_load_dwordx4 v14, s[64:67], s55 offen lds
ds_read_b64_tr_b16 a[122:123], v233 offset:5120
v_mfma_f32_16x16x32_bf16 a[92:95], a[176:179], a[152:155], a[92:95]
ds_read_b128 a[100:103], v232 offset:0
v_mfma_f32_16x16x32_bf16 a[96:99], a[176:179], a[156:159], a[96:99]
ds_read_b128 a[104:107], v232 offset:1024
buffer_load_dwordx4 v15, s[64:67], s55 offen offset:1024 lds
ds_read_b128 a[108:111], v232 offset:2048
ds_read_b128 a[112:115], v232 offset:3072
buffer_load_dwordx4 v16, s[64:67], s55 offen offset:2048 lds
ds_read_b128 a[116:119], v232 offset:4096
ds_read_b64_tr_b16 a[124:125], v234 offset:0
ds_read_b64_tr_b16 a[126:127], v234 offset:5120
ds_read_b64_tr_b16 a[128:129], v235 offset:0
buffer_load_dwordx4 v17, s[64:67], s55 offen offset:3072 lds
s_add_u32 m0, s54, 24576
s_add_u32 s54, s58, s47
s_add_u32 s58, s58, 40960
s_cmp_lt_u32 s58, 163840
s_cselect_b32 s58, s58, 0
ds_read_b64_tr_b16 a[130:131], v235 offset:5120
ds_read_b64_tr_b16 a[132:133], v236 offset:0
ds_read_b64_tr_b16 a[134:135], v236 offset:5120
buffer_load_dwordx4 v18, s[64:67], s55 offen lds
s_add_u32 m0, s54, 0
ds_read_b64_tr_b16 a[136:137], v237 offset:0
ds_read_b64_tr_b16 a[138:139], v237 offset:5120
ds_read_b64_tr_b16 a[160:161], v233 offset:10240
ds_read_b64_tr_b16 a[162:163], v233 offset:15360
v_add_u32 v233, s57, v241
v_min_u32 v8, 3, v1
v_lshlrev_b32 v8, 2, v8
s_mov_b32 s80, 0x20000
K1_p1:
buffer_load_dword v9, v8, s[88:91], s85 offen sc1
s_waitcnt vmcnt(0)
v_cmp_gt_u32 vcc, 4, v9
s_sub_u32 s80, s80, 1
s_cmp_eq_u32 s80, 0
s_cbranch_scc1 K1_p1_done
s_cbranch_vccz K1_p1_done
s_sleep 4
s_branch K1_p1
K1_p1_done:
v_min_u32 v8, 3, v1
v_lshlrev_b32 v8, 2, v8
s_mov_b32 s80, 0x20000
K1_p2:
buffer_load_dword v9, v8, s[28:31], s86 offen sc1
s_waitcnt vmcnt(0)
v_cmp_ne_u32 vcc, 1, v9
s_sub_u32 s80, s80, 1
s_cmp_eq_u32 s80, 0
s_cbranch_scc1 K1_p2_done
s_cbranch_vccz K1_p2_done
s_sleep 4
s_branch K1_p2
K1_p2_done:
s_waitcnt lgkmcnt(14)
v_mfma_f32_16x16x32_bf16 a[0:3], a[120:123], a[100:103], a[0:3]
ds_read_b128 a[140:143], v232 offset:10240
s_waitcnt lgkmcnt(14)
v_mfma_f32_16x16x32_bf16 a[4:7], a[120:123], a[104:107], a[4:7]
ds_read_b128 a[144:147], v232 offset:11264
buffer_load_dwordx4 v7, s[28:31], s50 offen sc1 lds
s_waitcnt lgkmcnt(14)
v_mfma_f32_16x16x32_bf16 a[8:11], a[120:123], a[108:111], a[8:11]
ds_read_b128 a[148:151], v232 offset:12288
s_waitcnt lgkmcnt(14)
v_mfma_f32_16x16x32_bf16 a[12:15], a[120:123], a[112:115], a[12:15]
ds_read_b128 a[152:155], v232 offset:13312
buffer_load_dwordx4 v7, s[28:31], s50 offen offset:1024 sc1 lds
s_waitcnt lgkmcnt(14)
v_mfma_f32_16x16x32_bf16 a[16:19], a[120:123], a[116:119], a[16:19]
ds_read_b128 a[156:159], v232 offset:14336
v_add_u32 v232, s57, v240
s_waitcnt lgkmcnt(13)
v_mfma_f32_16x16x32_bf16 a[20:23], a[124:127], a[100:103], a[20:23]
ds_read_b64_tr_b16 a[164:165], v234 offset:10240
buffer_load_dwordx4 v7, s[28:31], s50 offen offset:2048 sc1 lds
v_mfma_f32_16x16x32_bf16 a[24:27], a[124:127], a[104:107], a[24:27]
ds_read_b64_tr_b16 a[166:167], v234 offset:15360
v_add_u32 v234, s57, v242
v_mfma_f32_16x16x32_bf16 a[28:31], a[124:127], a[108:111], a[28:31]
ds_read_b64_tr_b16 a[168:169], v235 offset:10240
v_mfma_f32_16x16x32_bf16 a[32:35], a[124:127], a[112:115], a[32:35]
buffer_load_dwordx4 v7, s[28:31], s50 offen offset:3072 sc1 lds
s_add_u32 m0, s54, 4096
v_mfma_f32_16x16x32_bf16 a[36:39], a[124:127], a[116:119], a[36:39]
s_add_u32 s54, s58, s47
s_add_u32 s58, s58, 40960
s_cmp_lt_u32 s58, 163840
s_cselect_b32 s58, s58, 0
s_waitcnt lgkmcnt(9)
v_mfma_f32_16x16x32_bf16 a[40:43], a[128:131], a[100:103], a[40:43]
ds_read_b64_tr_b16 a[170:171], v235 offset:15360
buffer_load_dwordx4 v20, s[28:31], s50 offen sc1 lds
v_mfma_f32_16x16x32_bf16 a[44:47], a[128:131], a[104:107], a[44:47]
s_add_u32 m0, s54, 0
s_mul_i32 s50, s32, 20480
s_add_u32 s50, s50, s97
s_add_u32 s32, s32, 1
s_and_b32 s32, s32, 15
v_mfma_f32_16x16x32_bf16 a[48:51], a[128:131], a[108:111], a[48:51]
ds_read_b64_tr_b16 a[172:173], v236 offset:10240
v_add_u32 v235, s57, v243
v_mfma_f32_16x16x32_bf16 a[52:55], a[128:131], a[112:115], a[52:55]
buffer_load_dwordx4 v7, s[28:31], s50 offen sc1 lds
ds_read_b64_tr_b16 a[174:175], v236 offset:15360
v_mfma_f32_16x16x32_bf16 a[56:59], a[128:131], a[116:119], a[56:59]
ds_read_b64_tr_b16 a[176:177], v237 offset:10240
v_add_u32 v236, s57, v244
v_mfma_f32_16x16x32_bf16 a[60:63], a[132:135], a[100:103], a[60:63]
ds_read_b64_tr_b16 a[178:179], v237 offset:15360
v_add_u32 v237, s57, v245
v_mfma_f32_16x16x32_bf16 a[64:67], a[132:135], a[104:107], a[64:67]
buffer_load_dwordx4 v7, s[28:31], s50 offen offset:1024 sc1 lds
v_mfma_f32_16x16x32_bf16 a[68:71], a[132:135], a[108:111], a[68:71]
v_mfma_f32_16x16x32_bf16 a[72:75], a[132:135], a[112:115], a[72:75]
v_mfma_f32_16x16x32_bf16 a[76:79], a[132:135], a[116:119], a[76:79]
buffer_load_dwordx4 v7, s[28:31], s50 offen offset:2048 sc1 lds
v_mfma_f32_16x16x32_bf16 a[80:83], a[136:139], a[100:103], a[80:83]
v_mfma_f32_16x16x32_bf16 a[84:87], a[136:139], a[104:107], a[84:87]
v_mfma_f32_16x16x32_bf16 a[88:91], a[136:139], a[108:111], a[88:91]
buffer_load_dwordx4 v7, s[28:31], s50 offen offset:3072 sc1 lds
s_add_u32 m0, s54, 4096
v_mfma_f32_16x16x32_bf16 a[92:95], a[136:139], a[112:115], a[92:95]
s_add_u32 s54, s58, s47
s_add_u32 s58, s58, 40960
s_cmp_lt_u32 s58, 163840
s_cselect_b32 s58, s58, 0
v_mfma_f32_16x16x32_bf16 a[96:99], a[136:139], a[116:119], a[96:99]
s_waitcnt lgkmcnt(3)
v_mfma_f32_16x16x32_bf16 a[0:3], a[160:163], a[140:143], a[0:3]
buffer_load_dwordx4 v20, s[28:31], s50 offen sc1 lds
s_add_u32 m0, s54, 0
v_mfma_f32_16x16x32_bf16 a[4:7], a[160:163], a[144:147], a[4:7]
s_mul_i32 s50, s32, 20480
s_add_u32 s50, s50, s97
s_add_u32 s32, s32, 1
s_and_b32 s32, s32, 15
v_mfma_f32_16x16x32_bf16 a[8:11], a[160:163], a[148:151], a[8:11]
v_mfma_f32_16x16x32_bf16 a[12:15], a[160:163], a[152:155], a[12:15]
buffer_load_dwordx4 v7, s[28:31], s50 offen sc1 lds
v_mfma_f32_16x16x32_bf16 a[16:19], a[160:163], a[156:159], a[16:19]
v_mfma_f32_16x16x32_bf16 a[20:23], a[164:167], a[140:143], a[20:23]
v_mfma_f32_16x16x32_bf16 a[24:27], a[164:167], a[144:147], a[24:27]
buffer_load_dwordx4 v7, s[28:31], s50 offen offset:1024 sc1 lds
v_mfma_f32_16x16x32_bf16 a[28:31], a[164:167], a[148:151], a[28:31]
v_mfma_f32_16x16x32_bf16 a[32:35], a[164:167], a[152:155], a[32:35]
v_mfma_f32_16x16x32_bf16 a[36:39], a[164:167], a[156:159], a[36:39]
buffer_load_dwordx4 v7, s[28:31], s50 offen offset:2048 sc1 lds
v_mfma_f32_16x16x32_bf16 a[40:43], a[168:171], a[140:143], a[40:43]
v_mfma_f32_16x16x32_bf16 a[44:47], a[168:171], a[144:147], a[44:47]
v_mfma_f32_16x16x32_bf16 a[48:51], a[168:171], a[148:151], a[48:51]
buffer_load_dwordx4 v7, s[28:31], s50 offen offset:3072 sc1 lds
s_add_u32 m0, s54, 4096
v_mfma_f32_16x16x32_bf16 a[52:55], a[168:171], a[152:155], a[52:55]
v_mfma_f32_16x16x32_bf16 a[56:59], a[168:171], a[156:159], a[56:59]
s_waitcnt lgkmcnt(0)
v_mfma_f32_16x16x32_bf16 a[60:63], a[172:175], a[140:143], a[60:63]
buffer_load_dwordx4 v20, s[28:31], s50 offen sc1 lds
v_mfma_f32_16x16x32_bf16 a[64:67], a[172:175], a[144:147], a[64:67]
v_mfma_f32_16x16x32_bf16 a[68:71], a[172:175], a[148:151], a[68:71]
v_mfma_f32_16x16x32_bf16 a[72:75], a[172:175], a[152:155], a[72:75]
v_mfma_f32_16x16x32_bf16 a[76:79], a[172:175], a[156:159], a[76:79]
v_mfma_f32_16x16x32_bf16 a[80:83], a[176:179], a[140:143], a[80:83]
v_mfma_f32_16x16x32_bf16 a[84:87], a[176:179], a[144:147], a[84:87]
v_mfma_f32_16x16x32_bf16 a[88:91], a[176:179], a[148:151], a[88:91]
v_mfma_f32_16x16x32_bf16 a[92:95], a[176:179], a[152:155], a[92:95]
v_mfma_f32_16x16x32_bf16 a[96:99], a[176:179], a[156:159], a[96:99]
s_add_u32 s57, s57, 40960
s_cmp_lt_u32 s57, 163840
s_cselect_b32 s57, s57, 0
s_waitcnt vmcnt(10)
s_barrier
s_add_u32 s54, s56, s47
s_add_u32 m0, s54, 20480
s_mul_i32 s55, s61, 81920
s_add_u32 s55, s55, s98
s_add_u32 s61, s61, 1
s_and_b32 s61, s61, 15
buffer_load_dwordx4 v14, s[64:67], s55 offen lds
s_mul_i32 s50, s32, 20480
s_add_u32 s50, s50, s97
s_add_u32 s32, s32, 1
s_and_b32 s32, s32, 15
ds_read_b64_tr_b16 a[120:121], v233 offset:0
s_add_u32 s56, s56, 40960
s_cmp_lt_u32 s56, 163840
s_cselect_b32 s56, s56, 0
ds_read_b64_tr_b16 a[122:123], v233 offset:5120
ds_read_b128 a[100:103], v232 offset:0
buffer_load_dwordx4 v15, s[64:67], s55 offen offset:1024 lds
ds_read_b128 a[104:107], v232 offset:1024
ds_read_b128 a[108:111], v232 offset:2048
ds_read_b128 a[112:115], v232 offset:3072
buffer_load_dwordx4 v16, s[64:67], s55 offen offset:2048 lds
ds_read_b128 a[116:119], v232 offset:4096
ds_read_b64_tr_b16 a[124:125], v234 offset:0
ds_read_b64_tr_b16 a[126:127], v234 offset:5120
buffer_load_dwordx4 v17, s[64:67], s55 offen offset:3072 lds
s_add_u32 m0, s54, 24576
s_add_u32 s54, s58, s47
ds_read_b64_tr_b16 a[128:129], v235 offset:0
s_add_u32 s58, s58, 40960
s_cmp_lt_u32 s58, 163840
s_cselect_b32 s58, s58, 0
ds_read_b64_tr_b16 a[130:131], v235 offset:5120
ds_read_b64_tr_b16 a[132:133], v236 offset:0
ds_read_b64_tr_b16 a[134:135], v236 offset:5120
buffer_load_dwordx4 v18, s[64:67], s55 offen lds
s_waitcnt lgkmcnt(10)
v_mfma_f32_16x16x32_bf16 a[0:3], a[120:123], a[100:103], a[0:3]
s_add_u32 m0, s54, 0
ds_read_b64_tr_b16 a[136:137], v237 offset:0
s_waitcnt lgkmcnt(10)
v_mfma_f32_16x16x32_bf16 a[4:7], a[120:123], a[104:107], a[4:7]
ds_read_b64_tr_b16 a[138:139], v237 offset:5120
ds_read_b64_tr_b16 a[160:161], v233 offset:10240
ds_read_b64_tr_b16 a[162:163], v233 offset:15360
v_add_u32 v233, s57, v241
ds_read_b128 a[140:143], v232 offset:10240
ds_read_b128 a[144:147], v232 offset:11264
ds_read_b128 a[148:151], v232 offset:12288
ds_read_b128 a[152:155], v232 offset:13312
ds_read_b128 a[156:159], v232 offset:14336
ds_read_b64_tr_b16 a[164:165], v234 offset:10240
v_add_u32 v232, s57, v240
ds_read_b64_tr_b16 a[166:167], v234 offset:15360
v_add_u32 v234, s57, v242
buffer_load_dwordx4 v7, s[28:31], s50 offen sc1 lds
s_waitcnt lgkmcnt(14)
v_mfma_f32_16x16x32_bf16 a[8:11], a[120:123], a[108:111], a[8:11]
ds_read_b64_tr_b16 a[168:169], v235 offset:10240
v_mfma_f32_16x16x32_bf16 a[12:15], a[120:123], a[112:115], a[12:15]
ds_read_b64_tr_b16 a[170:171], v235 offset:15360
v_add_u32 v235, s57, v243
v_mfma_f32_16x16x32_bf16 a[16:19], a[120:123], a[116:119], a[16:19]
buffer_load_dwordx4 v7, s[28:31], s50 offen offset:1024 sc1 lds
ds_read_b64_tr_b16 a[172:173], v236 offset:10240
v_mfma_f32_16x16x32_bf16 a[20:23], a[124:127], a[100:103], a[20:23]
ds_read_b64_tr_b16 a[174:175], v236 offset:15360
v_add_u32 v236, s57, v244
v_mfma_f32_16x16x32_bf16 a[24:27], a[124:127], a[104:107], a[24:27]
ds_read_b64_tr_b16 a[176:177], v237 offset:10240
buffer_load_dwordx4 v7, s[28:31], s50 offen offset:2048 sc1 lds
v_mfma_f32_16x16x32_bf16 a[28:31], a[124:127], a[108:111], a[28:31]
ds_read_b64_tr_b16 a[178:179], v237 offset:15360
v_add_u32 v237, s57, v245
v_mfma_f32_16x16x32_bf16 a[32:35], a[124:127], a[112:115], a[32:35]
v_mfma_f32_16x16x32_bf16 a[36:39], a[124:127], a[116:119], a[36:39]
s_add_u32 s57, s57, 40960
s_cmp_lt_u32 s57, 163840
s_cselect_b32 s57, s57, 0
buffer_load_dwordx4 v7, s[28:31], s50 offen offset:3072 sc1 lds
s_add_u32 m0, s54, 4096
s_waitcnt lgkmcnt(14)
v_mfma_f32_16x16x32_bf16 a[40:43], a[128:131], a[100:103], a[40:43]
v_mfma_f32_16x16x32_bf16 a[44:47], a[128:131], a[104:107], a[44:47]
v_mfma_f32_16x16x32_bf16 a[48:51], a[128:131], a[108:111], a[48:51]
buffer_load_dwordx4 v20, s[28:31], s50 offen sc1 lds
v_mfma_f32_16x16x32_bf16 a[52:55], a[128:131], a[112:115], a[52:55]
v_mfma_f32_16x16x32_bf16 a[56:59], a[128:131], a[116:119], a[56:59]
v_mfma_f32_16x16x32_bf16 a[60:63], a[132:135], a[100:103], a[60:63]
v_mfma_f32_16x16x32_bf16 a[64:67], a[132:135], a[104:107], a[64:67]
s_waitcnt vmcnt(15) lgkmcnt(0)
s_barrier
v_mfma_f32_16x16x32_bf16 a[68:71], a[132:135], a[108:111], a[68:71]
s_add_u32 s54, s56, s47
s_add_u32 m0, s54, 20480
v_mfma_f32_16x16x32_bf16 a[72:75], a[132:135], a[112:115], a[72:75]
s_mul_i32 s55, s61, 81920
s_add_u32 s55, s55, s98
s_add_u32 s61, s61, 1
s_and_b32 s61, s61, 15
buffer_load_dwordx4 v14, s[64:67], s55 offen lds
v_mfma_f32_16x16x32_bf16 a[76:79], a[132:135], a[116:119], a[76:79]
s_mul_i32 s50, s32, 20480
s_add_u32 s50, s50, s97
s_add_u32 s32, s32, 1
s_and_b32 s32, s32, 15
ds_read_b64_tr_b16 a[120:121], v233 offset:0
v_mfma_f32_16x16x32_bf16 a[80:83], a[136:139], a[100:103], a[80:83]
ds_read_b64_tr_b16 a[122:123], v233 offset:5120
s_add_u32 s56, s56, 40960
s_cmp_lt_u32 s56, 163840
s_cselect_b32 s56, s56, 0
v_mfma_f32_16x16x32_bf16 a[84:87], a[136:139], a[104:107], a[84:87]
buffer_load_dwordx4 v15, s[64:67], s55 offen offset:1024 lds
ds_read_b128 a[100:103], v232 offset:0
v_mfma_f32_16x16x32_bf16 a[88:91], a[136:139], a[108:111], a[88:91]
ds_read_b128 a[104:107], v232 offset:1024
v_mfma_f32_16x16x32_bf16 a[92:95], a[136:139], a[112:115], a[92:95]
ds_read_b128 a[108:111], v232 offset:2048
v_mfma_f32_16x16x32_bf16 a[96:99], a[136:139], a[116:119], a[96:99]
buffer_load_dwordx4 v16, s[64:67], s55 offen offset:2048 lds
ds_read_b128 a[112:115], v232 offset:3072
v_mfma_f32_16x16x32_bf16 a[0:3], a[160:163], a[140:143], a[0:3]
ds_read_b128 a[116:119], v232 offset:4096
v_mfma_f32_16x16x32_bf16 a[4:7], a[160:163], a[144:147], a[4:7]
ds_read_b64_tr_b16 a[124:125], v234 offset:0
v_mfma_f32_16x16x32_bf16 a[8:11], a[160:163], a[148:151], a[8:11]
buffer_load_dwordx4 v17, s[64:67], s55 offen offset:3072 lds
s_add_u32 m0, s54, 24576
v_mfma_f32_16x16x32_bf16 a[12:15], a[160:163], a[152:155], a[12:15]
s_add_u32 s54, s58, s47
ds_read_b64_tr_b16 a[126:127], v234 offset:5120
v_mfma_f32_16x16x32_bf16 a[16:19], a[160:163], a[156:159], a[16:19]
ds_read_b64_tr_b16 a[128:129], v235 offset:0
s_add_u32 s58, s58, 40960
s_cmp_lt_u32 s58, 163840
s_cselect_b32 s58, s58, 0
v_mfma_f32_16x16x32_bf16 a[20:23], a[164:167], a[140:143], a[20:23]
buffer_load_dwordx4 v18, s[64:67], s55 offen lds
s_add_u32 m0, s54, 0
v_mfma_f32_16x16x32_bf16 a[24:27], a[164:167], a[144:147], a[24:27]
ds_read_b64_tr_b16 a[130:131], v235 offset:5120
v_mfma_f32_16x16x32_bf16 a[28:31], a[164:167], a[148:151], a[28:31]
ds_read_b64_tr_b16 a[132:133], v236 offset:0
v_mfma_f32_16x16x32_bf16 a[32:35], a[164:167], a[152:155], a[32:35]
buffer_load_dwordx4 v7, s[28:31], s50 offen sc1 lds
ds_read_b64_tr_b16 a[134:135], v236 offset:5120
v_mfma_f32_16x16x32_bf16 a[36:39], a[164:167], a[156:159], a[36:39]
ds_read_b64_tr_b16 a[136:137], v237 offset:0
v_mfma_f32_16x16x32_bf16 a[40:43], a[168:171], a[140:143], a[40:43]
ds_read_b64_tr_b16 a[138:139], v237 offset:5120
v_mfma_f32_16x16x32_bf16 a[44:47], a[168:171], a[144:147], a[44:47]
buffer_load_dwordx4 v7, s[28:31], s50 offen offset:1024 sc1 lds
v_mfma_f32_16x16x32_bf16 a[48:51], a[168:171], a[148:151], a[48:51]
ds_read_b64_tr_b16 a[160:161], v233 offset:10240
v_mfma_f32_16x16x32_bf16 a[52:55], a[168:171], a[152:155], a[52:55]
ds_read_b64_tr_b16 a[162:163], v233 offset:15360
v_add_u32 v233, s57, v241
v_mfma_f32_16x16x32_bf16 a[56:59], a[168:171], a[156:159], a[56:59]
buffer_load_dwordx4 v7, s[28:31], s50 offen offset:2048 sc1 lds
v_mfma_f32_16x16x32_bf16 a[60:63], a[172:175], a[140:143], a[60:63]
v_mfma_f32_16x16x32_bf16 a[64:67], a[172:175], a[144:147], a[64:67]
v_mfma_f32_16x16x32_bf16 a[68:71], a[172:175], a[148:151], a[68:71]
buffer_load_dwordx4 v7, s[28:31], s50 offen offset:3072 sc1 lds
s_add_u32 m0, s54, 4096
v_mfma_f32_16x16x32_bf16 a[72:75], a[172:175], a[152:155], a[72:75]
v_mfma_f32_16x16x32_bf16 a[76:79], a[172:175], a[156:159], a[76:79]
v_mfma_f32_16x16x32_bf16 a[80:83], a[176:179], a[140:143], a[80:83]
ds_read_b128 a[140:143], v232 offset:10240
buffer_load_dwordx4 v20, s[28:31], s50 offen sc1 lds
v_mfma_f32_16x16x32_bf16 a[84:87], a[176:179], a[144:147], a[84:87]
ds_read_b128 a[144:147], v232 offset:11264
v_mfma_f32_16x16x32_bf16 a[88:91], a[176:179], a[148:151], a[88:91]
ds_read_b128 a[148:151], v232 offset:12288
v_mfma_f32_16x16x32_bf16 a[92:95], a[176:179], a[152:155], a[92:95]
ds_read_b128 a[152:155], v232 offset:13312
v_mfma_f32_16x16x32_bf16 a[96:99], a[176:179], a[156:159], a[96:99]
ds_read_b128 a[156:159], v232 offset:14336
s_waitcnt lgkmcnt(6)
s_mov_b32 s41, 6
K1_L2:
v_mfma_f32_16x16x32_bf16 a[0:3], a[120:123], a[100:103], a[0:3]
ds_read_b64_tr_b16 a[164:165], v234 offset:10240
v_add_u32 v232, s57, v240
v_mfma_f32_16x16x32_bf16 a[4:7], a[120:123], a[104:107], a[4:7]
ds_read_b64_tr_b16 a[166:167], v234 offset:15360
v_add_u32 v234, s57, v242
v_mfma_f32_16x16x32_bf16 a[8:11], a[120:123], a[108:111], a[8:11]
ds_read_b64_tr_b16 a[168:169], v235 offset:10240
v_mfma_f32_16x16x32_bf16 a[12:15], a[120:123], a[112:115], a[12:15]
ds_read_b64_tr_b16 a[170:171], v235 offset:15360
v_add_u32 v235, s57, v243
v_mfma_f32_16x16x32_bf16 a[16:19], a[120:123], a[116:119], a[16:19]
ds_read_b64_tr_b16 a[172:173], v236 offset:10240
v_mfma_f32_16x16x32_bf16 a[20:23], a[124:127], a[100:103], a[20:23]
ds_read_b64_tr_b16 a[174:175], v236 offset:15360
v_add_u32 v236, s57, v244
v_mfma_f32_16x16x32_bf16 a[24:27], a[124:127], a[104:107], a[24:27]
ds_read_b64_tr_b16 a[176:177], v237 offset:10240
v_mfma_f32_16x16x32_bf16 a[28:31], a[124:127], a[108:111], a[28:31]
ds_read_b64_tr_b16 a[178:179], v237 offset:15360
v_add_u32 v237, s57, v245
v_mfma_f32_16x16x32_bf16 a[32:35], a[124:127], a[112:115], a[32:35]
v_mfma_f32_16x16x32_bf16 a[36:39], a[124:127], a[116:119], a[36:39]
s_add_u32 s57, s57, 40960
s_cmp_lt_u32 s57, 163840
s_cselect_b32 s57, s57, 0
v_mfma_f32_16x16x32_bf16 a[40:43], a[128:131], a[100:103], a[40:43]
v_mfma_f32_16x16x32_bf16 a[44:47], a[128:131], a[104:107], a[44:47]
v_mfma_f32_16x16x32_bf16 a[48:51], a[128:131], a[108:111], a[48:51]
v_mfma_f32_16x16x32_bf16 a[52:55], a[128:131], a[112:115], a[52:55]
v_mfma_f32_16x16x32_bf16 a[56:59], a[128:131], a[116:119], a[56:59]
v_mfma_f32_16x16x32_bf16 a[60:63], a[132:135], a[100:103], a[60:63]
v_mfma_f32_16x16x32_bf16 a[64:67], a[132:135], a[104:107], a[64:67]
s_waitcnt vmcnt(20) lgkmcnt(0)
s_barrier
v_mfma_f32_16x16x32_bf16 a[68:71], a[132:135], a[108:111], a[68:71]
s_add_u32 s54, s56, s47
s_add_u32 m0, s54, 20480
v_mfma_f32_16x16x32_bf16 a[72:75], a[132:135], a[112:115], a[72:75]
s_mul_i32 s55, s61, 81920
s_add_u32 s55, s55, s98
s_add_u32 s61, s61, 1
s_and_b32 s61, s61, 15
buffer_load_dwordx4 v14, s[64:67], s55 offen lds
v_mfma_f32_16x16x32_bf16 a[76:79], a[132:135], a[116:119], a[76:79]
s_mul_i32 s50, s32, 20480
s_add_u32 s50, s50, s97
s_add_u32 s32, s32, 1
s_and_b32 s32, s32, 15
ds_read_b64_tr_b16 a[120:121], v233 offset:0
v_mfma_f32_16x16x32_bf16 a[80:83], a[136:139], a[100:103], a[80:83]
ds_read_b64_tr_b16 a[122:123], v233 offset:5120
s_add_u32 s56, s56, 40960
s_cmp_lt_u32 s56, 163840
s_cselect_b32 s56, s56, 0
v_mfma_f32_16x16x32_bf16 a[84:87], a[136:139], a[104:107], a[84:87]
buffer_load_dwordx4 v15, s[64:67], s55 offen offset:1024 lds
ds_read_b128 a[100:103], v232 offset:0
v_mfma_f32_16x16x32_bf16 a[88:91], a[136:139], a[108:111], a[88:91]
ds_read_b128 a[104:107], v232 offset:1024
v_mfma_f32_16x16x32_bf16 a[92:95], a[136:139], a[112:115], a[92:95]
ds_read_b128 a[108:111], v232 offset:2048
v_mfma_f32_16x16x32_bf16 a[96:99], a[136:139], a[116:119], a[96:99]
buffer_load_dwordx4 v16, s[64:67], s55 offen offset:2048 lds
ds_read_b128 a[112:115], v232 offset:3072
v_mfma_f32_16x16x32_bf16 a[0:3], a[160:163], a[140:143], a[0:3]
ds_read_b128 a[116:119], v232 offset:4096
v_mfma_f32_16x16x32_bf16 a[4:7], a[160:163], a[144:147], a[4:7]
ds_read_b64_tr_b16 a[124:125], v234 offset:0
v_mfma_f32_16x16x32_bf16 a[8:11], a[160:163], a[148:151], a[8:11]
buffer_load_dwordx4 v17, s[64:67], s55 offen offset:3072 lds
s_add_u32 m0, s54, 24576
v_mfma_f32_16x16x32_bf16 a[12:15], a[160:163], a[152:155], a[12:15]
s_add_u32 s54, s58, s47
ds_read_b64_tr_b16 a[126:127], v234 offset:5120
v_mfma_f32_16x16x32_bf16 a[16:19], a[160:163], a[156:159], a[16:19]
ds_read_b64_tr_b16 a[128:129], v235 offset:0
s_add_u32 s58, s58, 40960
s_cmp_lt_u32 s58, 163840
s_cselect_b32 s58, s58, 0
v_mfma_f32_16x16x32_bf16 a[20:23], a[164:167], a[140:143], a[20:23]
buffer_load_dwordx4 v18, s[64:67], s55 offen lds
s_add_u32 m0, s54, 0
v_mfma_f32_16x16x32_bf16 a[24:27], a[164:167], a[144:147], a[24:27]
ds_read_b64_tr_b16 a[130:131], v235 offset:5120
v_mfma_f32_16x16x32_bf16 a[28:31], a[164:167], a[148:151], a[28:31]
ds_read_b64_tr_b16 a[132:133], v236 offset:0
v_mfma_f32_16x16x32_bf16 a[32:35], a[164:167], a[152:155], a[32:35]
buffer_load_dwordx4 v7, s[28:31], s50 offen sc1 lds
ds_read_b64_tr_b16 a[134:135], v236 offset:5120
v_mfma_f32_16x16x32_bf16 a[36:39], a[164:167], a[156:159], a[36:39]
ds_read_b64_tr_b16 a[136:137], v237 offset:0
v_mfma_f32_16x16x32_bf16 a[40:43], a[168:171], a[140:143], a[40:43]
ds_read_b64_tr_b16 a[138:139], v237 offset:5120
v_mfma_f32_16x16x32_bf16 a[44:47], a[168:171], a[144:147], a[44:47]
buffer_load_dwordx4 v7, s[28:31], s50 offen offset:1024 sc1 lds
v_mfma_f32_16x16x32_bf16 a[48:51], a[168:171], a[148:151], a[48:51]
ds_read_b64_tr_b16 a[160:161], v233 offset:10240
v_mfma_f32_16x16x32_bf16 a[52:55], a[168:171], a[152:155], a[52:55]
ds_read_b64_tr_b16 a[162:163], v233 offset:15360
v_add_u32 v233, s57, v241
v_mfma_f32_16x16x32_bf16 a[56:59], a[168:171], a[156:159], a[56:59]
buffer_load_dwordx4 v7, s[28:31], s50 offen offset:2048 sc1 lds
v_mfma_f32_16x16x32_bf16 a[60:63], a[172:175], a[140:143], a[60:63]
v_mfma_f32_16x16x32_bf16 a[64:67], a[172:175], a[144:147], a[64:67]
v_mfma_f32_16x16x32_bf16 a[68:71], a[172:175], a[148:151], a[68:71]
buffer_load_dwordx4 v7, s[28:31], s50 offen offset:3072 sc1 lds
s_add_u32 m0, s54, 4096
v_mfma_f32_16x16x32_bf16 a[72:75], a[172:175], a[152:155], a[72:75]
v_mfma_f32_16x16x32_bf16 a[76:79], a[172:175], a[156:159], a[76:79]
v_mfma_f32_16x16x32_bf16 a[80:83], a[176:179], a[140:143], a[80:83]
ds_read_b128 a[140:143], v232 offset:10240
buffer_load_dwordx4 v20, s[28:31], s50 offen sc1 lds
v_mfma_f32_16x16x32_bf16 a[84:87], a[176:179], a[144:147], a[84:87]
ds_read_b128 a[144:147], v232 offset:11264
v_mfma_f32_16x16x32_bf16 a[88:91], a[176:179], a[148:151], a[88:91]
ds_read_b128 a[148:151], v232 offset:12288
v_mfma_f32_16x16x32_bf16 a[92:95], a[176:179], a[152:155], a[92:95]
ds_read_b128 a[152:155], v232 offset:13312
v_mfma_f32_16x16x32_bf16 a[96:99], a[176:179], a[156:159], a[96:99]
ds_read_b128 a[156:159], v232 offset:14336
s_waitcnt lgkmcnt(6)
s_sub_u32 s41, s41, 1
s_cmp_lg_u32 s41, 0
s_cbranch_scc1 K1_L2
v_mfma_f32_16x16x32_bf16 a[0:3], a[120:123], a[100:103], a[0:3]
ds_read_b64_tr_b16 a[164:165], v234 offset:10240
v_add_u32 v232, s57, v240
v_mfma_f32_16x16x32_bf16 a[4:7], a[120:123], a[104:107], a[4:7]
ds_read_b64_tr_b16 a[166:167], v234 offset:15360
v_add_u32 v234, s57, v242
v_mfma_f32_16x16x32_bf16 a[8:11], a[120:123], a[108:111], a[8:11]
ds_read_b64_tr_b16 a[168:169], v235 offset:10240
v_mfma_f32_16x16x32_bf16 a[12:15], a[120:123], a[112:115], a[12:15]
ds_read_b64_tr_b16 a[170:171], v235 offset:15360
v_add_u32 v235, s57, v243
v_mfma_f32_16x16x32_bf16 a[16:19], a[120:123], a[116:119], a[16:19]
ds_read_b64_tr_b16 a[172:173], v236 offset:10240
v_mfma_f32_16x16x32_bf16 a[20:23], a[124:127], a[100:103], a[20:23]
ds_read_b64_tr_b16 a[174:175], v236 offset:15360
v_add_u32 v236, s57, v244
v_mfma_f32_16x16x32_bf16 a[24:27], a[124:127], a[104:107], a[24:27]
ds_read_b64_tr_b16 a[176:177], v237 offset:10240
v_mfma_f32_16x16x32_bf16 a[28:31], a[124:127], a[108:111], a[28:31]
ds_read_b64_tr_b16 a[178:179], v237 offset:15360
v_add_u32 v237, s57, v245
v_mfma_f32_16x16x32_bf16 a[32:35], a[124:127], a[112:115], a[32:35]
s_add_u32 s57, s57, 40960
s_cmp_lt_u32 s57, 163840
s_cselect_b32 s57, s57, 0
v_mfma_f32_16x16x32_bf16 a[36:39], a[124:127], a[116:119], a[36:39]
v_mfma_f32_16x16x32_bf16 a[40:43], a[128:131], a[100:103], a[40:43]
v_mfma_f32_16x16x32_bf16 a[44:47], a[128:131], a[104:107], a[44:47]
v_mfma_f32_16x16x32_bf16 a[48:51], a[128:131], a[108:111], a[48:51]
v_mfma_f32_16x16x32_bf16 a[52:55], a[128:131], a[112:115], a[52:55]
v_mfma_f32_16x16x32_bf16 a[56:59], a[128:131], a[116:119], a[56:59]
v_mfma_f32_16x16x32_bf16 a[60:63], a[132:135], a[100:103], a[60:63]
v_mfma_f32_16x16x32_bf16 a[64:67], a[132:135], a[104:107], a[64:67]
s_waitcnt vmcnt(20) lgkmcnt(0)
s_barrier
v_mfma_f32_16x16x32_bf16 a[68:71], a[132:135], a[108:111], a[68:71]
s_add_u32 s54, s56, s47
s_add_u32 m0, s54, 20480
v_mfma_f32_16x16x32_bf16 a[72:75], a[132:135], a[112:115], a[72:75]
s_mul_i32 s55, s61, 81920
s_add_u32 s55, s55, s98
s_add_u32 s61, s61, 1
s_and_b32 s61, s61, 15
buffer_load_dwordx4 v14, s[64:67], s55 offen lds
v_mfma_f32_16x16x32_bf16 a[76:79], a[132:135], a[116:119], a[76:79]
s_mul_i32 s50, s32, 20480
s_add_u32 s50, s50, s97
s_add_u32 s32, s32, 1
s_and_b32 s32, s32, 15
ds_read_b64_tr_b16 a[120:121], v233 offset:0
v_mfma_f32_16x16x32_bf16 a[80:83], a[136:139], a[100:103], a[80:83]
ds_read_b64_tr_b16 a[122:123], v233 offset:5120
s_add_u32 s56, s56, 40960
s_cmp_lt_u32 s56, 163840
s_cselect_b32 s56, s56, 0
v_mfma_f32_16x16x32_bf16 a[84:87], a[136:139], a[104:107], a[84:87]
buffer_load_dwordx4 v15, s[64:67], s55 offen offset:1024 lds
ds_read_b128 a[100:103], v232 offset:0
v_mfma_f32_16x16x32_bf16 a[88:91], a[136:139], a[108:111], a[88:91]
ds_read_b128 a[104:107], v232 offset:1024
v_mfma_f32_16x16x32_bf16 a[92:95], a[136:139], a[112:115], a[92:95]
ds_read_b128 a[108:111], v232 offset:2048
v_mfma_f32_16x16x32_bf16 a[96:99], a[136:139], a[116:119], a[96:99]
buffer_load_dwordx4 v16, s[64:67], s55 offen offset:2048 lds
ds_read_b128 a[112:115], v232 offset:3072
v_mfma_f32_16x16x32_bf16 a[0:3], a[160:163], a[140:143], a[0:3]
ds_read_b128 a[116:119], v232 offset:4096
v_mfma_f32_16x16x32_bf16 a[4:7], a[160:163], a[144:147], a[4:7]
ds_read_b64_tr_b16 a[124:125], v234 offset:0
v_mfma_f32_16x16x32_bf16 a[8:11], a[160:163], a[148:151], a[8:11]
buffer_load_dwordx4 v17, s[64:67], s55 offen offset:3072 lds
s_add_u32 m0, s54, 24576
v_mfma_f32_16x16x32_bf16 a[12:15], a[160:163], a[152:155], a[12:15]
s_add_u32 s54, s58, s47
ds_read_b64_tr_b16 a[126:127], v234 offset:5120
v_mfma_f32_16x16x32_bf16 a[16:19], a[160:163], a[156:159], a[16:19]
ds_read_b64_tr_b16 a[128:129], v235 offset:0
s_add_u32 s58, s58, 40960
s_cmp_lt_u32 s58, 163840
s_cselect_b32 s58, s58, 0
v_mfma_f32_16x16x32_bf16 a[20:23], a[164:167], a[140:143], a[20:23]
buffer_load_dwordx4 v18, s[64:67], s55 offen lds
s_add_u32 m0, s54, 0
v_mfma_f32_16x16x32_bf16 a[24:27], a[164:167], a[144:147], a[24:27]
ds_read_b64_tr_b16 a[130:131], v235 offset:5120
v_mfma_f32_16x16x32_bf16 a[28:31], a[164:167], a[148:151], a[28:31]
ds_read_b64_tr_b16 a[132:133], v236 offset:0
v_mfma_f32_16x16x32_bf16 a[32:35], a[164:167], a[152:155], a[32:35]
buffer_load_dwordx4 v7, s[28:31], s50 offen sc1 lds
ds_read_b64_tr_b16 a[134:135], v236 offset:5120
v_mfma_f32_16x16x32_bf16 a[36:39], a[164:167], a[156:159], a[36:39]
ds_read_b64_tr_b16 a[136:137], v237 offset:0
v_mfma_f32_16x16x32_bf16 a[40:43], a[168:171], a[140:143], a[40:43]
ds_read_b64_tr_b16 a[138:139], v237 offset:5120
ds_read_b64_tr_b16 a[160:161], v233 offset:10240
ds_read_b64_tr_b16 a[162:163], v233 offset:15360
v_add_u32 v233, s57, v241
v_mfma_f32_16x16x32_bf16 a[44:47], a[168:171], a[144:147], a[44:47]
buffer_load_dwordx4 v7, s[28:31], s50 offen offset:1024 sc1 lds
v_mfma_f32_16x16x32_bf16 a[48:51], a[168:171], a[148:151], a[48:51]
v_mfma_f32_16x16x32_bf16 a[52:55], a[168:171], a[152:155], a[52:55]
v_mfma_f32_16x16x32_bf16 a[56:59], a[168:171], a[156:159], a[56:59]
buffer_load_dwordx4 v7, s[28:31], s50 offen offset:2048 sc1 lds
v_mfma_f32_16x16x32_bf16 a[60:63], a[172:175], a[140:143], a[60:63]
v_mfma_f32_16x16x32_bf16 a[64:67], a[172:175], a[144:147], a[64:67]
v_mfma_f32_16x16x32_bf16 a[68:71], a[172:175], a[148:151], a[68:71]
buffer_load_dwordx4 v7, s[28:31], s50 offen offset:3072 sc1 lds
s_add_u32 m0, s54, 4096
v_mfma_f32_16x16x32_bf16 a[72:75], a[172:175], a[152:155], a[72:75]
v_mfma_f32_16x16x32_bf16 a[76:79], a[172:175], a[156:159], a[76:79]
v_mfma_f32_16x16x32_bf16 a[80:83], a[176:179], a[140:143], a[80:83]
buffer_load_dwordx4 v20, s[28:31], s50 offen sc1 lds
ds_read_b128 a[140:143], v232 offset:10240
v_mfma_f32_16x16x32_bf16 a[84:87], a[176:179], a[144:147], a[84:87]
ds_read_b128 a[144:147], v232 offset:11264
v_mfma_f32_16x16x32_bf16 a[88:91], a[176:179], a[148:151], a[88:91]
ds_read_b128 a[148:151], v232 offset:12288
v_mfma_f32_16x16x32_bf16 a[92:95], a[176:179], a[152:155], a[92:95]
ds_read_b128 a[152:155], v232 offset:13312
v_mfma_f32_16x16x32_bf16 a[96:99], a[176:179], a[156:159], a[96:99]
ds_read_b128 a[156:159], v232 offset:14336
v_add_u32 v232, s57, v240
s_waitcnt lgkmcnt(5)
s_mov_b32 s41, 3
K1_L3:
v_mfma_f32_16x16x32_bf16 a[0:3], a[120:123], a[100:103], a[0:3]
ds_read_b64_tr_b16 a[164:165], v234 offset:10240
v_mfma_f32_16x16x32_bf16 a[4:7], a[120:123], a[104:107], a[4:7]
ds_read_b64_tr_b16 a[166:167], v234 offset:15360
v_add_u32 v234, s57, v242
v_mfma_f32_16x16x32_bf16 a[8:11], a[120:123], a[108:111], a[8:11]
ds_read_b64_tr_b16 a[168:169], v235 offset:10240
v_mfma_f32_16x16x32_bf16 a[12:15], a[120:123], a[112:115], a[12:15]
ds_read_b64_tr_b16 a[170:171], v235 offset:15360
v_add_u32 v235, s57, v243
v_mfma_f32_16x16x32_bf16 a[16:19], a[120:123], a[116:119], a[16:19]
ds_read_b64_tr_b16 a[172:173], v236 offset:10240
v_mfma_f32_16x16x32_bf16 a[20:23], a[124:127], a[100:103], a[20:23]
ds_read_b64_tr_b16 a[174:175], v236 offset:15360
v_add_u32 v236, s57, v244
v_mfma_f32_16x16x32_bf16 a[24:27], a[124:127], a[104:107], a[24:27]
ds_read_b64_tr_b16 a[176:177], v237 offset:10240
v_mfma_f32_16x16x32_bf16 a[28:31], a[124:127], a[108:111], a[28:31]
ds_read_b64_tr_b16 a[178:179], v237 offset:15360
v_add_u32 v237, s57, v245
v_mfma_f32_16x16x32_bf16 a[32:35], a[124:127], a[112:115], a[32:35]
s_add_u32 s57, s57, 40960
s_cmp_lt_u32 s57, 163840
s_cselect_b32 s57, s57, 0
v_mfma_f32_16x16x32_bf16 a[36:39], a[124:127], a[116:119], a[36:39]
v_mfma_f32_16x16x32_bf16 a[40:43], a[128:131], a[100:103], a[40:43]
v_mfma_f32_16x16x32_bf16 a[44:47], a[128:131], a[104:107], a[44:47]
v_mfma_f32_16x16x32_bf16 a[48:51], a[128:131], a[108:111], a[48:51]
v_mfma_f32_16x16x32_bf16 a[52:55], a[128:131], a[112:115], a[52:55]
v_mfma_f32_16x16x32_bf16 a[56:59], a[128:131], a[116:119], a[56:59]
v_mfma_f32_16x16x32_bf16 a[60:63], a[132:135], a[100:103], a[60:63]
v_mfma_f32_16x16x32_bf16 a[64:67], a[132:135], a[104:107], a[64:67]
s_waitcnt vmcnt(0) lgkmcnt(0)
s_barrier
v_mfma_f32_16x16x32_bf16 a[68:71], a[132:135], a[108:111], a[68:71]
ds_read_b64_tr_b16 a[120:121], v233 offset:0
v_mfma_f32_16x16x32_bf16 a[72:75], a[132:135], a[112:115], a[72:75]
ds_read_b64_tr_b16 a[122:123], v233 offset:5120
v_mfma_f32_16x16x32_bf16 a[76:79], a[132:135], a[116:119], a[76:79]
v_mfma_f32_16x16x32_bf16 a[80:83], a[136:139], a[100:103], a[80:83]
ds_read_b128 a[100:103], v232 offset:0
v_mfma_f32_16x16x32_bf16 a[84:87], a[136:139], a[104:107], a[84:87]
ds_read_b128 a[104:107], v232 offset:1024
v_mfma_f32_16x16x32_bf16 a[88:91], a[136:139], a[108:111], a[88:91]
ds_read_b128 a[108:111], v232 offset:2048
v_mfma_f32_16x16x32_bf16 a[92:95], a[136:139], a[112:115], a[92:95]
ds_read_b128 a[112:115], v232 offset:3072
v_mfma_f32_16x16x32_bf16 a[96:99], a[136:139], a[116:119], a[96:99]
ds_read_b128 a[116:119], v232 offset:4096
v_mfma_f32_16x16x32_bf16 a[0:3], a[160:163], a[140:143], a[0:3]
ds_read_b64_tr_b16 a[124:125], v234 offset:0
v_mfma_f32_16x16x32_bf16 a[4:7], a[160:163], a[144:147], a[4:7]
ds_read_b64_tr_b16 a[126:127], v234 offset:5120
v_mfma_f32_16x16x32_bf16 a[8:11], a[160:163], a[148:151], a[8:11]
ds_read_b64_tr_b16 a[128:129], v235 offset:0
v_mfma_f32_16x16x32_bf16 a[12:15], a[160:163], a[152:155], a[12:15]
ds_read_b64_tr_b16 a[130:131], v235 offset:5120
v_mfma_f32_16x16x32_bf16 a[16:19], a[160:163], a[156:159], a[16:19]
ds_read_b64_tr_b16 a[132:133], v236 offset:0
v_mfma_f32_16x16x32_bf16 a[20:23], a[164:167], a[140:143], a[20:23]
ds_read_b64_tr_b16 a[134:135], v236 offset:5120
v_mfma_f32_16x16x32_bf16 a[24:27], a[164:167], a[144:147], a[24:27]
ds_read_b64_tr_b16 a[136:137], v237 offset:0
v_mfma_f32_16x16x32_bf16 a[28:31], a[164:167], a[148:151], a[28:31]
ds_read_b64_tr_b16 a[138:139], v237 offset:5120
v_mfma_f32_16x16x32_bf16 a[32:35], a[164:167], a[152:155], a[32:35]
ds_read_b64_tr_b16 a[160:161], v233 offset:10240
v_mfma_f32_16x16x32_bf16 a[36:39], a[164:167], a[156:159], a[36:39]
ds_read_b64_tr_b16 a[162:163], v233 offset:15360
v_add_u32 v233, s57, v241
v_mfma_f32_16x16x32_bf16 a[40:43], a[168:171], a[140:143], a[40:43]
v_mfma_f32_16x16x32_bf16 a[44:47], a[168:171], a[144:147], a[44:47]
v_mfma_f32_16x16x32_bf16 a[48:51], a[168:171], a[148:151], a[48:51]
v_mfma_f32_16x16x32_bf16 a[52:55], a[168:171], a[152:155], a[52:55]
v_mfma_f32_16x16x32_bf16 a[56:59], a[168:171], a[156:159], a[56:59]
v_mfma_f32_16x16x32_bf16 a[60:63], a[172:175], a[140:143], a[60:63]
v_mfma_f32_16x16x32_bf16 a[64:67], a[172:175], a[144:147], a[64:67]
v_mfma_f32_16x16x32_bf16 a[68:71], a[172:175], a[148:151], a[68:71]
v_mfma_f32_16x16x32_bf16 a[72:75], a[172:175], a[152:155], a[72:75]
v_mfma_f32_16x16x32_bf16 a[76:79], a[172:175], a[156:159], a[76:79]
v_mfma_f32_16x16x32_bf16 a[80:83], a[176:179], a[140:143], a[80:83]
ds_read_b128 a[140:143], v232 offset:10240
v_mfma_f32_16x16x32_bf16 a[84:87], a[176:179], a[144:147], a[84:87]
ds_read_b128 a[144:147], v232 offset:11264
v_mfma_f32_16x16x32_bf16 a[88:91], a[176:179], a[148:151], a[88:91]
ds_read_b128 a[148:151], v232 offset:12288
v_mfma_f32_16x16x32_bf16 a[92:95], a[176:179], a[152:155], a[92:95]
ds_read_b128 a[152:155], v232 offset:13312
v_mfma_f32_16x16x32_bf16 a[96:99], a[176:179], a[156:159], a[96:99]
ds_read_b128 a[156:159], v232 offset:14336
v_add_u32 v232, s57, v240
s_waitcnt lgkmcnt(5)
s_sub_u32 s41, s41, 1
s_cmp_lg_u32 s41, 0
s_cbranch_scc1 K1_L3
v_mfma_f32_16x16x32_bf16 a[0:3], a[120:123], a[100:103], a[0:3]
ds_read_b64_tr_b16 a[164:165], v234 offset:10240
v_mfma_f32_16x16x32_bf16 a[4:7], a[120:123], a[104:107], a[4:7]
ds_read_b64_tr_b16 a[166:167], v234 offset:15360
v_add_u32 v234, s57, v242
v_mfma_f32_16x16x32_bf16 a[8:11], a[120:123], a[108:111], a[8:11]
ds_read_b64_tr_b16 a[168:169], v235 offset:10240
v_mfma_f32_16x16x32_bf16 a[12:15], a[120:123], a[112:115], a[12:15]
ds_read_b64_tr_b16 a[170:171], v235 offset:15360
v_add_u32 v235, s57, v243
v_mfma_f32_16x16x32_bf16 a[16:19], a[120:123], a[116:119], a[16:19]
ds_read_b64_tr_b16 a[172:173], v236 offset:10240
v_mfma_f32_16x16x32_bf16 a[20:23], a[124:127], a[100:103], a[20:23]
ds_read_b64_tr_b16 a[174:175], v236 offset:15360
v_add_u32 v236, s57, v244
v_mfma_f32_16x16x32_bf16 a[24:27], a[124:127], a[104:107], a[24:27]
ds_read_b64_tr_b16 a[176:177], v237 offset:10240
v_mfma_f32_16x16x32_bf16 a[28:31], a[124:127], a[108:111], a[28:31]
ds_read_b64_tr_b16 a[178:179], v237 offset:15360
v_add_u32 v237, s57, v245
v_mfma_f32_16x16x32_bf16 a[32:35], a[124:127], a[112:115], a[32:35]
v_mfma_f32_16x16x32_bf16 a[36:39], a[124:127], a[116:119], a[36:39]
v_mfma_f32_16x16x32_bf16 a[40:43], a[128:131], a[100:103], a[40:43]
v_mfma_f32_16x16x32_bf16 a[44:47], a[128:131], a[104:107], a[44:47]
v_mfma_f32_16x16x32_bf16 a[48:51], a[128:131], a[108:111], a[48:51]
v_mfma_f32_16x16x32_bf16 a[52:55], a[128:131], a[112:115], a[52:55]
v_mfma_f32_16x16x32_bf16 a[56:59], a[128:131], a[116:119], a[56:59]
v_mfma_f32_16x16x32_bf16 a[60:63], a[132:135], a[100:103], a[60:63]
v_mfma_f32_16x16x32_bf16 a[64:67], a[132:135], a[104:107], a[64:67]
v_mfma_f32_16x16x32_bf16 a[68:71], a[132:135], a[108:111], a[68:71]
v_mfma_f32_16x16x32_bf16 a[72:75], a[132:135], a[112:115], a[72:75]
v_mfma_f32_16x16x32_bf16 a[76:79], a[132:135], a[116:119], a[76:79]
v_mfma_f32_16x16x32_bf16 a[80:83], a[136:139], a[100:103], a[80:83]
v_mfma_f32_16x16x32_bf16 a[84:87], a[136:139], a[104:107], a[84:87]
v_mfma_f32_16x16x32_bf16 a[88:91], a[136:139], a[108:111], a[88:91]
v_mfma_f32_16x16x32_bf16 a[92:95], a[136:139], a[112:115], a[92:95]
v_mfma_f32_16x16x32_bf16 a[96:99], a[136:139], a[116:119], a[96:99]
s_waitcnt lgkmcnt(0)
v_mfma_f32_16x16x32_bf16 a[0:3], a[160:163], a[140:143], a[0:3]
v_mfma_f32_16x16x32_bf16 a[4:7], a[160:163], a[144:147], a[4:7]
v_mfma_f32_16x16x32_bf16 a[8:11], a[160:163], a[148:151], a[8:11]
s_nop 5
v_accvgpr_read_b32 v116, a0
v_mfma_f32_16x16x32_bf16 a[12:15], a[160:163], a[152:155], a[12:15]
v_accvgpr_read_b32 v117, a1
v_accvgpr_read_b32 v118, a2
v_mfma_f32_16x16x32_bf16 a[16:19], a[160:163], a[156:159], a[16:19]
v_accvgpr_read_b32 v119, a3
v_accvgpr_read_b32 v120, a4
v_mfma_f32_16x16x32_bf16 a[20:23], a[164:167], a[140:143], a[20:23]
v_accvgpr_read_b32 v121, a5
v_accvgpr_read_b32 v122, a6
v_mfma_f32_16x16x32_bf16 a[24:27], a[164:167], a[144:147], a[24:27]
v_accvgpr_read_b32 v123, a7
s_lshl_b32 s50, s74, 10
s_add_u32 s50, s50, s73
v_mfma_f32_16x16x32_bf16 a[28:31], a[164:167], a[148:151], a[28:31]
v_cvt_pk_bf16_f32 v112, v116, v117
v_cvt_pk_bf16_f32 v113, v118, v119
v_mfma_f32_16x16x32_bf16 a[32:35], a[164:167], a[152:155], a[32:35]
v_cvt_pk_bf16_f32 v114, v120, v121
v_cvt_pk_bf16_f32 v115, v122, v123
v_mfma_f32_16x16x32_bf16 a[36:39], a[164:167], a[156:159], a[36:39]
buffer_store_dwordx4 v[112:115], v7, s[28:31], s50 offen sc1
v_accvgpr_read_b32 v128, a8
v_mfma_f32_16x16x32_bf16 a[40:43], a[168:171], a[140:143], a[40:43]
v_accvgpr_read_b32 v129, a9
v_accvgpr_read_b32 v130, a10
v_mfma_f32_16x16x32_bf16 a[44:47], a[168:171], a[144:147], a[44:47]
v_accvgpr_read_b32 v131, a11
v_accvgpr_read_b32 v132, a12
v_mfma_f32_16x16x32_bf16 a[48:51], a[168:171], a[148:151], a[48:51]
v_accvgpr_read_b32 v133, a13
v_accvgpr_read_b32 v134, a14
v_mfma_f32_16x16x32_bf16 a[52:55], a[168:171], a[152:155], a[52:55]
v_accvgpr_read_b32 v135, a15
s_add_u32 s50, s50, 4096
v_mfma_f32_16x16x32_bf16 a[56:59], a[168:171], a[156:159], a[56:59]
v_cvt_pk_bf16_f32 v124, v128, v129
v_cvt_pk_bf16_f32 v125, v130, v131
v_mfma_f32_16x16x32_bf16 a[60:63], a[172:175], a[140:143], a[60:63]
v_cvt_pk_bf16_f32 v126, v132, v133
v_cvt_pk_bf16_f32 v127, v134, v135
v_mfma_f32_16x16x32_bf16 a[64:67], a[172:175], a[144:147], a[64:67]
buffer_store_dwordx4 v[124:127], v7, s[28:31], s50 offen sc1
v_accvgpr_read_b32 v140, a16
v_mfma_f32_16x16x32_bf16 a[68:71], a[172:175], a[148:151], a[68:71]
v_accvgpr_read_b32 v141, a17
v_accvgpr_read_b32 v142, a18
v_mfma_f32_16x16x32_bf16 a[72:75], a[172:175], a[152:155], a[72:75]
v_accvgpr_read_b32 v143, a19
v_accvgpr_read_b32 v144, a20
v_mfma_f32_16x16x32_bf16 a[76:79], a[172:175], a[156:159], a[76:79]
v_accvgpr_read_b32 v145, a21
v_accvgpr_read_b32 v146, a22
v_mfma_f32_16x16x32_bf16 a[80:83], a[176:179], a[140:143], a[80:83]
v_accvgpr_read_b32 v147, a23
s_add_u32 s50, s50, 4096
v_mfma_f32_16x16x32_bf16 a[84:87], a[176:179], a[144:147], a[84:87]
v_cvt_pk_bf16_f32 v136, v140, v141
v_cvt_pk_bf16_f32 v137, v142, v143
v_mfma_f32_16x16x32_bf16 a[88:91], a[176:179], a[148:151], a[88:91]
v_cvt_pk_bf16_f32 v138, v144, v145
v_cvt_pk_bf16_f32 v139, v146, v147
v_mfma_f32_16x16x32_bf16 a[92:95], a[176:179], a[152:155], a[92:95]
buffer_store_dwordx4 v[136:139], v7, s[28:31], s50 offen sc1
v_accvgpr_read_b32 v152, a24
v_mfma_f32_16x16x32_bf16 a[96:99], a[176:179], a[156:159], a[96:99]
v_accvgpr_read_b32 v153, a25
v_accvgpr_read_b32 v154, a26
v_accvgpr_read_b32 v155, a27
v_accvgpr_read_b32 v156, a28
v_accvgpr_read_b32 v157, a29
v_accvgpr_read_b32 v158, a30
v_accvgpr_read_b32 v159, a31
s_add_u32 s50, s50, 4096
v_cvt_pk_bf16_f32 v148, v152, v153
v_cvt_pk_bf16_f32 v149, v154, v155
v_cvt_pk_bf16_f32 v150, v156, v157
v_cvt_pk_bf16_f32 v151, v158, v159
buffer_store_dwordx4 v[148:151], v7, s[28:31], s50 offen sc1
v_accvgpr_read_b32 v164, a32
v_accvgpr_read_b32 v165, a33
v_accvgpr_read_b32 v166, a34
v_accvgpr_read_b32 v167, a35
v_accvgpr_read_b32 v168, a36
v_accvgpr_read_b32 v169, a37
v_accvgpr_read_b32 v170, a38
v_accvgpr_read_b32 v171, a39
s_add_u32 s50, s50, 4096
v_cvt_pk_bf16_f32 v160, v164, v165
v_cvt_pk_bf16_f32 v161, v166, v167
v_cvt_pk_bf16_f32 v162, v168, v169
v_cvt_pk_bf16_f32 v163, v170, v171
buffer_store_dwordx4 v[160:163], v7, s[28:31], s50 offen sc1
v_accvgpr_read_b32 v176, a40
v_accvgpr_read_b32 v177, a41
v_accvgpr_read_b32 v178, a42
v_accvgpr_read_b32 v179, a43
v_accvgpr_read_b32 v180, a44
v_accvgpr_read_b32 v181, a45
v_accvgpr_read_b32 v182, a46
v_accvgpr_read_b32 v183, a47
s_add_u32 s50, s50, 4096
v_cvt_pk_bf16_f32 v172, v176, v177
v_cvt_pk_bf16_f32 v173, v178, v179
v_cvt_pk_bf16_f32 v174, v180, v181
v_cvt_pk_bf16_f32 v175, v182, v183
buffer_store_dwordx4 v[172:175], v7, s[28:31], s50 offen sc1
v_accvgpr_read_b32 v116, a48
v_accvgpr_read_b32 v117, a49
v_accvgpr_read_b32 v118, a50
v_accvgpr_read_b32 v119, a51
v_accvgpr_read_b32 v120, a52
v_accvgpr_read_b32 v121, a53
v_accvgpr_read_b32 v122, a54
v_accvgpr_read_b32 v123, a55
s_add_u32 s50, s50, 4096
v_cvt_pk_bf16_f32 v112, v116, v117
v_cvt_pk_bf16_f32 v113, v118, v119
v_cvt_pk_bf16_f32 v114, v120, v121
v_cvt_pk_bf16_f32 v115, v122, v123
buffer_store_dwordx4 v[112:115], v7, s[28:31], s50 offen sc1
v_accvgpr_read_b32 v128, a56
v_accvgpr_read_b32 v129, a57
v_accvgpr_read_b32 v130, a58
v_accvgpr_read_b32 v131, a59
v_accvgpr_read_b32 v132, a60
v_accvgpr_read_b32 v133, a61
v_accvgpr_read_b32 v134, a62
v_accvgpr_read_b32 v135, a63
s_add_u32 s50, s50, 4096
v_cvt_pk_bf16_f32 v124, v128, v129
v_cvt_pk_bf16_f32 v125, v130, v131
v_cvt_pk_bf16_f32 v126, v132, v133
v_cvt_pk_bf16_f32 v127, v134, v135
buffer_store_dwordx4 v[124:127], v7, s[28:31], s50 offen sc1
v_accvgpr_read_b32 v140, a64
v_accvgpr_read_b32 v141, a65
v_accvgpr_read_b32 v142, a66
v_accvgpr_read_b32 v143, a67
v_accvgpr_read_b32 v144, a68
v_accvgpr_read_b32 v145, a69
v_accvgpr_read_b32 v146, a70
v_accvgpr_read_b32 v147, a71
s_add_u32 s50, s50, 4096
v_cvt_pk_bf16_f32 v136, v140, v141
v_cvt_pk_bf16_f32 v137, v142, v143
v_cvt_pk_bf16_f32 v138, v144, v145
v_cvt_pk_bf16_f32 v139, v146, v147
buffer_store_dwordx4 v[136:139], v7, s[28:31], s50 offen sc1
v_accvgpr_read_b32 v152, a72
v_accvgpr_read_b32 v153, a73
v_accvgpr_read_b32 v154, a74
v_accvgpr_read_b32 v155, a75
v_accvgpr_read_b32 v156, a76
v_accvgpr_read_b32 v157, a77
v_accvgpr_read_b32 v158, a78
v_accvgpr_read_b32 v159, a79
s_add_u32 s50, s50, 4096
v_cvt_pk_bf16_f32 v148, v152, v153
v_cvt_pk_bf16_f32 v149, v154, v155
v_cvt_pk_bf16_f32 v150, v156, v157
v_cvt_pk_bf16_f32 v151, v158, v159
buffer_store_dwordx4 v[148:151], v7, s[28:31], s50 offen sc1
v_accvgpr_read_b32 v164, a80
v_accvgpr_read_b32 v165, a81
v_accvgpr_read_b32 v166, a82
v_accvgpr_read_b32 v167, a83
v_accvgpr_read_b32 v168, a84
v_accvgpr_read_b32 v169, a85
v_accvgpr_read_b32 v170, a86
v_accvgpr_read_b32 v171, a87
s_add_u32 s50, s50, 4096
v_cvt_pk_bf16_f32 v160, v164, v165
v_cvt_pk_bf16_f32 v161, v166, v167
v_cvt_pk_bf16_f32 v162, v168, v169
v_cvt_pk_bf16_f32 v163, v170, v171
buffer_store_dwordx4 v[160:163], v7, s[28:31], s50 offen sc1
v_accvgpr_read_b32 v176, a88
v_accvgpr_read_b32 v177, a89
v_accvgpr_read_b32 v178, a90
v_accvgpr_read_b32 v179, a91
v_accvgpr_read_b32 v180, a92
v_accvgpr_read_b32 v181, a93
v_accvgpr_read_b32 v182, a94
v_accvgpr_read_b32 v183, a95
s_add_u32 s50, s50, 4096
v_cvt_pk_bf16_f32 v172, v176, v177
v_cvt_pk_bf16_f32 v173, v178, v179
v_cvt_pk_bf16_f32 v174, v180, v181
v_cvt_pk_bf16_f32 v175, v182, v183
buffer_store_dwordx4 v[172:175], v7, s[28:31], s50 offen sc1
v_accvgpr_read_b32 v116, a96
v_accvgpr_read_b32 v117, a97
v_accvgpr_read_b32 v118, a98
v_accvgpr_read_b32 v119, a99
s_add_u32 s50, s50, 4096
v_cvt_pk_bf16_f32 v112, v116, v117
v_cvt_pk_bf16_f32 v113, v118, v119
buffer_store_dwordx4 v[112:115], v7, s[28:31], s50 offen sc1
s_add_u32 s50, s50, 4096
s_waitcnt vmcnt(0)
s_barrier
buffer_store_dword v11, off, s[28:31], s72 sc1
s_cmp_lg_u32 s36, 0
s_cbranch_scc1 K1_p3_done
v_min_u32 v8, 3, v1
v_lshlrev_b32 v8, 2, v8
s_mov_b32 s80, 0x20000
K1_p3:
buffer_load_dword v9, v8, s[28:31], s87 offen sc1
s_waitcnt vmcnt(0)
v_cmp_ne_u32 vcc, 1, v9
s_sub_u32 s80, s80, 1
s_cmp_eq_u32 s80, 0
s_cbranch_scc1 K1_p3_done
s_cbranch_vccz K1_p3_done
s_sleep 4
s_branch K1_p3
K1_p3_done:
s_barrier
s_lshl_b32 s50, s74, 12
s_add_u32 s50, s50, s73
buffer_load_dwordx4 v[32:35], v7, s[28:31], s50 offen sc1
buffer_load_dwordx4 v[36:39], v7, s[28:31], s50 offen offset:1024 sc1
buffer_load_dwordx4 v[40:43], v7, s[28:31], s50 offen offset:2048 sc1
buffer_load_dwordx4 v[44:47], v7, s[28:31], s50 offen offset:3072 sc1
s_add_u32 s50, s50, 16384
buffer_load_dwordx4 v[48:51], v7, s[28:31], s50 offen sc1
buffer_load_dwordx4 v[52:55], v7, s[28:31], s50 offen offset:1024 sc1
buffer_load_dwordx4 v[56:59], v7, s[28:31], s50 offen offset:2048 sc1
buffer_load_dwordx4 v[60:63], v7, s[28:31], s50 offen offset:3072 sc1
s_add_u32 s50, s50, 16384
buffer_load_dwordx4 v[64:67], v7, s[28:31], s50 offen sc1
buffer_load_dwordx4 v[68:71], v7, s[28:31], s50 offen offset:1024 sc1
buffer_load_dwordx4 v[72:75], v7, s[28:31], s50 offen offset:2048 sc1
buffer_load_dwordx4 v[76:79], v7, s[28:31], s50 offen offset:3072 sc1
s_add_u32 s50, s50, 16384
s_cmp_eq_u32 s74, 0
s_cselect_b32 s50, s50, 0x7ff00000
buffer_load_dwordx4 v[80:83], v7, s[28:31], s50 offen sc1
buffer_load_dwordx4 v[84:87], v7, s[28:31], s50 offen offset:1024 sc1
buffer_load_dwordx4 v[88:91], v7, s[28:31], s50 offen offset:2048 sc1
buffer_load_dwordx4 v[92:95], v7, s[28:31], s50 offen offset:3072 sc1
s_add_u32 s50, s50, 16384
v_and_b32 v6, 15, v1
v_lshrrev_b32 v8, 4, v1
v_mul_u32_u24 v6, 2560, v6
v_lshl_add_u32 v6, v8, 3, v6
s_lshl_b32 s80, s74, 1
s_mov_b32 s81, 0xffff0000
s_waitcnt vmcnt(12)
v_lshlrev_b32 v100, 16, v32
v_and_b32 v101, s81, v32
v_lshlrev_b32 v14, 16, v36
v_and_b32 v15, s81, v36
v_add_f32 v100, v100, v14
v_add_f32 v101, v101, v15
v_lshlrev_b32 v14, 16, v40
v_and_b32 v15, s81, v40
v_add_f32 v100, v100, v14
v_add_f32 v101, v101, v15
v_lshlrev_b32 v14, 16, v44
v_and_b32 v15, s81, v44
v_add_f32 v100, v100, v14
v_add_f32 v101, v101, v15
v_cvt_pk_bf16_f32 v32, v100, v101
v_lshlrev_b32 v102, 16, v33
v_and_b32 v103, s81, v33
v_lshlrev_b32 v14, 16, v37
v_and_b32 v15, s81, v37
v_add_f32 v102, v102, v14
v_add_f32 v103, v103, v15
v_lshlrev_b32 v14, 16, v41
v_and_b32 v15, s81, v41
v_add_f32 v102, v102, v14
v_add_f32 v103, v103, v15
v_lshlrev_b32 v14, 16, v45
v_and_b32 v15, s81, v45
v_add_f32 v102, v102, v14
v_add_f32 v103, v103, v15
v_cvt_pk_bf16_f32 v33, v102, v103
v_lshlrev_b32 v104, 16, v34
v_and_b32 v105, s81, v34
v_lshlrev_b32 v14, 16, v38
v_and_b32 v15, s81, v38
v_add_f32 v104, v104, v14
v_add_f32 v105, v105, v15
v_lshlrev_b32 v14, 16, v42
v_and_b32 v15, s81, v42
v_add_f32 v104, v104, v14
v_add_f32 v105, v105, v15
v_lshlrev_b32 v14, 16, v46
v_and_b32 v15, s81, v46
v_add_f32 v104, v104, v14
v_add_f32 v105, v105, v15
v_cvt_pk_bf16_f32 v34, v104, v105
v_lshlrev_b32 v106, 16, v35
v_and_b32 v107, s81, v35
v_lshlrev_b32 v14, 16, v39
v_and_b32 v15, s81, v39
v_add_f32 v106, v106, v14
v_add_f32 v107, v107, v15
v_lshlrev_b32 v14, 16, v43
v_and_b32 v15, s81, v43
v_add_f32 v106, v106, v14
v_add_f32 v107, v107, v15
v_lshlrev_b32 v14, 16, v47
v_and_b32 v15, s81, v47
v_add_f32 v106, v106, v14
v_add_f32 v107, v107, v15
v_cvt_pk_bf16_f32 v35, v106, v107
s_mul_i32 s62, s80, 52
s_lshr_b32 s62, s62, 8
s_mul_i32 s63, s62, 5
s_sub_u32 s63, s80, s63
s_mul_i32 s63, s63, 40960
s_lshl_b32 s62, s62, 5
s_add_u32 s63, s63, s62
s_add_u32 s63, s63, s99
buffer_store_dwordx2 v[32:33], v6, s[92:95], s63 offen
s_add_u32 s80, s80, 1
s_mul_i32 s62, s80, 52
s_lshr_b32 s62, s62, 8
s_mul_i32 s63, s62, 5
s_sub_u32 s63, s80, s63
s_mul_i32 s63, s63, 40960
s_lshl_b32 s62, s62, 5
s_add_u32 s63, s63, s62
s_add_u32 s63, s63, s99
buffer_store_dwordx2 v[34:35], v6, s[92:95], s63 offen
s_add_u32 s80, s80, 7
s_waitcnt vmcnt(10)
v_lshlrev_b32 v100, 16, v48
v_and_b32 v101, s81, v48
v_lshlrev_b32 v14, 16, v52
v_and_b32 v15, s81, v52
v_add_f32 v100, v100, v14
v_add_f32 v101, v101, v15
v_lshlrev_b32 v14, 16, v56
v_and_b32 v15, s81, v56
v_add_f32 v100, v100, v14
v_add_f32 v101, v101, v15
v_lshlrev_b32 v14, 16, v60
v_and_b32 v15, s81, v60
v_add_f32 v100, v100, v14
v_add_f32 v101, v101, v15
v_cvt_pk_bf16_f32 v48, v100, v101
v_lshlrev_b32 v102, 16, v49
v_and_b32 v103, s81, v49
v_lshlrev_b32 v14, 16, v53
v_and_b32 v15, s81, v53
v_add_f32 v102, v102, v14
v_add_f32 v103, v103, v15
v_lshlrev_b32 v14, 16, v57
v_and_b32 v15, s81, v57
v_add_f32 v102, v102, v14
v_add_f32 v103, v103, v15
v_lshlrev_b32 v14, 16, v61
v_and_b32 v15, s81, v61
v_add_f32 v102, v102, v14
v_add_f32 v103, v103, v15
v_cvt_pk_bf16_f32 v49, v102, v103
v_lshlrev_b32 v104, 16, v50
v_and_b32 v105, s81, v50
v_lshlrev_b32 v14, 16, v54
v_and_b32 v15, s81, v54
v_add_f32 v104, v104, v14
v_add_f32 v105, v105, v15
v_lshlrev_b32 v14, 16, v58
v_and_b32 v15, s81, v58
v_add_f32 v104, v104, v14
v_add_f32 v105, v105, v15
v_lshlrev_b32 v14, 16, v62
v_and_b32 v15, s81, v62
v_add_f32 v104, v104, v14
v_add_f32 v105, v105, v15
v_cvt_pk_bf16_f32 v50, v104, v105
v_lshlrev_b32 v106, 16, v51
v_and_b32 v107, s81, v51
v_lshlrev_b32 v14, 16, v55
v_and_b32 v15, s81, v55
v_add_f32 v106, v106, v14
v_add_f32 v107, v107, v15
v_lshlrev_b32 v14, 16, v59
v_and_b32 v15, s81, v59
v_add_f32 v106, v106, v14
v_add_f32 v107, v107, v15
v_lshlrev_b32 v14, 16, v63
v_and_b32 v15, s81, v63
v_add_f32 v106, v106, v14
v_add_f32 v107, v107, v15
v_cvt_pk_bf16_f32 v51, v106, v107
s_mul_i32 s62, s80, 52
s_lshr_b32 s62, s62, 8
s_mul_i32 s63, s62, 5
s_sub_u32 s63, s80, s63
s_mul_i32 s63, s63, 40960
s_lshl_b32 s62, s62, 5
s_add_u32 s63, s63, s62
s_add_u32 s63, s63, s99
buffer_store_dwordx2 v[48:49], v6, s[92:95], s63 offen
s_add_u32 s80, s80, 1
s_mul_i32 s62, s80, 52
s_lshr_b32 s62, s62, 8
s_mul_i32 s63, s62, 5
s_sub_u32 s63, s80, s63
s_mul_i32 s63, s63, 40960
s_lshl_b32 s62, s62, 5
s_add_u32 s63, s63, s62
s_add_u32 s63, s63, s99
buffer_store_dwordx2 v[50:51], v6, s[92:95], s63 offen
s_add_u32 s80, s80, 7
s_waitcnt vmcnt(8)
v_lshlrev_b32 v100, 16, v64
v_and_b32 v101, s81, v64
v_lshlrev_b32 v14, 16, v68
v_and_b32 v15, s81, v68
v_add_f32 v100, v100, v14
v_add_f32 v101, v101, v15
v_lshlrev_b32 v14, 16, v72
v_and_b32 v15, s81, v72
v_add_f32 v100, v100, v14
v_add_f32 v101, v101, v15
v_lshlrev_b32 v14, 16, v76
v_and_b32 v15, s81, v76
v_add_f32 v100, v100, v14
v_add_f32 v101, v101, v15
v_cvt_pk_bf16_f32 v64, v100, v101
v_lshlrev_b32 v102, 16, v65
v_and_b32 v103, s81, v65
v_lshlrev_b32 v14, 16, v69
v_and_b32 v15, s81, v69
v_add_f32 v102, v102, v14
v_add_f32 v103, v103, v15
v_lshlrev_b32 v14, 16, v73
v_and_b32 v15, s81, v73
v_add_f32 v102, v102, v14
v_add_f32 v103, v103, v15
v_lshlrev_b32 v14, 16, v77
v_and_b32 v15, s81, v77
v_add_f32 v102, v102, v14
v_add_f32 v103, v103, v15
v_cvt_pk_bf16_f32 v65, v102, v103
v_lshlrev_b32 v104, 16, v66
v_and_b32 v105, s81, v66
v_lshlrev_b32 v14, 16, v70
v_and_b32 v15, s81, v70
v_add_f32 v104, v104, v14
v_add_f32 v105, v105, v15
v_lshlrev_b32 v14, 16, v74
v_and_b32 v15, s81, v74
v_add_f32 v104, v104, v14
v_add_f32 v105, v105, v15
v_lshlrev_b32 v14, 16, v78
v_and_b32 v15, s81, v78
v_add_f32 v104, v104, v14
v_add_f32 v105, v105, v15
v_cvt_pk_bf16_f32 v66, v104, v105
v_lshlrev_b32 v106, 16, v67
v_and_b32 v107, s81, v67
v_lshlrev_b32 v14, 16, v71
v_and_b32 v15, s81, v71
v_add_f32 v106, v106, v14
v_add_f32 v107, v107, v15
v_lshlrev_b32 v14, 16, v75
v_and_b32 v15, s81, v75
v_add_f32 v106, v106, v14
v_add_f32 v107, v107, v15
v_lshlrev_b32 v14, 16, v79
v_and_b32 v15, s81, v79
v_add_f32 v106, v106, v14
v_add_f32 v107, v107, v15
v_cvt_pk_bf16_f32 v67, v106, v107
s_mul_i32 s62, s80, 52
s_lshr_b32 s62, s62, 8
s_mul_i32 s63, s62, 5
s_sub_u32 s63, s80, s63
s_mul_i32 s63, s63, 40960
s_lshl_b32 s62, s62, 5
s_add_u32 s63, s63, s62
s_add_u32 s63, s63, s99
buffer_store_dwordx2 v[64:65], v6, s[92:95], s63 offen
s_add_u32 s80, s80, 1
s_mul_i32 s62, s80, 52
s_lshr_b32 s62, s62, 8
s_mul_i32 s63, s62, 5
s_sub_u32 s63, s80, s63
s_mul_i32 s63, s63, 40960
s_lshl_b32 s62, s62, 5
s_add_u32 s63, s63, s62
s_add_u32 s63, s63, s99
buffer_store_dwordx2 v[66:67], v6, s[92:95], s63 offen
s_add_u32 s80, s80, 7
s_waitcnt vmcnt(6)
v_lshlrev_b32 v100, 16, v80
v_and_b32 v101, s81, v80
v_lshlrev_b32 v14, 16, v84
v_and_b32 v15, s81, v84
v_add_f32 v100, v100, v14
v_add_f32 v101, v101, v15
v_lshlrev_b32 v14, 16, v88
v_and_b32 v15, s81, v88
v_add_f32 v100, v100, v14
v_add_f32 v101, v101, v15
v_lshlrev_b32 v14, 16, v92
v_and_b32 v15, s81, v92
v_add_f32 v100, v100, v14
v_add_f32 v101, v101, v15
v_cvt_pk_bf16_f32 v80, v100, v101
v_lshlrev_b32 v102, 16, v81
v_and_b32 v103, s81, v81
v_lshlrev_b32 v14, 16, v85
v_and_b32 v15, s81, v85
v_add_f32 v102, v102, v14
v_add_f32 v103, v103, v15
v_lshlrev_b32 v14, 16, v89
v_and_b32 v15, s81, v89
v_add_f32 v102, v102, v14
v_add_f32 v103, v103, v15
v_lshlrev_b32 v14, 16, v93
v_and_b32 v15, s81, v93
v_add_f32 v102, v102, v14
v_add_f32 v103, v103, v15
v_cvt_pk_bf16_f32 v81, v102, v103
s_mul_i32 s62, s80, 52
s_lshr_b32 s62, s62, 8
s_mul_i32 s63, s62, 5
s_sub_u32 s63, s80, s63
s_mul_i32 s63, s63, 40960
s_lshl_b32 s62, s62, 5
s_add_u32 s63, s63, s62
s_add_u32 s63, s63, s99
s_cmp_eq_u32 s74, 0
s_cselect_b32 s63, s63, 0x7ff00000
buffer_store_dwordx2 v[80:81], v6, s[92:95], s63 offen
s_add_u32 s80, s80, 1
K1_end:
s_endpgm
K1_slow:
s_waitcnt vmcnt(0) lgkmcnt(0)
v_and_b32 v24, 0x3df, v5
v_and_b32 v29, 2, v1
v_lshl_or_b32 v24, v29, 4, v24
v_xor_b32 v25, 32, v24
v_readfirstlane_b32 s51, v19
v_and_b32 v26, 0xfff, v2
v_and_b32 v27, 0xfff, v3
v_and_b32 v28, 0xfff, v4
s_nop 1
v_add_u32 v26, s51, v26
v_add_u32 v27, s51, v27
v_add_u32 v28, s51, v28
v_mov_b32 v212, 0xff800000
v_mov_b32 v216, 0xff800000
v_mov_b32 v220, 0xff800000
v_mov_b32 v224, 0xff800000
v_mov_b32 v228, 0xff800000
s_sub_u32 s50, s37, 131072
s_mov_b32 s54, 16
K1_sl1:
s_add_u32 m0, s51, 0
s_add_u32 s80, s50, 0
buffer_load_dwordx4 v24, s[12:15], s80 offen lds
buffer_load_dwordx4 v24, s[12:15], s80 offen offset:1024 lds
buffer_load_dwordx4 v25, s[12:15], s80 offen offset:2048 lds
buffer_load_dwordx4 v25, s[12:15], s80 offen offset:3072 lds
s_add_u32 m0, s51, 10240
s_add_u32 s80, s50, 4096
buffer_load_dwordx4 v24, s[12:15], s80 offen lds
buffer_load_dwordx4 v24, s[12:15], s80 offen offset:1024 lds
buffer_load_dwordx4 v25, s[12:15], s80 offen offset:2048 lds
buffer_load_dwordx4 v25, s[12:15], s80 offen offset:3072 lds
s_waitcnt vmcnt(0)
ds_read_b128 a[0:3], v26 offset:0
ds_read_b128 a[4:7], v26 offset:256
ds_read_b128 a[8:11], v26 offset:512
ds_read_b128 a[12:15], v26 offset:768
ds_read_b128 a[16:19], v26 offset:10240
ds_read_b128 a[20:23], v26 offset:10496
ds_read_b128 a[24:27], v26 offset:10752
ds_read_b128 a[28:31], v26 offset:11008
s_waitcnt lgkmcnt(7)
v_mfma_f32_16x16x32_bf16 v[232:235], a[0:3], a[96:99], 0
s_waitcnt lgkmcnt(6)
v_mfma_f32_16x16x32_bf16 v[232:235], a[4:7], a[100:103], v[232:235]
s_waitcnt lgkmcnt(5)
v_mfma_f32_16x16x32_bf16 v[232:235], a[8:11], a[104:107], v[232:235]
s_waitcnt lgkmcnt(4)
v_mfma_f32_16x16x32_bf16 v[232:235], a[12:15], a[108:111], v[232:235]
s_waitcnt lgkmcnt(3)
v_mfma_f32_16x16x32_bf16 v[236:239], a[16:19], a[96:99], 0
s_waitcnt lgkmcnt(2)
v_mfma_f32_16x16x32_bf16 v[236:239], a[20:23], a[100:103], v[236:239]
s_nop 3
v_max3_f32 v212, v212, v232, v233
s_waitcnt lgkmcnt(1)
v_mfma_f32_16x16x32_bf16 v[236:239], a[24:27], a[104:107], v[236:239]
v_max3_f32 v212, v212, v234, v235
s_waitcnt lgkmcnt(0)
v_mfma_f32_16x16x32_bf16 v[236:239], a[28:31], a[108:111], v[236:239]
v_mfma_f32_16x16x32_bf16 v[240:243], a[0:3], a[112:115], 0
v_mfma_f32_16x16x32_bf16 v[240:243], a[4:7], a[116:119], v[240:243]
s_nop 5
v_max3_f32 v212, v212, v236, v237
v_mfma_f32_16x16x32_bf16 v[240:243], a[8:11], a[120:123], v[240:243]
v_max3_f32 v212, v212, v238, v239
v_mfma_f32_16x16x32_bf16 v[240:243], a[12:15], a[124:127], v[240:243]
v_mfma_f32_16x16x32_bf16 v[244:247], a[16:19], a[112:115], 0
v_mfma_f32_16x16x32_bf16 v[244:247], a[20:23], a[116:119], v[244:247]
s_nop 5
v_max3_f32 v216, v216, v240, v241
v_mfma_f32_16x16x32_bf16 v[244:247], a[24:27], a[120:123], v[244:247]
v_max3_f32 v216, v216, v242, v243
v_mfma_f32_16x16x32_bf16 v[244:247], a[28:31], a[124:127], v[244:247]
v_mfma_f32_16x16x32_bf16 v[232:235], a[0:3], a[128:131], 0
v_mfma_f32_16x16x32_bf16 v[232:235], a[4:7], a[132:135], v[232:235]
s_nop 5
v_max3_f32 v216, v216, v244, v245
v_mfma_f32_16x16x32_bf16 v[232:235], a[8:11], a[136:139], v[232:235]
v_max3_f32 v216, v216, v246, v247
v_mfma_f32_16x16x32_bf16 v[232:235], a[12:15], a[140:143], v[232:235]
v_mfma_f32_16x16x32_bf16 v[236:239], a[16:19], a[128:131], 0
v_mfma_f32_16x16x32_bf16 v[236:239], a[20:23], a[132:135], v[236:239]
s_nop 5
v_max3_f32 v220, v220, v232, v233
v_mfma_f32_16x16x32_bf16 v[236:239], a[24:27], a[136:139], v[236:239]
v_max3_f32 v220, v220, v234, v235
v_mfma_f32_16x16x32_bf16 v[236:239], a[28:31], a[140:143], v[236:239]
v_mfma_f32_16x16x32_bf16 v[240:243], a[0:3], a[144:147], 0
v_mfma_f32_16x16x32_bf16 v[240:243], a[4:7], a[148:151], v[240:243]
s_nop 5
v_max3_f32 v220, v220, v236, v237
v_mfma_f32_16x16x32_bf16 v[240:243], a[8:11], a[152:155], v[240:243]
v_max3_f32 v220, v220, v238, v239
v_mfma_f32_16x16x32_bf16 v[240:243], a[12:15], a[156:159], v[240:243]
v_mfma_f32_16x16x32_bf16 v[244:247], a[16:19], a[144:147], 0
v_mfma_f32_16x16x32_bf16 v[244:247], a[20:23], a[148:151], v[244:247]
s_nop 5
v_max3_f32 v224, v224, v240, v241
v_mfma_f32_16x16x32_bf16 v[244:247], a[24:27], a[152:155], v[244:247]
v_max3_f32 v224, v224, v242, v243
v_mfma_f32_16x16x32_bf16 v[244:247], a[28:31], a[156:159], v[244:247]
v_mfma_f32_16x16x32_bf16 v[232:235], a[0:3], a[160:163], 0
v_mfma_f32_16x16x32_bf16 v[232:235], a[4:7], a[164:167], v[232:235]
s_nop 5
v_max3_f32 v224, v224, v244, v245
v_mfma_f32_16x16x32_bf16 v[232:235], a[8:11], a[168:171], v[232:235]
v_max3_f32 v224, v224, v246, v247
v_mfma_f32_16x16x32_bf16 v[232:235], a[12:15], a[172:175], v[232:235]
v_mfma_f32_16x16x32_bf16 v[236:239], a[16:19], a[160:163], 0
v_mfma_f32_16x16x32_bf16 v[236:239], a[20:23], a[164:167], v[236:239]
s_nop 5
v_max3_f32 v228, v228, v232, v233
v_mfma_f32_16x16x32_bf16 v[236:239], a[24:27], a[168:171], v[236:239]
v_max3_f32 v228, v228, v234, v235
v_mfma_f32_16x16x32_bf16 v[236:239], a[28:31], a[172:175], v[236:239]
s_nop 7
v_max3_f32 v228, v228, v236, v237
v_max3_f32 v228, v228, v238, v239
s_waitcnt lgkmcnt(0)
s_nop 7
s_add_u32 s50, s50, 8192
s_sub_u32 s54, s54, 1
s_cmp_lg_u32 s54, 0
s_cbranch_scc1 K1_sl1
v_mov_b32 v29, v212
s_nop 1
v_permlane32_swap_b32 v212, v29
s_nop 1
v_max_f32 v212, v212, v29
v_mov_b32 v29, v212
s_nop 1
v_permlane16_swap_b32 v212, v29
s_nop 1
v_max_f32 v212, v212, v29
v_sub_f32 v212, 0, v212
v_mov_b32 v213, v212
v_mov_b32 v214, v212
v_mov_b32 v215, v212
v_mov_b32 v29, v216
s_nop 1
v_permlane32_swap_b32 v216, v29
s_nop 1
v_max_f32 v216, v216, v29
v_mov_b32 v29, v216
s_nop 1
v_permlane16_swap_b32 v216, v29
s_nop 1
v_max_f32 v216, v216, v29
v_sub_f32 v216, 0, v216
v_mov_b32 v217, v216
v_mov_b32 v218, v216
v_mov_b32 v219, v216
v_mov_b32 v29, v220
s_nop 1
v_permlane32_swap_b32 v220, v29
s_nop 1
v_max_f32 v220, v220, v29
v_mov_b32 v29, v220
s_nop 1
v_permlane16_swap_b32 v220, v29
s_nop 1
v_max_f32 v220, v220, v29
v_sub_f32 v220, 0, v220
v_mov_b32 v221, v220
v_mov_b32 v222, v220
v_mov_b32 v223, v220
v_mov_b32 v29, v224
s_nop 1
v_permlane32_swap_b32 v224, v29
s_nop 1
v_max_f32 v224, v224, v29
v_mov_b32 v29, v224
s_nop 1
v_permlane16_swap_b32 v224, v29
s_nop 1
v_max_f32 v224, v224, v29
v_sub_f32 v224, 0, v224
v_mov_b32 v225, v224
v_mov_b32 v226, v224
v_mov_b32 v227, v224
v_mov_b32 v29, v228
s_nop 1
v_permlane32_swap_b32 v228, v29
s_nop 1
v_max_f32 v228, v228, v29
v_mov_b32 v29, v228
s_nop 1
v_permlane16_swap_b32 v228, v29
s_nop 1
v_max_f32 v228, v228, v29
v_sub_f32 v228, 0, v228
v_mov_b32 v229, v228
v_mov_b32 v230, v228
v_mov_b32 v231, v228
v_mov_b32 v32, 0
v_mov_b32 v33, 0
v_mov_b32 v34, 0
v_mov_b32 v35, 0
v_mov_b32 v36, 0
v_mov_b32 v37, 0
v_mov_b32 v38, 0
v_mov_b32 v39, 0
v_mov_b32 v40, 0
v_mov_b32 v41, 0
v_mov_b32 v42, 0
v_mov_b32 v43, 0
v_mov_b32 v44, 0
v_mov_b32 v45, 0
v_mov_b32 v46, 0
v_mov_b32 v47, 0
v_mov_b32 v48, 0
v_mov_b32 v49, 0
v_mov_b32 v50, 0
v_mov_b32 v51, 0
v_mov_b32 v52, 0
v_mov_b32 v53, 0
v_mov_b32 v54, 0
v_mov_b32 v55, 0
v_mov_b32 v56, 0
v_mov_b32 v57, 0
v_mov_b32 v58, 0
v_mov_b32 v59, 0
v_mov_b32 v60, 0
v_mov_b32 v61, 0
v_mov_b32 v62, 0
v_mov_b32 v63, 0
v_mov_b32 v64, 0
v_mov_b32 v65, 0
v_mov_b32 v66, 0
v_mov_b32 v67, 0
v_mov_b32 v68, 0
v_mov_b32 v69, 0
v_mov_b32 v70, 0
v_mov_b32 v71, 0
v_mov_b32 v72, 0
v_mov_b32 v73, 0
v_mov_b32 v74, 0
v_mov_b32 v75, 0
v_mov_b32 v76, 0
v_mov_b32 v77, 0
v_mov_b32 v78, 0
v_mov_b32 v79, 0
v_mov_b32 v80, 0
v_mov_b32 v81, 0
v_mov_b32 v82, 0
v_mov_b32 v83, 0
v_mov_b32 v84, 0
v_mov_b32 v85, 0
v_mov_b32 v86, 0
v_mov_b32 v87, 0
v_mov_b32 v88, 0
v_mov_b32 v89, 0
v_mov_b32 v90, 0
v_mov_b32 v91, 0
v_mov_b32 v92, 0
v_mov_b32 v93, 0
v_mov_b32 v94, 0
v_mov_b32 v95, 0
v_mov_b32 v96, 0
v_mov_b32 v97, 0
v_mov_b32 v98, 0
v_mov_b32 v99, 0
v_mov_b32 v100, 0
v_mov_b32 v101, 0
v_mov_b32 v102, 0
v_mov_b32 v103, 0
v_mov_b32 v104, 0
v_mov_b32 v105, 0
v_mov_b32 v106, 0
v_mov_b32 v107, 0
v_mov_b32 v108, 0
v_mov_b32 v109, 0
v_mov_b32 v110, 0
v_mov_b32 v111, 0
v_mov_b32 v112, 0
v_mov_b32 v113, 0
v_mov_b32 v114, 0
v_mov_b32 v115, 0
v_mov_b32 v116, 0
v_mov_b32 v117, 0
v_mov_b32 v118, 0
v_mov_b32 v119, 0
v_mov_b32 v120, 0
v_mov_b32 v121, 0
v_mov_b32 v122, 0
v_mov_b32 v123, 0
v_mov_b32 v124, 0
v_mov_b32 v125, 0
v_mov_b32 v126, 0
v_mov_b32 v127, 0
v_mov_b32 v128, 0
v_mov_b32 v129, 0
v_mov_b32 v130, 0
v_mov_b32 v131, 0
v_mov_b32 v132, 0
v_mov_b32 v133, 0
v_mov_b32 v134, 0
v_mov_b32 v135, 0
v_mov_b32 v136, 0
v_mov_b32 v137, 0
v_mov_b32 v138, 0
v_mov_b32 v139, 0
v_mov_b32 v140, 0
v_mov_b32 v141, 0
v_mov_b32 v142, 0
v_mov_b32 v143, 0
v_mov_b32 v144, 0
v_mov_b32 v145, 0
v_mov_b32 v146, 0
v_mov_b32 v147, 0
v_mov_b32 v148, 0
v_mov_b32 v149, 0
v_mov_b32 v150, 0
v_mov_b32 v151, 0
v_mov_b32 v152, 0
v_mov_b32 v153, 0
v_mov_b32 v154, 0
v_mov_b32 v155, 0
v_mov_b32 v156, 0
v_mov_b32 v157, 0
v_mov_b32 v158, 0
v_mov_b32 v159, 0
v_mov_b32 v160, 0
v_mov_b32 v161, 0
v_mov_b32 v162, 0
v_mov_b32 v163, 0
v_mov_b32 v164, 0
v_mov_b32 v165, 0
v_mov_b32 v166, 0
v_mov_b32 v167, 0
v_mov_b32 v168, 0
v_mov_b32 v169, 0
v_mov_b32 v170, 0
v_mov_b32 v171, 0
v_mov_b32 v172, 0
v_mov_b32 v173, 0
v_mov_b32 v174, 0
v_mov_b32 v175, 0
v_mov_b32 v176, 0
v_mov_b32 v177, 0
v_mov_b32 v178, 0
v_mov_b32 v179, 0
v_mov_b32 v180, 0
v_mov_b32 v181, 0
v_mov_b32 v182, 0
v_mov_b32 v183, 0
v_mov_b32 v184, 0
v_mov_b32 v185, 0
v_mov_b32 v186, 0
v_mov_b32 v187, 0
v_mov_b32 v188, 0
v_mov_b32 v189, 0
v_mov_b32 v190, 0
v_mov_b32 v191, 0
v_mov_b32 v192, 0
v_mov_b32 v193, 0
v_mov_b32 v194, 0
v_mov_b32 v195, 0
v_mov_b32 v196, 0
v_mov_b32 v197, 0
v_mov_b32 v198, 0
v_mov_b32 v199, 0
v_mov_b32 v200, 0
v_mov_b32 v201, 0
v_mov_b32 v202, 0
v_mov_b32 v203, 0
v_mov_b32 v204, 0
v_mov_b32 v205, 0
v_mov_b32 v206, 0
v_mov_b32 v207, 0
v_mov_b32 v208, 0
v_mov_b32 v209, 0
v_mov_b32 v210, 0
v_mov_b32 v211, 0
s_sub_u32 s50, s37, 131072
s_mov_b32 s54, 16
K1_sl2:
s_add_u32 m0, s51, 0
s_add_u32 s80, s50, 0
buffer_load_dwordx4 v24, s[12:15], s80 offen lds
buffer_load_dwordx4 v24, s[12:15], s80 offen offset:1024 lds
buffer_load_dwordx4 v25, s[12:15], s80 offen offset:2048 lds
buffer_load_dwordx4 v25, s[12:15], s80 offen offset:3072 lds
s_add_u32 m0, s51, 10240
s_add_u32 s80, s50, 4096
buffer_load_dwordx4 v24, s[12:15], s80 offen lds
buffer_load_dwordx4 v24, s[12:15], s80 offen offset:1024 lds
buffer_load_dwordx4 v25, s[12:15], s80 offen offset:2048 lds
buffer_load_dwordx4 v25, s[12:15], s80 offen offset:3072 lds
s_add_u32 m0, s51, 40960
s_add_u32 s80, s50, 0
buffer_load_dwordx4 v24, s[16:19], s80 offen lds
buffer_load_dwordx4 v25, s[16:19], s80 offen offset:1024 lds
buffer_load_dwordx4 v24, s[16:19], s80 offen offset:2048 lds
buffer_load_dwordx4 v25, s[16:19], s80 offen offset:3072 lds
s_add_u32 m0, s51, 51200
s_add_u32 s80, s50, 4096
buffer_load_dwordx4 v24, s[16:19], s80 offen lds
buffer_load_dwordx4 v25, s[16:19], s80 offen offset:1024 lds
buffer_load_dwordx4 v24, s[16:19], s80 offen offset:2048 lds
buffer_load_dwordx4 v25, s[16:19], s80 offen offset:3072 lds
s_waitcnt vmcnt(0)
ds_read_b128 a[0:3], v26 offset:0
ds_read_b128 a[4:7], v26 offset:256
ds_read_b128 a[8:11], v26 offset:512
ds_read_b128 a[12:15], v26 offset:768
ds_read_b128 a[16:19], v26 offset:10240
ds_read_b128 a[20:23], v26 offset:10496
ds_read_b128 a[24:27], v26 offset:10752
ds_read_b128 a[28:31], v26 offset:11008
ds_read_b64_tr_b16 a[32:33], v27 offset:40960
ds_read_b64_tr_b16 a[34:35], v27 offset:51200
s_waitcnt lgkmcnt(9)
v_mfma_f32_16x16x32_bf16 v[232:235], a[0:3], a[96:99], v[212:215]
ds_read_b64_tr_b16 a[36:37], v28 offset:40960
s_waitcnt lgkmcnt(9)
v_mfma_f32_16x16x32_bf16 v[232:235], a[4:7], a[100:103], v[232:235]
ds_read_b64_tr_b16 a[38:39], v28 offset:51200
s_waitcnt lgkmcnt(9)
v_mfma_f32_16x16x32_bf16 v[232:235], a[8:11], a[104:107], v[232:235]
ds_read_b64_tr_b16 a[40:41], v27 offset:41216
s_waitcnt lgkmcnt(9)
v_mfma_f32_16x16x32_bf16 v[232:235], a[12:15], a[108:111], v[232:235]
ds_read_b64_tr_b16 a[42:43], v27 offset:51456
s_waitcnt lgkmcnt(9)
v_mfma_f32_16x16x32_bf16 v[236:239], a[16:19], a[96:99], v[212:215]
ds_read_b64_tr_b16 a[44:45], v28 offset:41216
s_waitcnt lgkmcnt(9)
v_mfma_f32_16x16x32_bf16 v[236:239], a[20:23], a[100:103], v[236:239]
ds_read_b64_tr_b16 a[46:47], v28 offset:51456
s_nop 0
v_exp_f32 v232, v232
s_waitcnt lgkmcnt(9)
v_mfma_f32_16x16x32_bf16 v[236:239], a[24:27], a[104:107], v[236:239]
ds_read_b64_tr_b16 a[48:49], v27 offset:41472
v_exp_f32 v233, v233
s_waitcnt lgkmcnt(9)
v_mfma_f32_16x16x32_bf16 v[236:239], a[28:31], a[108:111], v[236:239]
ds_read_b64_tr_b16 a[50:51], v27 offset:51712
v_exp_f32 v234, v234
ds_read_b64_tr_b16 a[52:53], v28 offset:41472
v_exp_f32 v235, v235
ds_read_b64_tr_b16 a[54:55], v28 offset:51712
v_cvt_pk_bf16_f32 v248, v232, v233
ds_read_b64_tr_b16 a[56:57], v27 offset:41728
s_nop 0
v_exp_f32 v236, v236
ds_read_b64_tr_b16 a[58:59], v27 offset:51968
v_exp_f32 v237, v237
ds_read_b64_tr_b16 a[60:61], v28 offset:41728
v_exp_f32 v238, v238
ds_read_b64_tr_b16 a[62:63], v28 offset:51968
v_exp_f32 v239, v239
v_cvt_pk_bf16_f32 v249, v234, v235
v_cvt_pk_bf16_f32 v250, v236, v237
v_cvt_pk_bf16_f32 v251, v238, v239
s_waitcnt lgkmcnt(11)
s_nop 0
v_mfma_f32_16x16x32_bf16 v[32:35], a[32:35], v[248:251], v[32:35]
v_mfma_f32_16x16x32_bf16 v[36:39], a[36:39], v[248:251], v[36:39]
s_waitcnt lgkmcnt(9)
v_mfma_f32_16x16x32_bf16 v[40:43], a[40:43], v[248:251], v[40:43]
s_waitcnt lgkmcnt(8)
v_mfma_f32_16x16x32_bf16 v[44:47], a[44:47], v[248:251], v[44:47]
s_waitcnt lgkmcnt(6)
v_mfma_f32_16x16x32_bf16 v[48:51], a[48:51], v[248:251], v[48:51]
s_waitcnt lgkmcnt(4)
v_mfma_f32_16x16x32_bf16 v[52:55], a[52:55], v[248:251], v[52:55]
s_waitcnt lgkmcnt(2)
v_mfma_f32_16x16x32_bf16 v[56:59], a[56:59], v[248:251], v[56:59]
s_waitcnt lgkmcnt(0)
v_mfma_f32_16x16x32_bf16 v[60:63], a[60:63], v[248:251], v[60:63]
v_mfma_f32_16x16x32_bf16 v[192:195], a[252:255], v[248:251], v[192:195]
v_mfma_f32_16x16x32_bf16 v[240:243], a[0:3], a[112:115], v[216:219]
v_mfma_f32_16x16x32_bf16 v[240:243], a[4:7], a[116:119], v[240:243]
v_mfma_f32_16x16x32_bf16 v[240:243], a[8:11], a[120:123], v[240:243]
v_mfma_f32_16x16x32_bf16 v[240:243], a[12:15], a[124:127], v[240:243]
v_mfma_f32_16x16x32_bf16 v[244:247], a[16:19], a[112:115], v[216:219]
v_mfma_f32_16x16x32_bf16 v[244:247], a[20:23], a[116:119], v[244:247]
s_nop 5
v_exp_f32 v240, v240
v_mfma_f32_16x16x32_bf16 v[244:247], a[24:27], a[120:123], v[244:247]
v_exp_f32 v241, v241
v_mfma_f32_16x16x32_bf16 v[244:247], a[28:31], a[124:127], v[244:247]
v_exp_f32 v242, v242
v_exp_f32 v243, v243
v_cvt_pk_bf16_f32 v252, v240, v241
v_cvt_pk_bf16_f32 v253, v242, v243
s_nop 3
v_exp_f32 v244, v244
v_exp_f32 v245, v245
v_exp_f32 v246, v246
v_exp_f32 v247, v247
v_cvt_pk_bf16_f32 v254, v244, v245
v_cvt_pk_bf16_f32 v255, v246, v247
s_nop 1
v_mfma_f32_16x16x32_bf16 v[64:67], a[32:35], v[252:255], v[64:67]
v_mfma_f32_16x16x32_bf16 v[68:71], a[36:39], v[252:255], v[68:71]
v_mfma_f32_16x16x32_bf16 v[72:75], a[40:43], v[252:255], v[72:75]
v_mfma_f32_16x16x32_bf16 v[76:79], a[44:47], v[252:255], v[76:79]
v_mfma_f32_16x16x32_bf16 v[80:83], a[48:51], v[252:255], v[80:83]
v_mfma_f32_16x16x32_bf16 v[84:87], a[52:55], v[252:255], v[84:87]
v_mfma_f32_16x16x32_bf16 v[88:91], a[56:59], v[252:255], v[88:91]
v_mfma_f32_16x16x32_bf16 v[92:95], a[60:63], v[252:255], v[92:95]
v_mfma_f32_16x16x32_bf16 v[196:199], a[252:255], v[252:255], v[196:199]
v_mfma_f32_16x16x32_bf16 v[232:235], a[0:3], a[128:131], v[220:223]
v_mfma_f32_16x16x32_bf16 v[232:235], a[4:7], a[132:135], v[232:235]
v_mfma_f32_16x16x32_bf16 v[232:235], a[8:11], a[136:139], v[232:235]
v_mfma_f32_16x16x32_bf16 v[232:235], a[12:15], a[140:143], v[232:235]
v_mfma_f32_16x16x32_bf16 v[236:239], a[16:19], a[128:131], v[220:223]
v_mfma_f32_16x16x32_bf16 v[236:239], a[20:23], a[132:135], v[236:239]
s_nop 5
v_exp_f32 v232, v232
v_mfma_f32_16x16x32_bf16 v[236:239], a[24:27], a[136:139], v[236:239]
v_exp_f32 v233, v233
v_mfma_f32_16x16x32_bf16 v[236:239], a[28:31], a[140:143], v[236:239]
v_exp_f32 v234, v234
v_exp_f32 v235, v235
v_cvt_pk_bf16_f32 v248, v232, v233
v_cvt_pk_bf16_f32 v249, v234, v235
s_nop 3
v_exp_f32 v236, v236
v_exp_f32 v237, v237
v_exp_f32 v238, v238
v_exp_f32 v239, v239
v_cvt_pk_bf16_f32 v250, v236, v237
v_cvt_pk_bf16_f32 v251, v238, v239
s_nop 1
v_mfma_f32_16x16x32_bf16 v[96:99], a[32:35], v[248:251], v[96:99]
v_mfma_f32_16x16x32_bf16 v[100:103], a[36:39], v[248:251], v[100:103]
v_mfma_f32_16x16x32_bf16 v[104:107], a[40:43], v[248:251], v[104:107]
v_mfma_f32_16x16x32_bf16 v[108:111], a[44:47], v[248:251], v[108:111]
v_mfma_f32_16x16x32_bf16 v[112:115], a[48:51], v[248:251], v[112:115]
v_mfma_f32_16x16x32_bf16 v[116:119], a[52:55], v[248:251], v[116:119]
v_mfma_f32_16x16x32_bf16 v[120:123], a[56:59], v[248:251], v[120:123]
v_mfma_f32_16x16x32_bf16 v[124:127], a[60:63], v[248:251], v[124:127]
v_mfma_f32_16x16x32_bf16 v[200:203], a[252:255], v[248:251], v[200:203]
v_mfma_f32_16x16x32_bf16 v[240:243], a[0:3], a[144:147], v[224:227]
v_mfma_f32_16x16x32_bf16 v[240:243], a[4:7], a[148:151], v[240:243]
v_mfma_f32_16x16x32_bf16 v[240:243], a[8:11], a[152:155], v[240:243]
v_mfma_f32_16x16x32_bf16 v[240:243], a[12:15], a[156:159], v[240:243]
v_mfma_f32_16x16x32_bf16 v[244:247], a[16:19], a[144:147], v[224:227]
v_mfma_f32_16x16x32_bf16 v[244:247], a[20:23], a[148:151], v[244:247]
s_nop 5
v_exp_f32 v240, v240
v_mfma_f32_16x16x32_bf16 v[244:247], a[24:27], a[152:155], v[244:247]
v_exp_f32 v241, v241
v_mfma_f32_16x16x32_bf16 v[244:247], a[28:31], a[156:159], v[244:247]
v_exp_f32 v242, v242
v_exp_f32 v243, v243
v_cvt_pk_bf16_f32 v252, v240, v241
v_cvt_pk_bf16_f32 v253, v242, v243
s_nop 3
v_exp_f32 v244, v244
v_exp_f32 v245, v245
v_exp_f32 v246, v246
v_exp_f32 v247, v247
v_cvt_pk_bf16_f32 v254, v244, v245
v_cvt_pk_bf16_f32 v255, v246, v247
s_nop 1
v_mfma_f32_16x16x32_bf16 v[128:131], a[32:35], v[252:255], v[128:131]
v_mfma_f32_16x16x32_bf16 v[132:135], a[36:39], v[252:255], v[132:135]
v_mfma_f32_16x16x32_bf16 v[136:139], a[40:43], v[252:255], v[136:139]
v_mfma_f32_16x16x32_bf16 v[140:143], a[44:47], v[252:255], v[140:143]
v_mfma_f32_16x16x32_bf16 v[144:147], a[48:51], v[252:255], v[144:147]
v_mfma_f32_16x16x32_bf16 v[148:151], a[52:55], v[252:255], v[148:151]
v_mfma_f32_16x16x32_bf16 v[152:155], a[56:59], v[252:255], v[152:155]
v_mfma_f32_16x16x32_bf16 v[156:159], a[60:63], v[252:255], v[156:159]
v_mfma_f32_16x16x32_bf16 v[204:207], a[252:255], v[252:255], v[204:207]
v_mfma_f32_16x16x32_bf16 v[232:235], a[0:3], a[160:163], v[228:231]
v_mfma_f32_16x16x32_bf16 v[232:235], a[4:7], a[164:167], v[232:235]
v_mfma_f32_16x16x32_bf16 v[232:235], a[8:11], a[168:171], v[232:235]
v_mfma_f32_16x16x32_bf16 v[232:235], a[12:15], a[172:175], v[232:235]
v_mfma_f32_16x16x32_bf16 v[236:239], a[16:19], a[160:163], v[228:231]
v_mfma_f32_16x16x32_bf16 v[236:239], a[20:23], a[164:167], v[236:239]
s_nop 5
v_exp_f32 v232, v232
v_mfma_f32_16x16x32_bf16 v[236:239], a[24:27], a[168:171], v[236:239]
v_exp_f32 v233, v233
v_mfma_f32_16x16x32_bf16 v[236:239], a[28:31], a[172:175], v[236:239]
v_exp_f32 v234, v234
v_exp_f32 v235, v235
v_cvt_pk_bf16_f32 v248, v232, v233
v_cvt_pk_bf16_f32 v249, v234, v235
s_nop 3
v_exp_f32 v236, v236
v_exp_f32 v237, v237
v_exp_f32 v238, v238
v_exp_f32 v239, v239
v_cvt_pk_bf16_f32 v250, v236, v237
v_cvt_pk_bf16_f32 v251, v238, v239
s_nop 1
v_mfma_f32_16x16x32_bf16 v[160:163], a[32:35], v[248:251], v[160:163]
v_mfma_f32_16x16x32_bf16 v[164:167], a[36:39], v[248:251], v[164:167]
v_mfma_f32_16x16x32_bf16 v[168:171], a[40:43], v[248:251], v[168:171]
v_mfma_f32_16x16x32_bf16 v[172:175], a[44:47], v[248:251], v[172:175]
v_mfma_f32_16x16x32_bf16 v[176:179], a[48:51], v[248:251], v[176:179]
v_mfma_f32_16x16x32_bf16 v[180:183], a[52:55], v[248:251], v[180:183]
v_mfma_f32_16x16x32_bf16 v[184:187], a[56:59], v[248:251], v[184:187]
v_mfma_f32_16x16x32_bf16 v[188:191], a[60:63], v[248:251], v[188:191]
v_mfma_f32_16x16x32_bf16 v[208:211], a[252:255], v[248:251], v[208:211]
s_waitcnt lgkmcnt(0)
s_nop 7
s_add_u32 s50, s50, 8192
s_sub_u32 s54, s54, 1
s_cmp_lg_u32 s54, 0
s_cbranch_scc1 K1_sl2
s_nop 7
v_rcp_f32 v192, v192
s_add_u32 s80, s44, 0
v_mov_b32 v193, v192
v_pk_mul_f32 v[32:33], v[32:33], v[192:193]
v_pk_mul_f32 v[34:35], v[34:35], v[192:193]
v_cvt_pk_bf16_f32 v32, v32, v33
v_pk_mul_f32 v[36:37], v[36:37], v[192:193]
v_pk_mul_f32 v[38:39], v[38:39], v[192:193]
v_cvt_pk_bf16_f32 v33, v34, v35
v_cvt_pk_bf16_f32 v34, v36, v37
v_cvt_pk_bf16_f32 v35, v38, v39
buffer_store_dwordx4 v[32:35], v7, s[28:31], s80 offen sc1
v_pk_mul_f32 v[40:41], v[40:41], v[192:193]
v_pk_mul_f32 v[42:43], v[42:43], v[192:193]
v_cvt_pk_bf16_f32 v40, v40, v41
v_pk_mul_f32 v[44:45], v[44:45], v[192:193]
v_pk_mul_f32 v[46:47], v[46:47], v[192:193]
v_cvt_pk_bf16_f32 v41, v42, v43
v_cvt_pk_bf16_f32 v42, v44, v45
v_cvt_pk_bf16_f32 v43, v46, v47
s_add_u32 s80, s44, 10240
buffer_store_dwordx4 v[40:43], v7, s[28:31], s80 offen sc1
v_pk_mul_f32 v[48:49], v[48:49], v[192:193]
v_pk_mul_f32 v[50:51], v[50:51], v[192:193]
v_cvt_pk_bf16_f32 v48, v48, v49
v_pk_mul_f32 v[52:53], v[52:53], v[192:193]
v_pk_mul_f32 v[54:55], v[54:55], v[192:193]
v_cvt_pk_bf16_f32 v49, v50, v51
v_cvt_pk_bf16_f32 v50, v52, v53
v_cvt_pk_bf16_f32 v51, v54, v55
s_add_u32 s80, s44, 20480
buffer_store_dwordx4 v[48:51], v7, s[28:31], s80 offen sc1
v_pk_mul_f32 v[56:57], v[56:57], v[192:193]
v_pk_mul_f32 v[58:59], v[58:59], v[192:193]
v_cvt_pk_bf16_f32 v56, v56, v57
v_pk_mul_f32 v[60:61], v[60:61], v[192:193]
v_pk_mul_f32 v[62:63], v[62:63], v[192:193]
v_cvt_pk_bf16_f32 v57, v58, v59
v_cvt_pk_bf16_f32 v58, v60, v61
v_cvt_pk_bf16_f32 v59, v62, v63
s_add_u32 s80, s44, 30720
buffer_store_dwordx4 v[56:59], v7, s[28:31], s80 offen sc1
v_rcp_f32 v196, v196
s_add_u32 s80, s44, 1024
v_mov_b32 v197, v196
v_pk_mul_f32 v[64:65], v[64:65], v[196:197]
v_pk_mul_f32 v[66:67], v[66:67], v[196:197]
v_cvt_pk_bf16_f32 v64, v64, v65
v_pk_mul_f32 v[68:69], v[68:69], v[196:197]
v_pk_mul_f32 v[70:71], v[70:71], v[196:197]
v_cvt_pk_bf16_f32 v65, v66, v67
v_cvt_pk_bf16_f32 v66, v68, v69
v_cvt_pk_bf16_f32 v67, v70, v71
buffer_store_dwordx4 v[64:67], v7, s[28:31], s80 offen sc1
v_pk_mul_f32 v[72:73], v[72:73], v[196:197]
v_pk_mul_f32 v[74:75], v[74:75], v[196:197]
v_cvt_pk_bf16_f32 v72, v72, v73
v_pk_mul_f32 v[76:77], v[76:77], v[196:197]
v_pk_mul_f32 v[78:79], v[78:79], v[196:197]
v_cvt_pk_bf16_f32 v73, v74, v75
v_cvt_pk_bf16_f32 v74, v76, v77
v_cvt_pk_bf16_f32 v75, v78, v79
s_add_u32 s80, s44, 11264
buffer_store_dwordx4 v[72:75], v7, s[28:31], s80 offen sc1
v_pk_mul_f32 v[80:81], v[80:81], v[196:197]
v_pk_mul_f32 v[82:83], v[82:83], v[196:197]
v_cvt_pk_bf16_f32 v80, v80, v81
v_pk_mul_f32 v[84:85], v[84:85], v[196:197]
v_pk_mul_f32 v[86:87], v[86:87], v[196:197]
v_cvt_pk_bf16_f32 v81, v82, v83
v_cvt_pk_bf16_f32 v82, v84, v85
v_cvt_pk_bf16_f32 v83, v86, v87
s_add_u32 s80, s44, 21504
buffer_store_dwordx4 v[80:83], v7, s[28:31], s80 offen sc1
v_pk_mul_f32 v[88:89], v[88:89], v[196:197]
v_pk_mul_f32 v[90:91], v[90:91], v[196:197]
v_cvt_pk_bf16_f32 v88, v88, v89
v_pk_mul_f32 v[92:93], v[92:93], v[196:197]
v_pk_mul_f32 v[94:95], v[94:95], v[196:197]
v_cvt_pk_bf16_f32 v89, v90, v91
v_cvt_pk_bf16_f32 v90, v92, v93
v_cvt_pk_bf16_f32 v91, v94, v95
s_add_u32 s80, s44, 31744
buffer_store_dwordx4 v[88:91], v7, s[28:31], s80 offen sc1
v_rcp_f32 v200, v200
s_add_u32 s80, s44, 2048
v_mov_b32 v201, v200
v_pk_mul_f32 v[96:97], v[96:97], v[200:201]
v_pk_mul_f32 v[98:99], v[98:99], v[200:201]
v_cvt_pk_bf16_f32 v96, v96, v97
v_pk_mul_f32 v[100:101], v[100:101], v[200:201]
v_pk_mul_f32 v[102:103], v[102:103], v[200:201]
v_cvt_pk_bf16_f32 v97, v98, v99
v_cvt_pk_bf16_f32 v98, v100, v101
v_cvt_pk_bf16_f32 v99, v102, v103
buffer_store_dwordx4 v[96:99], v7, s[28:31], s80 offen sc1
v_pk_mul_f32 v[104:105], v[104:105], v[200:201]
v_pk_mul_f32 v[106:107], v[106:107], v[200:201]
v_cvt_pk_bf16_f32 v104, v104, v105
v_pk_mul_f32 v[108:109], v[108:109], v[200:201]
v_pk_mul_f32 v[110:111], v[110:111], v[200:201]
v_cvt_pk_bf16_f32 v105, v106, v107
v_cvt_pk_bf16_f32 v106, v108, v109
v_cvt_pk_bf16_f32 v107, v110, v111
s_add_u32 s80, s44, 12288
buffer_store_dwordx4 v[104:107], v7, s[28:31], s80 offen sc1
v_pk_mul_f32 v[112:113], v[112:113], v[200:201]
v_pk_mul_f32 v[114:115], v[114:115], v[200:201]
v_cvt_pk_bf16_f32 v112, v112, v113
v_pk_mul_f32 v[116:117], v[116:117], v[200:201]
v_pk_mul_f32 v[118:119], v[118:119], v[200:201]
v_cvt_pk_bf16_f32 v113, v114, v115
v_cvt_pk_bf16_f32 v114, v116, v117
v_cvt_pk_bf16_f32 v115, v118, v119
s_add_u32 s80, s44, 22528
buffer_store_dwordx4 v[112:115], v7, s[28:31], s80 offen sc1
v_pk_mul_f32 v[120:121], v[120:121], v[200:201]
v_pk_mul_f32 v[122:123], v[122:123], v[200:201]
v_cvt_pk_bf16_f32 v120, v120, v121
v_pk_mul_f32 v[124:125], v[124:125], v[200:201]
v_pk_mul_f32 v[126:127], v[126:127], v[200:201]
v_cvt_pk_bf16_f32 v121, v122, v123
v_cvt_pk_bf16_f32 v122, v124, v125
v_cvt_pk_bf16_f32 v123, v126, v127
s_add_u32 s80, s44, 32768
buffer_store_dwordx4 v[120:123], v7, s[28:31], s80 offen sc1
v_rcp_f32 v204, v204
s_add_u32 s80, s44, 3072
v_mov_b32 v205, v204
v_pk_mul_f32 v[128:129], v[128:129], v[204:205]
v_pk_mul_f32 v[130:131], v[130:131], v[204:205]
v_cvt_pk_bf16_f32 v128, v128, v129
v_pk_mul_f32 v[132:133], v[132:133], v[204:205]
v_pk_mul_f32 v[134:135], v[134:135], v[204:205]
v_cvt_pk_bf16_f32 v129, v130, v131
v_cvt_pk_bf16_f32 v130, v132, v133
v_cvt_pk_bf16_f32 v131, v134, v135
buffer_store_dwordx4 v[128:131], v7, s[28:31], s80 offen sc1
v_pk_mul_f32 v[136:137], v[136:137], v[204:205]
v_pk_mul_f32 v[138:139], v[138:139], v[204:205]
v_cvt_pk_bf16_f32 v136, v136, v137
v_pk_mul_f32 v[140:141], v[140:141], v[204:205]
v_pk_mul_f32 v[142:143], v[142:143], v[204:205]
v_cvt_pk_bf16_f32 v137, v138, v139
v_cvt_pk_bf16_f32 v138, v140, v141
v_cvt_pk_bf16_f32 v139, v142, v143
s_add_u32 s80, s44, 13312
buffer_store_dwordx4 v[136:139], v7, s[28:31], s80 offen sc1
v_pk_mul_f32 v[144:145], v[144:145], v[204:205]
v_pk_mul_f32 v[146:147], v[146:147], v[204:205]
v_cvt_pk_bf16_f32 v144, v144, v145
v_pk_mul_f32 v[148:149], v[148:149], v[204:205]
v_pk_mul_f32 v[150:151], v[150:151], v[204:205]
v_cvt_pk_bf16_f32 v145, v146, v147
v_cvt_pk_bf16_f32 v146, v148, v149
v_cvt_pk_bf16_f32 v147, v150, v151
s_add_u32 s80, s44, 23552
buffer_store_dwordx4 v[144:147], v7, s[28:31], s80 offen sc1
v_pk_mul_f32 v[152:153], v[152:153], v[204:205]
v_pk_mul_f32 v[154:155], v[154:155], v[204:205]
v_cvt_pk_bf16_f32 v152, v152, v153
v_pk_mul_f32 v[156:157], v[156:157], v[204:205]
v_pk_mul_f32 v[158:159], v[158:159], v[204:205]
v_cvt_pk_bf16_f32 v153, v154, v155
v_cvt_pk_bf16_f32 v154, v156, v157
v_cvt_pk_bf16_f32 v155, v158, v159
s_add_u32 s80, s44, 33792
buffer_store_dwordx4 v[152:155], v7, s[28:31], s80 offen sc1
v_rcp_f32 v208, v208
s_add_u32 s80, s44, 4096
v_mov_b32 v209, v208
v_pk_mul_f32 v[160:161], v[160:161], v[208:209]
v_pk_mul_f32 v[162:163], v[162:163], v[208:209]
v_cvt_pk_bf16_f32 v160, v160, v161
v_pk_mul_f32 v[164:165], v[164:165], v[208:209]
v_pk_mul_f32 v[166:167], v[166:167], v[208:209]
v_cvt_pk_bf16_f32 v161, v162, v163
v_cvt_pk_bf16_f32 v162, v164, v165
v_cvt_pk_bf16_f32 v163, v166, v167
buffer_store_dwordx4 v[160:163], v7, s[28:31], s80 offen sc1
v_pk_mul_f32 v[168:169], v[168:169], v[208:209]
v_pk_mul_f32 v[170:171], v[170:171], v[208:209]
v_cvt_pk_bf16_f32 v168, v168, v169
v_pk_mul_f32 v[172:173], v[172:173], v[208:209]
v_pk_mul_f32 v[174:175], v[174:175], v[208:209]
v_cvt_pk_bf16_f32 v169, v170, v171
v_cvt_pk_bf16_f32 v170, v172, v173
v_cvt_pk_bf16_f32 v171, v174, v175
s_add_u32 s80, s44, 14336
buffer_store_dwordx4 v[168:171], v7, s[28:31], s80 offen sc1
v_pk_mul_f32 v[176:177], v[176:177], v[208:209]
v_pk_mul_f32 v[178:179], v[178:179], v[208:209]
v_cvt_pk_bf16_f32 v176, v176, v177
v_pk_mul_f32 v[180:181], v[180:181], v[208:209]
v_pk_mul_f32 v[182:183], v[182:183], v[208:209]
v_cvt_pk_bf16_f32 v177, v178, v179
v_cvt_pk_bf16_f32 v178, v180, v181
v_cvt_pk_bf16_f32 v179, v182, v183
s_add_u32 s80, s44, 24576
buffer_store_dwordx4 v[176:179], v7, s[28:31], s80 offen sc1
v_pk_mul_f32 v[184:185], v[184:185], v[208:209]
v_pk_mul_f32 v[186:187], v[186:187], v[208:209]
v_cvt_pk_bf16_f32 v184, v184, v185
v_pk_mul_f32 v[188:189], v[188:189], v[208:209]
v_pk_mul_f32 v[190:191], v[190:191], v[208:209]
v_cvt_pk_bf16_f32 v185, v186, v187
v_cvt_pk_bf16_f32 v186, v188, v189
v_cvt_pk_bf16_f32 v187, v190, v191
s_add_u32 s80, s44, 34816
buffer_store_dwordx4 v[184:187], v7, s[28:31], s80 offen sc1
ds_write_b128 v19, v[32:35] offset:0
ds_write_b128 v19, v[40:43] offset:10240
ds_write_b128 v19, v[48:51] offset:40960
ds_write_b128 v19, v[56:59] offset:51200
ds_write_b128 v19, v[64:67] offset:1024
ds_write_b128 v19, v[72:75] offset:11264
ds_write_b128 v19, v[80:83] offset:41984
ds_write_b128 v19, v[88:91] offset:52224
ds_write_b128 v19, v[96:99] offset:2048
ds_write_b128 v19, v[104:107] offset:12288
ds_write_b128 v19, v[112:115] offset:43008
ds_write_b128 v19, v[120:123] offset:53248
ds_write_b128 v19, v[128:131] offset:3072
ds_write_b128 v19, v[136:139] offset:13312
ds_write_b128 v19, v[144:147] offset:44032
ds_write_b128 v19, v[152:155] offset:54272
ds_write_b128 v19, v[160:163] offset:4096
ds_write_b128 v19, v[168:171] offset:14336
ds_write_b128 v19, v[176:179] offset:45056
ds_write_b128 v19, v[184:187] offset:55296
s_waitcnt vmcnt(0) lgkmcnt(0)
s_branch K1_rejoin
.section .rodata,"a"
.p2align 6
.amdhsa_kernel concat_heads__gqa_block_cached__gqa_block_cached__near_ridge_kernel
  .amdhsa_next_free_vgpr 512
  .amdhsa_next_free_sgpr 102
  .amdhsa_accum_offset 256
  .amdhsa_group_segment_fixed_size 0
  .amdhsa_kernarg_size 104
  .amdhsa_user_sgpr_count 2
  .amdhsa_user_sgpr_kernarg_segment_ptr 1
  .amdhsa_system_sgpr_workgroup_id_x 1
.end_amdhsa_kernel
```
